```python
import torch

def _softmax(x, axis=-1):
    return torch.softmax(x, dim=axis)

def _gelu(x):
    return torch.nn.functional.gelu(x, approximate='tanh')

def _silu(x):
    return torch.nn.functional.silu(x)

def _sigmoid(x):
    return torch.sigmoid(x)

def _layernorm(x, axis=-1, eps=1e-05):
    m = x.mean(dim=axis, keepdim=True)
    v = x.var(dim=axis, keepdim=True, unbiased=False)
    return (x - m) / torch.sqrt(v + eps)

def _scatter_add(tgt, idx, src, axis=0):
    return tgt.clone().index_add_(axis, idx, src)

def _segment_sum(src, seg, n):
    out = torch.zeros((n,) + src.shape[1:], dtype=src.dtype)
    return out.index_add_(0, seg, src)

def _pad(x, pw):
    flat = tuple((v for pair in reversed(pw) for v in pair))
    return torch.nn.functional.pad(x, flat)
kernel_name = 'concat_heads__memory_aug_recurrent_mem_tr__mha_block__prompt'

def setup_inputs():

    _w = lambda a: (lambda t: t.to(torch.bfloat16) if t.is_floating_point() else t)(torch.as_tensor(a))

    def _A_setup():
        B, S, Dm = (1, 2048, 640)
        H, Dh = (32, 128)
        M, seg = (8, 32)
        seg = min(seg, S)
        S = S // seg * seg
        return {'x': _w((lambda *s: torch.randn(*s, dtype=torch.bfloat16) * 0.05)(B, S, Dm)), 'mem0': _w((lambda *s: torch.randn(*s, dtype=torch.bfloat16) * 0.8)(B, M, Dm)), 'Wq': _w((lambda *s: torch.randn(*s, dtype=torch.bfloat16) * 1.6)(Dm, H, Dh) * Dm ** (-0.5)), 'Wk': _w((lambda *s: torch.randn(*s, dtype=torch.bfloat16) * 1.6)(Dm, H, Dh) * Dm ** (-0.5)), 'Wv': _w((lambda *s: torch.randn(*s, dtype=torch.bfloat16) * 0.8)(Dm, H, Dh) * Dm ** (-0.5)), 'Wo': _w((lambda *s: torch.randn(*s, dtype=torch.bfloat16) * 0.8)(H, Dh, Dm) * (H * Dh) ** (-0.5)), 'seg_len': seg}
    _A_in = _A_setup()

    def _B_setup():
        B, S, D, H = (1, 2048, 640, 32)
        return {'x': _w((lambda *s: torch.randn(*s, dtype=torch.bfloat16) * 0.2)(B, S, D)), 'wqkv': _w((lambda *s: torch.randn(*s, dtype=torch.bfloat16) * 0.2)(D, 3 * D)), 'wo': _w((lambda *s: torch.randn(*s, dtype=torch.bfloat16) * 0.05)(D, D))}
    _B_in = _B_setup()
    return {'A_x': _A_in['x'], 'A_mem0': _A_in['mem0'], 'A_Wq': _A_in['Wq'], 'A_Wk': _A_in['Wk'], 'A_Wv': _A_in['Wv'], 'A_Wo': _A_in['Wo'], 'A_seg_len': _A_in['seg_len'], 'B_x': _B_in['x'], 'B_wqkv': _B_in['wqkv'], 'B_wo': _B_in['wo']}

def reference(A_x, A_mem0, A_Wq, A_Wk, A_Wv, A_Wo, A_seg_len, B_x, B_wqkv, B_wo):

    def _A_ref(x, mem0, Wq, Wk, Wv, Wo, seg_len):
        B, S, Dm = x.shape
        H, Dh = (Wq.shape[1], Wq.shape[2])
        M = mem0.shape[1]
        scale = Dh ** (-0.5)
        n_seg = S // seg_len
        L = M + seg_len
        idx = torch.arange(L)
        mask = (idx[:, None] < M) | (idx[:, None] >= idx[None, :])
        mem = mem0
        outs = []
        for s in range(n_seg):
            xs = x[:, s * seg_len:(s + 1) * seg_len, :].clone()
            h = torch.concatenate([mem, xs], axis=1)
            q = torch.einsum('btd,dhe->bhte', h, Wq)
            k = torch.einsum('btd,dhe->bhte', h, Wk)
            v = torch.einsum('btd,dhe->bhte', h, Wv)
            scores = torch.einsum('bhqe,bhke->bhqk', q, k) * scale
            scores = torch.where(mask[None, None], scores, -1000000000.0)
            p = _softmax(scores, axis=-1)
            o = torch.einsum('bhqk,bhke->bhqe', p, v)
            o = torch.einsum('bhte,hed->btd', o, Wo)
            mem = o[:, :M, :].clone()
            outs.append(o[:, M:, :])
        return torch.concatenate(outs, axis=1)

    def _B_ref(x, wqkv, wo):
        B, S, D = x.shape
        H = 32
        Dh = D // H
        qkv = (lambda x, *d: x.permute(*d))((x @ wqkv).reshape(B, S, 3, H, Dh), 2, 0, 3, 1, 4)
        q, k, v = (qkv[0], qkv[1], qkv[2])
        scores = torch.einsum('bhqd,bhkd->bhqk', q, k) * Dh ** (-0.5)
        p = _softmax(scores, axis=-1)
        o = torch.einsum('bhqk,bhkd->bhqd', p, v)
        return (lambda x, *d: x.permute(*d))(o, 0, 2, 1, 3).reshape(B, S, D) @ wo
    a = _A_ref(A_x, A_mem0, A_Wq, A_Wk, A_Wv, A_Wo, A_seg_len)
    b = _B_ref(B_x, B_wqkv, B_wo)
    return torch.concatenate([a, b], axis=-1)
```

```asm
; @launch grid=(256,1,1) block=(256,1,1) lds=163840
.amdgcn_target "amdgcn-amd-amdhsa--gfx950"
.text
.globl concat_heads__memory_aug_recurrent_mem_tr__mha_block__prompt_kernel
.p2align 8
.type concat_heads__memory_aug_recurrent_mem_tr__mha_block__prompt_kernel,@function
concat_heads__memory_aug_recurrent_mem_tr__mha_block__prompt_kernel:
    s_cmp_ge_u32 s2, 256
    s_cbranch_scc1 M_end
    v_lshrrev_b32 v1, 6, v0
    s_load_dwordx2 s[60:61], s[0:1], 88
    s_getreg_b32 s5, hwreg(HW_REG_XCC_ID)
    v_readfirstlane_b32 s4, v1
    s_and_b32 s5, s5, 7
    s_waitcnt lgkmcnt(0)
    v_cmp_eq_u32 vcc, 0, v0
    s_and_saveexec_b64 s[44:45], vcc
    s_cbranch_execz M_tk
    s_lshl_b32 s46, s5, 2
    v_mov_b32 v2, s46
    v_mov_b32 v3, 1
    global_atomic_add v4, v2, v3, s[60:61] sc0
    s_waitcnt vmcnt(0)
    v_mov_b32 v5, 0
    ds_write_b32 v5, v4
    s_waitcnt lgkmcnt(0)
M_tk:
    s_mov_b64 exec, s[44:45]
    s_barrier
    v_mov_b32 v5, 0
    ds_read_b32 v4, v5
    s_waitcnt lgkmcnt(0)
    v_readfirstlane_b32 s6, v4
    s_barrier
    s_cmp_ge_u32 s6, 32
    s_cbranch_scc1 M_end
    s_mov_b32 s97, 0
    s_cmp_lt_u32 s5, 2
    s_cbranch_scc1 M_chain
    s_mov_b32 s96, s5
    s_mov_b32 s95, s6
    s_sub_u32 s44, s5, 2
    s_lshl_b32 s44, s44, 5
    s_add_u32 s44, s44, s6
    s_mul_hi_u32 s45, s44, 0x2AAAAAAB
    s_mul_i32 s46, s45, 6
    s_sub_u32 s46, s44, s46
    s_cmp_lt_u32 s46, 2
    s_cbranch_scc1 M_noinit
    s_lshl_b32 s47, s45, 2
    s_add_u32 s47, s47, s46
    s_sub_u32 s47, s47, 2
    s_mov_b32 s93, s47
    s_cmp_ge_u32 s47, 8
    s_cbranch_scc1 FI_1_d
    s_load_dwordx2 s[8:9], s[0:1], 96
    s_waitcnt lgkmcnt(0)
    s_mov_b32 s10, 0x10000000
    s_mov_b32 s11, 0x20000
    v_lshlrev_b32 v2, 4, v0
    v_mov_b64 v[8:9], 0
    v_mov_b64 v[10:11], 0
    s_lshl_b32 s48, s47, 12
    s_add_u32 s48, s48, 100663296
    buffer_store_dwordx4 v[8:11], v2, s[8:11], s48 offen sc1
    s_waitcnt vmcnt(0)
    s_barrier
    s_cmp_lg_u32 s4, 0
    s_cbranch_scc1 FI_1_d
    s_load_dwordx2 s[48:49], s[0:1], 88
    v_mov_b32 v2, 76
    v_mov_b32 v3, 1
    v_cmp_eq_u32 vcc, 0, v0
    s_waitcnt lgkmcnt(0)
    s_and_saveexec_b64 s[50:51], vcc
    global_atomic_add v2, v3, s[48:49]
    s_mov_b64 exec, -1
FI_1_d:
    s_cmp_lg_u32 s93, 9
    s_cbranch_scc1 M_nopr
    s_cmp_lg_u32 s4, 0
    s_cbranch_scc1 PR_2_done
    s_load_dwordx2 s[8:9], s[0:1], 96
    s_waitcnt lgkmcnt(0)
    s_mov_b32 s10, 0x10000000
    s_mov_b32 s11, 0x20000
    s_load_dwordx2 s[60:61], s[0:1], 88
    s_add_u32 s44, s8, 92274688
    s_and_b32 s44, s44, 0x1fffff
    s_sub_u32 s44, 0x200000, s44
    s_and_b32 s44, s44, 0x1fffff
    s_add_u32 s33, s44, 92274688
    s_mov_b32 s50, -1
    s_mov_b32 s51, -1
    v_and_b32 v40, 15, v0
    v_lshlrev_b32 v40, 13, v40
    s_waitcnt lgkmcnt(0)
    s_add_u32 s47, s33, 6144
    buffer_store_dword v40, v40, s[8:11], s47 offen sc1
    s_waitcnt vmcnt(0)
    v_mov_b32 v40, 0
    s_mov_b32 s46, 0
PR_2_l:
    s_lshl_b32 s47, s46, 14
    s_add_u32 s47, s47, s33
    s_add_u32 s47, s47, 6144
    s_memtime s[62:63]
    s_waitcnt lgkmcnt(0)
    buffer_load_dword v41, v40, s[8:11], s47 offen sc1
    s_waitcnt vmcnt(0)
    s_memtime s[64:65]
    s_waitcnt lgkmcnt(0)
    s_sub_u32 s48, s64, s62
    s_min_u32 s50, s50, s48
    s_lshl_b32 s47, s46, 14
    s_add_u32 s47, s47, s33
    s_add_u32 s47, s47, 14336
    s_memtime s[62:63]
    s_waitcnt lgkmcnt(0)
    buffer_load_dword v41, v40, s[8:11], s47 offen sc1
    s_waitcnt vmcnt(0)
    s_memtime s[64:65]
    s_waitcnt lgkmcnt(0)
    s_sub_u32 s48, s64, s62
    s_min_u32 s51, s51, s48
    s_add_u32 s46, s46, 1
    s_cmp_lt_u32 s46, 8
    s_cbranch_scc1 PR_2_l
    s_cmp_lt_u32 s51, s50
    s_cselect_b32 s47, 2, 1
    v_mov_b32 v41, s47
    v_mov_b32 v40, 68
    v_cmp_eq_u32 vcc, 0, v0
    s_and_saveexec_b64 s[44:45], vcc
    global_store_dword v40, v41, s[60:61] sc1
    s_mov_b64 exec, -1
PR_2_done:
M_nopr:
    s_sub_u32 s44, s5, 2
    s_lshl_b32 s44, s44, 5
    s_add_u32 s44, s44, s6
    s_mul_hi_u32 s45, s44, 0x2AAAAAAB
    s_mul_i32 s46, s45, 6
    s_sub_u32 s46, s44, s46
    s_cmp_lt_u32 s45, 16
    s_cselect_b32 s47, 24, 32
    s_load_dwordx2 s[12:13], s[0:1], s47
    s_load_dwordx2 s[16:17], s[0:1], 0
    v_and_b32 v1, 63, v0
    v_lshrrev_b32 v2, 5, v1
    v_lshlrev_b32 v2, 13, v2
    v_and_b32 v3, 31, v1
    v_lshl_add_u32 v2, v3, 4, v2
    v_lshlrev_b32 v3, 4, v1
    s_and_b32 s47, s45, 15
    s_lshl_b32 s47, s47, 9
    s_sub_u32 s48, s46, 2
    s_mul_i32 s48, s48, 160
    s_mul_i32 s49, s4, 40
    s_add_u32 s48, s48, s49
    s_lshl_b32 s48, s48, 13
    s_add_u32 s47, s47, s48
    s_lshl_b32 s49, s4, 10
    s_add_u32 s49, s49, 131072
    s_mov_b32 m0, s49
    s_waitcnt lgkmcnt(0)
    s_mov_b32 s14, 5242880
    s_mov_b32 s15, 0x20000
    s_mov_b32 s18, 2621440
    s_mov_b32 s19, 0x20000
    buffer_load_dwordx4 v2, s[12:15], s47 offen lds
    s_add_u32 s47, s47, 16384
    buffer_load_dwordx4 v2, s[12:15], s47 offen lds
    s_add_u32 s47, s47, 16384
    buffer_load_dwordx4 v2, s[12:15], s47 offen lds
    s_add_u32 s47, s47, 16384
    buffer_load_dwordx4 v2, s[12:15], s47 offen lds
    s_add_u32 s47, s47, 16384
    buffer_load_dwordx4 v2, s[12:15], s47 offen lds
    s_add_u32 s47, s47, 16384
    buffer_load_dwordx4 v2, s[12:15], s47 offen lds
    s_add_u32 s47, s47, 16384
    buffer_load_dwordx4 v2, s[12:15], s47 offen lds
    s_add_u32 s47, s47, 16384
    buffer_load_dwordx4 v2, s[12:15], s47 offen lds
    s_add_u32 s47, s47, 16384
    buffer_load_dwordx4 v2, s[12:15], s47 offen lds
    s_add_u32 s47, s47, 16384
    buffer_load_dwordx4 v2, s[12:15], s47 offen lds
    s_add_u32 s47, s47, 16384
    buffer_load_dwordx4 v2, s[12:15], s47 offen lds
    s_add_u32 s47, s47, 16384
    buffer_load_dwordx4 v2, s[12:15], s47 offen lds
    s_add_u32 s47, s47, 16384
    buffer_load_dwordx4 v2, s[12:15], s47 offen lds
    s_add_u32 s47, s47, 16384
    buffer_load_dwordx4 v2, s[12:15], s47 offen lds
    s_add_u32 s47, s47, 16384
    buffer_load_dwordx4 v2, s[12:15], s47 offen lds
    s_add_u32 s47, s47, 16384
    buffer_load_dwordx4 v2, s[12:15], s47 offen lds
    s_add_u32 s47, s47, 16384
    buffer_load_dwordx4 v2, s[12:15], s47 offen lds
    s_add_u32 s47, s47, 16384
    buffer_load_dwordx4 v2, s[12:15], s47 offen lds
    s_add_u32 s47, s47, 16384
    buffer_load_dwordx4 v2, s[12:15], s47 offen lds
    s_add_u32 s47, s47, 16384
    buffer_load_dwordx4 v2, s[12:15], s47 offen lds
    s_add_u32 s47, s47, 16384
    s_and_b32 s48, s44, 15
    s_mul_i32 s48, s48, 20480
    s_mul_i32 s47, s4, 5120
    s_add_u32 s48, s48, s47
    buffer_load_dwordx4 v3, s[16:19], s48 offen lds
    s_add_u32 s48, s48, 1024
    buffer_load_dwordx4 v3, s[16:19], s48 offen lds
    s_add_u32 s48, s48, 1024
    buffer_load_dwordx4 v3, s[16:19], s48 offen lds
    s_add_u32 s48, s48, 1024
    buffer_load_dwordx4 v3, s[16:19], s48 offen lds
    s_add_u32 s48, s48, 1024
    buffer_load_dwordx4 v3, s[16:19], s48 offen lds
    s_add_u32 s48, s48, 1024
    s_mov_b32 s44, s93
    s_load_dwordx2 s[8:9], s[0:1], 96
    s_waitcnt lgkmcnt(0)
    s_mov_b32 s10, 0x10000000
    s_mov_b32 s11, 0x20000
    v_lshlrev_b32 v2, 4, v0
    v_mov_b64 v[4:5], -1
    v_mov_b64 v[6:7], -1
    s_mov_b32 s45, s44
IN_3_l:
    s_lshl_b32 s46, s45, 12
    s_add_u32 s46, s46, 67108864
    buffer_store_dwordx4 v[4:7], v2, s[8:11], s46 offen sc1
    s_add_u32 s45, s45, 128
    s_cmp_lt_u32 s45, 2048
    s_cbranch_scc1 IN_3_l
    s_waitcnt vmcnt(0)
    s_barrier
    s_cmp_lg_u32 s4, 0
    s_cbranch_scc1 IN_3_d
    s_load_dwordx2 s[46:47], s[0:1], 88
    v_mov_b32 v2, 72
    v_mov_b32 v3, 1
    v_cmp_eq_u32 vcc, 0, v0
    s_waitcnt lgkmcnt(0)
    s_and_saveexec_b64 s[44:45], vcc
    global_atomic_add v2, v3, s[46:47]
    s_mov_b64 exec, s[44:45]
IN_3_d:
M_noinit:
    s_mov_b32 s98, 100000
    s_cmp_ge_u32 s96, 4
    s_cbranch_scc1 M_go
    s_cmp_ge_u32 s95, 28
    s_cbranch_scc1 M_go
    s_mov_b32 s98, 1
M_go:
    s_sub_u32 s44, s96, 2
    s_lshl_b32 s44, s44, 5
    s_add_u32 s44, s44, s95
    s_mul_hi_u32 s7, s44, 0x2AAAAAAB
    s_mul_i32 s45, s7, 6
    s_sub_u32 s45, s44, s45
    s_sub_u32 s98, s98, 1
    s_cmp_ge_u32 s45, 2
    s_cbranch_scc1 M_f2
    s_mov_b32 s6, s45
    s_lshl_b32 s44, s7, 2
    s_add_u32 s99, s44, 100663296
    s_cmp_eq_u32 s6, 1
    s_cbranch_scc0 M_ah
    s_add_u32 s99, s44, 100665344
    s_branch M_ah
M_f2:
    s_sub_u32 s6, s45, 1
    s_branch M_ap
M_gl:
    s_cmp_eq_u32 s98, 0
    s_cbranch_scc1 M_gdone
    s_sub_u32 s98, s98, 1
    s_barrier
    s_cmp_lg_u32 s4, 0
    s_cbranch_scc1 M_g1
    s_load_dwordx2 s[46:47], s[0:1], 88
    v_mov_b32 v2, 80
    v_mov_b32 v3, 1
    v_cmp_eq_u32 vcc, 0, v0
    s_waitcnt lgkmcnt(0)
    s_and_saveexec_b64 s[44:45], vcc
    global_atomic_add v4, v2, v3, s[46:47] sc0
    s_waitcnt vmcnt(0)
    v_mov_b32 v5, 163000
    ds_write_b32 v5, v4
    s_waitcnt lgkmcnt(0)
    s_mov_b64 exec, s[44:45]
M_g1:
    s_barrier
    v_mov_b32 v5, 163000
    ds_read_b32 v4, v5
    s_waitcnt lgkmcnt(0)
    v_readfirstlane_b32 s5, v4
    s_barrier
    s_cmp_ge_u32 s5, 608
    s_cbranch_scc1 M_gdone
    s_cmp_ge_u32 s5, 576
    s_cbranch_scc1 M_bo
    s_cmp_ge_u32 s5, 320
    s_cbranch_scc1 M_ba
    s_cmp_ge_u32 s5, 176
    s_cbranch_scc1 M_ap3
    s_cmp_ge_u32 s5, 112
    s_cbranch_scc1 M_ap2
    s_cmp_ge_u32 s5, 16
    s_cbranch_scc1 M_bq
    s_mov_b32 s6, 0
    s_add_u32 s7, s5, 32
    s_branch M_ap
M_ap2:
    s_sub_u32 s5, s5, 112
    s_lshr_b32 s6, s5, 4
    s_add_u32 s6, s6, 1
    s_and_b32 s7, s5, 15
    s_add_u32 s7, s7, 32
    s_branch M_ap
M_ap3:
    s_sub_u32 s5, s5, 176
    s_mul_hi_u32 s6, s5, 0x5555556
    s_mul_i32 s7, s6, 48
    s_sub_u32 s7, s5, s7
    s_add_u32 s6, s6, 5
    s_branch M_ap
M_ah:
    s_lshr_b32 s27, s7, 4
    s_and_b32 s7, s7, 15
    s_load_dwordx2 s[8:9], s[0:1], 0
    s_load_dwordx2 s[20:21], s[0:1], 96
    s_cmp_eq_u32 s27, 0
    s_cselect_b32 s28, 24, 32
    s_load_dwordx2 s[12:13], s[0:1], s28
    s_mov_b32 s24, 16777216
    s_cmp_eq_u32 s27, 1
    s_cselect_b32 s24, 33554432, s24
    s_mul_i32 s16, s6, 163840
    s_lshl_b32 s17, s7, 9
    s_mov_b32 s18, 8192
    s_lshl_b32 s29, s6, 20
    s_add_u32 s24, s24, s29
    s_lshl_b32 s29, s7, 14
    s_add_u32 s24, s24, s29
    s_waitcnt lgkmcnt(0)
    s_mov_b32 s10, 2621440
    s_mov_b32 s11, 0x20000
    s_mov_b32 s14, 5242880
    s_mov_b32 s15, 0x20000
    s_mov_b32 s22, 0x10000000
    s_mov_b32 s23, 0x20000
    v_and_b32 v1, 63, v0
    v_lshrrev_b32 v20, 2, v1
    v_and_b32 v21, 3, v1
    v_lshrrev_b32 v22, 4, v1
    v_xor_b32 v23, v21, v22
    v_mul_u32_u24 v24, 1280, v20
    v_lshl_add_u32 v2, v23, 4, v24
    v_add_u32 v20, 0, v1
    v_lshrrev_b32 v21, 5, v20
    v_and_b32 v22, 31, v20
    v_and_b32 v23, 3, v21
    v_lshlrev_b32 v23, 2, v23
    v_xor_b32 v22, v22, v23
    v_mul_lo_u32 v21, v21, s18
    v_lshl_add_u32 v4, v22, 4, v21
    v_add_u32 v20, 64, v1
    v_lshrrev_b32 v21, 5, v20
    v_and_b32 v22, 31, v20
    v_and_b32 v23, 3, v21
    v_lshlrev_b32 v23, 2, v23
    v_xor_b32 v22, v22, v23
    v_mul_lo_u32 v21, v21, s18
    v_lshl_add_u32 v5, v22, 4, v21
    v_add_u32 v20, 128, v1
    v_lshrrev_b32 v21, 5, v20
    v_and_b32 v22, 31, v20
    v_and_b32 v23, 3, v21
    v_lshlrev_b32 v23, 2, v23
    v_xor_b32 v22, v22, v23
    v_mul_lo_u32 v21, v21, s18
    v_lshl_add_u32 v6, v22, 4, v21
    v_add_u32 v20, 192, v1
    v_lshrrev_b32 v21, 5, v20
    v_and_b32 v22, 31, v20
    v_and_b32 v23, 3, v21
    v_lshlrev_b32 v23, 2, v23
    v_xor_b32 v22, v22, v23
    v_mul_lo_u32 v21, v21, s18
    v_lshl_add_u32 v7, v22, 4, v21
    s_and_b32 s30, s4, 1
    s_mul_i32 s30, s30, 4096
    v_and_b32 v20, 31, v1
    v_lshrrev_b32 v21, 5, v1
    v_bfe_u32 v22, v20, 2, 2
    v_lshlrev_b32 v20, 6, v20
    v_add_u32 v20, s30, v20
    v_add_u32 v23, 0, v21
    v_xor_b32 v23, v23, v22
    v_lshl_add_u32 v10, v23, 4, v20
    v_add_u32 v11, 0x10000, v10
    v_add_u32 v23, 2, v21
    v_xor_b32 v23, v23, v22
    v_lshl_add_u32 v12, v23, 4, v20
    v_add_u32 v13, 0x10000, v12
    s_lshr_b32 s31, s4, 1
    s_mul_i32 s31, s31, 16
    v_bfe_u32 v20, v1, 2, 2
    v_and_b32 v21, 3, v1
    v_bfe_u32 v22, v1, 4, 1
    v_lshrrev_b32 v23, 5, v1
    v_lshl_add_u32 v24, v23, 3, v20
    v_mul_u32_u24 v24, 512, v24
    v_add_u32 v24, 8192, v24
    v_and_b32 v25, 1, v21
    v_lshl_add_u32 v24, v25, 3, v24
    v_lshrrev_b32 v25, 1, v21
    v_lshl_add_u32 v25, v22, 1, v25
    v_add_u32 v25, s31, v25
    v_lshlrev_b32 v26, 2, v20
    v_add_u32 v27, 0, v25
    v_xor_b32 v27, v27, v26
    v_lshl_add_u32 v14, v27, 4, v24
    v_add_u32 v15, 0x10000, v14
    v_add_u32 v27, 4, v25
    v_xor_b32 v27, v27, v26
    v_lshl_add_u32 v16, v27, 4, v24
    v_add_u32 v17, 0x10000, v16
    v_add_u32 v27, 8, v25
    v_xor_b32 v27, v27, v26
    v_lshl_add_u32 v18, v27, 4, v24
    v_add_u32 v19, 0x10000, v18
    v_add_u32 v27, 12, v25
    v_xor_b32 v27, v27, v26
    v_lshl_add_u32 v20, v27, 4, v24
    v_add_u32 v21, 0x10000, v20
    s_cmp_eq_u32 s27, 1
    s_cbranch_scc1 AH_4_v
    s_mul_i32 s33, s4, 40960
    s_add_u32 s33, s33, s16
    s_lshl_b32 s37, s18, 3
    s_mul_i32 s34, s4, s37
    s_add_u32 s34, s34, s17
    s_mul_i32 s39, s4, 2048
    s_mul_i32 s40, s4, 4096
    s_add_u32 s40, s40, 8192
    s_lshl_b32 s41, s18, 5
    s_add_u32 m0, s39, 0
    s_add_u32 s38, s33, 0
    buffer_load_dwordx4 v2, s[8:11], s38 offen  lds
    s_add_u32 m0, s39, 1024
    s_add_u32 s38, s33, 20480
    buffer_load_dwordx4 v2, s[8:11], s38 offen  lds
    s_add_u32 m0, s40, 0
    buffer_load_dwordx4 v4, s[12:15], s34 offen lds
    s_add_u32 m0, s40, 1024
    buffer_load_dwordx4 v5, s[12:15], s34 offen lds
    s_add_u32 m0, s40, 2048
    buffer_load_dwordx4 v6, s[12:15], s34 offen lds
    s_add_u32 m0, s40, 3072
    buffer_load_dwordx4 v7, s[12:15], s34 offen lds
    s_add_u32 s33, s33, 64
    s_add_u32 s34, s34, s41
    s_add_u32 m0, s39, 32768
    s_add_u32 s38, s33, 0
    buffer_load_dwordx4 v2, s[8:11], s38 offen  lds
    s_add_u32 m0, s39, 33792
    s_add_u32 s38, s33, 20480
    buffer_load_dwordx4 v2, s[8:11], s38 offen  lds
    s_add_u32 m0, s40, 32768
    buffer_load_dwordx4 v4, s[12:15], s34 offen lds
    s_add_u32 m0, s40, 33792
    buffer_load_dwordx4 v5, s[12:15], s34 offen lds
    s_add_u32 m0, s40, 34816
    buffer_load_dwordx4 v6, s[12:15], s34 offen lds
    s_add_u32 m0, s40, 35840
    buffer_load_dwordx4 v7, s[12:15], s34 offen lds
    s_add_u32 s33, s33, 64
    s_add_u32 s34, s34, s41
    s_add_u32 m0, s39, 65536
    s_add_u32 s38, s33, 0
    buffer_load_dwordx4 v2, s[8:11], s38 offen  lds
    s_add_u32 m0, s39, 66560
    s_add_u32 s38, s33, 20480
    buffer_load_dwordx4 v2, s[8:11], s38 offen  lds
    s_add_u32 m0, s40, 65536
    buffer_load_dwordx4 v4, s[12:15], s34 offen lds
    s_add_u32 m0, s40, 66560
    buffer_load_dwordx4 v5, s[12:15], s34 offen lds
    s_add_u32 m0, s40, 67584
    buffer_load_dwordx4 v6, s[12:15], s34 offen lds
    s_add_u32 m0, s40, 68608
    buffer_load_dwordx4 v7, s[12:15], s34 offen lds
    s_add_u32 s33, s33, 64
    s_add_u32 s34, s34, s41
    v_accvgpr_write_b32 a0, 0
    v_accvgpr_write_b32 a1, 0
    v_accvgpr_write_b32 a2, 0
    v_accvgpr_write_b32 a3, 0
    v_accvgpr_write_b32 a4, 0
    v_accvgpr_write_b32 a5, 0
    v_accvgpr_write_b32 a6, 0
    v_accvgpr_write_b32 a7, 0
    v_accvgpr_write_b32 a8, 0
    v_accvgpr_write_b32 a9, 0
    v_accvgpr_write_b32 a10, 0
    v_accvgpr_write_b32 a11, 0
    v_accvgpr_write_b32 a12, 0
    v_accvgpr_write_b32 a13, 0
    v_accvgpr_write_b32 a14, 0
    v_accvgpr_write_b32 a15, 0
    v_accvgpr_write_b32 a16, 0
    v_accvgpr_write_b32 a17, 0
    v_accvgpr_write_b32 a18, 0
    v_accvgpr_write_b32 a19, 0
    v_accvgpr_write_b32 a20, 0
    v_accvgpr_write_b32 a21, 0
    v_accvgpr_write_b32 a22, 0
    v_accvgpr_write_b32 a23, 0
    v_accvgpr_write_b32 a24, 0
    v_accvgpr_write_b32 a25, 0
    v_accvgpr_write_b32 a26, 0
    v_accvgpr_write_b32 a27, 0
    v_accvgpr_write_b32 a28, 0
    v_accvgpr_write_b32 a29, 0
    v_accvgpr_write_b32 a30, 0
    v_accvgpr_write_b32 a31, 0
    v_accvgpr_write_b32 a32, 0
    v_accvgpr_write_b32 a33, 0
    v_accvgpr_write_b32 a34, 0
    v_accvgpr_write_b32 a35, 0
    v_accvgpr_write_b32 a36, 0
    v_accvgpr_write_b32 a37, 0
    v_accvgpr_write_b32 a38, 0
    v_accvgpr_write_b32 a39, 0
    v_accvgpr_write_b32 a40, 0
    v_accvgpr_write_b32 a41, 0
    v_accvgpr_write_b32 a42, 0
    v_accvgpr_write_b32 a43, 0
    v_accvgpr_write_b32 a44, 0
    v_accvgpr_write_b32 a45, 0
    v_accvgpr_write_b32 a46, 0
    v_accvgpr_write_b32 a47, 0
    v_accvgpr_write_b32 a48, 0
    v_accvgpr_write_b32 a49, 0
    v_accvgpr_write_b32 a50, 0
    v_accvgpr_write_b32 a51, 0
    v_accvgpr_write_b32 a52, 0
    v_accvgpr_write_b32 a53, 0
    v_accvgpr_write_b32 a54, 0
    v_accvgpr_write_b32 a55, 0
    v_accvgpr_write_b32 a56, 0
    v_accvgpr_write_b32 a57, 0
    v_accvgpr_write_b32 a58, 0
    v_accvgpr_write_b32 a59, 0
    v_accvgpr_write_b32 a60, 0
    v_accvgpr_write_b32 a61, 0
    v_accvgpr_write_b32 a62, 0
    v_accvgpr_write_b32 a63, 0
    v_accvgpr_write_b32 a64, 0
    v_accvgpr_write_b32 a65, 0
    v_accvgpr_write_b32 a66, 0
    v_accvgpr_write_b32 a67, 0
    v_accvgpr_write_b32 a68, 0
    v_accvgpr_write_b32 a69, 0
    v_accvgpr_write_b32 a70, 0
    v_accvgpr_write_b32 a71, 0
    v_accvgpr_write_b32 a72, 0
    v_accvgpr_write_b32 a73, 0
    v_accvgpr_write_b32 a74, 0
    v_accvgpr_write_b32 a75, 0
    v_accvgpr_write_b32 a76, 0
    v_accvgpr_write_b32 a77, 0
    v_accvgpr_write_b32 a78, 0
    v_accvgpr_write_b32 a79, 0
    v_accvgpr_write_b32 a80, 0
    v_accvgpr_write_b32 a81, 0
    v_accvgpr_write_b32 a82, 0
    v_accvgpr_write_b32 a83, 0
    v_accvgpr_write_b32 a84, 0
    v_accvgpr_write_b32 a85, 0
    v_accvgpr_write_b32 a86, 0
    v_accvgpr_write_b32 a87, 0
    v_accvgpr_write_b32 a88, 0
    v_accvgpr_write_b32 a89, 0
    v_accvgpr_write_b32 a90, 0
    v_accvgpr_write_b32 a91, 0
    v_accvgpr_write_b32 a92, 0
    v_accvgpr_write_b32 a93, 0
    v_accvgpr_write_b32 a94, 0
    v_accvgpr_write_b32 a95, 0
    v_accvgpr_write_b32 a96, 0
    v_accvgpr_write_b32 a97, 0
    v_accvgpr_write_b32 a98, 0
    v_accvgpr_write_b32 a99, 0
    v_accvgpr_write_b32 a100, 0
    v_accvgpr_write_b32 a101, 0
    v_accvgpr_write_b32 a102, 0
    v_accvgpr_write_b32 a103, 0
    v_accvgpr_write_b32 a104, 0
    v_accvgpr_write_b32 a105, 0
    v_accvgpr_write_b32 a106, 0
    v_accvgpr_write_b32 a107, 0
    v_accvgpr_write_b32 a108, 0
    v_accvgpr_write_b32 a109, 0
    v_accvgpr_write_b32 a110, 0
    v_accvgpr_write_b32 a111, 0
    v_accvgpr_write_b32 a112, 0
    v_accvgpr_write_b32 a113, 0
    v_accvgpr_write_b32 a114, 0
    v_accvgpr_write_b32 a115, 0
    v_accvgpr_write_b32 a116, 0
    v_accvgpr_write_b32 a117, 0
    v_accvgpr_write_b32 a118, 0
    v_accvgpr_write_b32 a119, 0
    v_accvgpr_write_b32 a120, 0
    v_accvgpr_write_b32 a121, 0
    v_accvgpr_write_b32 a122, 0
    v_accvgpr_write_b32 a123, 0
    v_accvgpr_write_b32 a124, 0
    v_accvgpr_write_b32 a125, 0
    v_accvgpr_write_b32 a126, 0
    v_accvgpr_write_b32 a127, 0
    s_waitcnt vmcnt(12)
    s_barrier
    ds_read_b128 v[32:35], v10 offset:0
    ds_read_b128 v[36:39], v10 offset:2048
    ds_read_b64_tr_b16 v[48:49], v14 offset:0
    ds_read_b64_tr_b16 v[50:51], v14 offset:2048
    ds_read_b64_tr_b16 v[52:53], v16 offset:0
    ds_read_b64_tr_b16 v[54:55], v16 offset:2048
    ds_read_b64_tr_b16 v[56:57], v18 offset:0
    ds_read_b64_tr_b16 v[58:59], v18 offset:2048
    ds_read_b64_tr_b16 v[60:61], v20 offset:0
    ds_read_b64_tr_b16 v[62:63], v20 offset:2048
    s_mov_b32 s42, 0
G_5_loop:
    s_waitcnt lgkmcnt(0)
    v_mfma_f32_32x32x16_bf16 a[0:15], v[48:51], v[32:35], a[0:15]
    ds_read_b128 v[68:71], v12 offset:0
    v_mfma_f32_32x32x16_bf16 a[16:31], v[52:55], v[32:35], a[16:31]
    s_add_u32 m0, s39, 98304
    s_add_u32 s38, s33, 0
    buffer_load_dwordx4 v2, s[8:11], s38 offen  lds
    ds_read_b128 v[72:75], v12 offset:2048
    v_mfma_f32_32x32x16_bf16 a[32:47], v[56:59], v[32:35], a[32:47]
    ds_read_b64_tr_b16 v[84:85], v14 offset:8192
    v_mfma_f32_32x32x16_bf16 a[48:63], v[60:63], v[32:35], a[48:63]
    ds_read_b64_tr_b16 v[86:87], v14 offset:10240
    s_add_u32 m0, s39, 99328
    s_add_u32 s38, s33, 20480
    buffer_load_dwordx4 v2, s[8:11], s38 offen  lds
    v_mfma_f32_32x32x16_bf16 a[64:79], v[48:51], v[36:39], a[64:79]
    ds_read_b64_tr_b16 v[88:89], v16 offset:8192
    ds_read_b64_tr_b16 v[90:91], v16 offset:10240
    v_mfma_f32_32x32x16_bf16 a[80:95], v[52:55], v[36:39], a[80:95]
    ds_read_b64_tr_b16 v[92:93], v18 offset:8192
    v_mfma_f32_32x32x16_bf16 a[96:111], v[56:59], v[36:39], a[96:111]
    s_add_u32 m0, s40, 98304
    buffer_load_dwordx4 v4, s[12:15], s34 offen lds
    ds_read_b64_tr_b16 v[94:95], v18 offset:10240
    v_mfma_f32_32x32x16_bf16 a[112:127], v[60:63], v[36:39], a[112:127]
    ds_read_b64_tr_b16 v[96:97], v20 offset:8192
    ds_read_b64_tr_b16 v[98:99], v20 offset:10240
    s_waitcnt lgkmcnt(0)
    v_mfma_f32_32x32x16_bf16 a[0:15], v[84:87], v[68:71], a[0:15]
    v_mfma_f32_32x32x16_bf16 a[16:31], v[88:91], v[68:71], a[16:31]
    v_mfma_f32_32x32x16_bf16 a[32:47], v[92:95], v[68:71], a[32:47]
    s_waitcnt vmcnt(9)
    s_barrier
    v_mfma_f32_32x32x16_bf16 a[48:63], v[96:99], v[68:71], a[48:63]
    ds_read_b128 v[32:35], v10 offset:32768
    s_add_u32 m0, s40, 99328
    buffer_load_dwordx4 v5, s[12:15], s34 offen lds
    v_mfma_f32_32x32x16_bf16 a[64:79], v[84:87], v[72:75], a[64:79]
    ds_read_b128 v[36:39], v10 offset:34816
    ds_read_b64_tr_b16 v[48:49], v14 offset:32768
    ds_read_b64_tr_b16 v[50:51], v14 offset:34816
    v_mfma_f32_32x32x16_bf16 a[80:95], v[88:91], v[72:75], a[80:95]
    s_add_u32 m0, s40, 100352
    buffer_load_dwordx4 v6, s[12:15], s34 offen lds
    ds_read_b64_tr_b16 v[52:53], v16 offset:32768
    v_mfma_f32_32x32x16_bf16 a[96:111], v[92:95], v[72:75], a[96:111]
    ds_read_b64_tr_b16 v[54:55], v16 offset:34816
    ds_read_b64_tr_b16 v[56:57], v18 offset:32768
    s_add_u32 m0, s40, 101376
    buffer_load_dwordx4 v7, s[12:15], s34 offen lds
    v_mfma_f32_32x32x16_bf16 a[112:127], v[96:99], v[72:75], a[112:127]
    ds_read_b64_tr_b16 v[58:59], v18 offset:34816
    ds_read_b64_tr_b16 v[60:61], v20 offset:32768
    ds_read_b64_tr_b16 v[62:63], v20 offset:34816
    s_add_u32 s33, s33, 64
    s_add_u32 s34, s34, s41
    s_cmp_eq_u32 s42, 4
    s_cselect_b32 s10, 0, s10
    s_cselect_b32 s14, 0, s14
    s_waitcnt lgkmcnt(0)
    v_mfma_f32_32x32x16_bf16 a[0:15], v[48:51], v[32:35], a[0:15]
    ds_read_b128 v[68:71], v12 offset:32768
    v_mfma_f32_32x32x16_bf16 a[16:31], v[52:55], v[32:35], a[16:31]
    s_add_u32 m0, s39, 0
    s_add_u32 s38, s33, 0
    buffer_load_dwordx4 v2, s[8:11], s38 offen  lds
    ds_read_b128 v[72:75], v12 offset:34816
    v_mfma_f32_32x32x16_bf16 a[32:47], v[56:59], v[32:35], a[32:47]
    ds_read_b64_tr_b16 v[84:85], v14 offset:40960
    v_mfma_f32_32x32x16_bf16 a[48:63], v[60:63], v[32:35], a[48:63]
    ds_read_b64_tr_b16 v[86:87], v14 offset:43008
    s_add_u32 m0, s39, 1024
    s_add_u32 s38, s33, 20480
    buffer_load_dwordx4 v2, s[8:11], s38 offen  lds
    v_mfma_f32_32x32x16_bf16 a[64:79], v[48:51], v[36:39], a[64:79]
    ds_read_b64_tr_b16 v[88:89], v16 offset:40960
    ds_read_b64_tr_b16 v[90:91], v16 offset:43008
    v_mfma_f32_32x32x16_bf16 a[80:95], v[52:55], v[36:39], a[80:95]
    ds_read_b64_tr_b16 v[92:93], v18 offset:40960
    v_mfma_f32_32x32x16_bf16 a[96:111], v[56:59], v[36:39], a[96:111]
    s_add_u32 m0, s40, 0
    buffer_load_dwordx4 v4, s[12:15], s34 offen lds
    ds_read_b64_tr_b16 v[94:95], v18 offset:43008
    v_mfma_f32_32x32x16_bf16 a[112:127], v[60:63], v[36:39], a[112:127]
    ds_read_b64_tr_b16 v[96:97], v20 offset:40960
    ds_read_b64_tr_b16 v[98:99], v20 offset:43008
    s_waitcnt lgkmcnt(0)
    v_mfma_f32_32x32x16_bf16 a[0:15], v[84:87], v[68:71], a[0:15]
    v_mfma_f32_32x32x16_bf16 a[16:31], v[88:91], v[68:71], a[16:31]
    v_mfma_f32_32x32x16_bf16 a[32:47], v[92:95], v[68:71], a[32:47]
    s_waitcnt vmcnt(9)
    s_barrier
    v_mfma_f32_32x32x16_bf16 a[48:63], v[96:99], v[68:71], a[48:63]
    ds_read_b128 v[32:35], v11 offset:0
    s_add_u32 m0, s40, 1024
    buffer_load_dwordx4 v5, s[12:15], s34 offen lds
    v_mfma_f32_32x32x16_bf16 a[64:79], v[84:87], v[72:75], a[64:79]
    ds_read_b128 v[36:39], v11 offset:2048
    ds_read_b64_tr_b16 v[48:49], v15 offset:0
    ds_read_b64_tr_b16 v[50:51], v15 offset:2048
    v_mfma_f32_32x32x16_bf16 a[80:95], v[88:91], v[72:75], a[80:95]
    s_add_u32 m0, s40, 2048
    buffer_load_dwordx4 v6, s[12:15], s34 offen lds
    ds_read_b64_tr_b16 v[52:53], v17 offset:0
    v_mfma_f32_32x32x16_bf16 a[96:111], v[92:95], v[72:75], a[96:111]
    ds_read_b64_tr_b16 v[54:55], v17 offset:2048
    ds_read_b64_tr_b16 v[56:57], v19 offset:0
    s_add_u32 m0, s40, 3072
    buffer_load_dwordx4 v7, s[12:15], s34 offen lds
    v_mfma_f32_32x32x16_bf16 a[112:127], v[96:99], v[72:75], a[112:127]
    ds_read_b64_tr_b16 v[58:59], v19 offset:2048
    ds_read_b64_tr_b16 v[60:61], v21 offset:0
    ds_read_b64_tr_b16 v[62:63], v21 offset:2048
    s_add_u32 s33, s33, 64
    s_add_u32 s34, s34, s41
    s_waitcnt lgkmcnt(0)
    v_mfma_f32_32x32x16_bf16 a[0:15], v[48:51], v[32:35], a[0:15]
    ds_read_b128 v[68:71], v13 offset:0
    v_mfma_f32_32x32x16_bf16 a[16:31], v[52:55], v[32:35], a[16:31]
    s_add_u32 m0, s39, 32768
    s_add_u32 s38, s33, 0
    buffer_load_dwordx4 v2, s[8:11], s38 offen  lds
    ds_read_b128 v[72:75], v13 offset:2048
    v_mfma_f32_32x32x16_bf16 a[32:47], v[56:59], v[32:35], a[32:47]
    ds_read_b64_tr_b16 v[84:85], v15 offset:8192
    v_mfma_f32_32x32x16_bf16 a[48:63], v[60:63], v[32:35], a[48:63]
    ds_read_b64_tr_b16 v[86:87], v15 offset:10240
    s_add_u32 m0, s39, 33792
    s_add_u32 s38, s33, 20480
    buffer_load_dwordx4 v2, s[8:11], s38 offen  lds
    v_mfma_f32_32x32x16_bf16 a[64:79], v[48:51], v[36:39], a[64:79]
    ds_read_b64_tr_b16 v[88:89], v17 offset:8192
    ds_read_b64_tr_b16 v[90:91], v17 offset:10240
    v_mfma_f32_32x32x16_bf16 a[80:95], v[52:55], v[36:39], a[80:95]
    ds_read_b64_tr_b16 v[92:93], v19 offset:8192
    v_mfma_f32_32x32x16_bf16 a[96:111], v[56:59], v[36:39], a[96:111]
    s_add_u32 m0, s40, 32768
    buffer_load_dwordx4 v4, s[12:15], s34 offen lds
    ds_read_b64_tr_b16 v[94:95], v19 offset:10240
    v_mfma_f32_32x32x16_bf16 a[112:127], v[60:63], v[36:39], a[112:127]
    ds_read_b64_tr_b16 v[96:97], v21 offset:8192
    ds_read_b64_tr_b16 v[98:99], v21 offset:10240
    s_waitcnt lgkmcnt(0)
    v_mfma_f32_32x32x16_bf16 a[0:15], v[84:87], v[68:71], a[0:15]
    v_mfma_f32_32x32x16_bf16 a[16:31], v[88:91], v[68:71], a[16:31]
    v_mfma_f32_32x32x16_bf16 a[32:47], v[92:95], v[68:71], a[32:47]
    s_waitcnt vmcnt(9)
    s_barrier
    v_mfma_f32_32x32x16_bf16 a[48:63], v[96:99], v[68:71], a[48:63]
    ds_read_b128 v[32:35], v11 offset:32768
    s_add_u32 m0, s40, 33792
    buffer_load_dwordx4 v5, s[12:15], s34 offen lds
    v_mfma_f32_32x32x16_bf16 a[64:79], v[84:87], v[72:75], a[64:79]
    ds_read_b128 v[36:39], v11 offset:34816
    ds_read_b64_tr_b16 v[48:49], v15 offset:32768
    ds_read_b64_tr_b16 v[50:51], v15 offset:34816
    v_mfma_f32_32x32x16_bf16 a[80:95], v[88:91], v[72:75], a[80:95]
    s_add_u32 m0, s40, 34816
    buffer_load_dwordx4 v6, s[12:15], s34 offen lds
    ds_read_b64_tr_b16 v[52:53], v17 offset:32768
    v_mfma_f32_32x32x16_bf16 a[96:111], v[92:95], v[72:75], a[96:111]
    ds_read_b64_tr_b16 v[54:55], v17 offset:34816
    ds_read_b64_tr_b16 v[56:57], v19 offset:32768
    s_add_u32 m0, s40, 35840
    buffer_load_dwordx4 v7, s[12:15], s34 offen lds
    v_mfma_f32_32x32x16_bf16 a[112:127], v[96:99], v[72:75], a[112:127]
    ds_read_b64_tr_b16 v[58:59], v19 offset:34816
    ds_read_b64_tr_b16 v[60:61], v21 offset:32768
    ds_read_b64_tr_b16 v[62:63], v21 offset:34816
    s_add_u32 s33, s33, 64
    s_add_u32 s34, s34, s41
    s_waitcnt lgkmcnt(0)
    v_mfma_f32_32x32x16_bf16 a[0:15], v[48:51], v[32:35], a[0:15]
    ds_read_b128 v[68:71], v13 offset:32768
    v_mfma_f32_32x32x16_bf16 a[16:31], v[52:55], v[32:35], a[16:31]
    s_add_u32 m0, s39, 65536
    s_add_u32 s38, s33, 0
    buffer_load_dwordx4 v2, s[8:11], s38 offen  lds
    ds_read_b128 v[72:75], v13 offset:34816
    v_mfma_f32_32x32x16_bf16 a[32:47], v[56:59], v[32:35], a[32:47]
    ds_read_b64_tr_b16 v[84:85], v15 offset:40960
    v_mfma_f32_32x32x16_bf16 a[48:63], v[60:63], v[32:35], a[48:63]
    ds_read_b64_tr_b16 v[86:87], v15 offset:43008
    s_add_u32 m0, s39, 66560
    s_add_u32 s38, s33, 20480
    buffer_load_dwordx4 v2, s[8:11], s38 offen  lds
    v_mfma_f32_32x32x16_bf16 a[64:79], v[48:51], v[36:39], a[64:79]
    ds_read_b64_tr_b16 v[88:89], v17 offset:40960
    ds_read_b64_tr_b16 v[90:91], v17 offset:43008
    v_mfma_f32_32x32x16_bf16 a[80:95], v[52:55], v[36:39], a[80:95]
    ds_read_b64_tr_b16 v[92:93], v19 offset:40960
    v_mfma_f32_32x32x16_bf16 a[96:111], v[56:59], v[36:39], a[96:111]
    s_add_u32 m0, s40, 65536
    buffer_load_dwordx4 v4, s[12:15], s34 offen lds
    ds_read_b64_tr_b16 v[94:95], v19 offset:43008
    v_mfma_f32_32x32x16_bf16 a[112:127], v[60:63], v[36:39], a[112:127]
    ds_read_b64_tr_b16 v[96:97], v21 offset:40960
    ds_read_b64_tr_b16 v[98:99], v21 offset:43008
    s_waitcnt lgkmcnt(0)
    v_mfma_f32_32x32x16_bf16 a[0:15], v[84:87], v[68:71], a[0:15]
    v_mfma_f32_32x32x16_bf16 a[16:31], v[88:91], v[68:71], a[16:31]
    v_mfma_f32_32x32x16_bf16 a[32:47], v[92:95], v[68:71], a[32:47]
    s_waitcnt vmcnt(9)
    s_barrier
    v_mfma_f32_32x32x16_bf16 a[48:63], v[96:99], v[68:71], a[48:63]
    ds_read_b128 v[32:35], v10 offset:0
    s_add_u32 m0, s40, 66560
    buffer_load_dwordx4 v5, s[12:15], s34 offen lds
    v_mfma_f32_32x32x16_bf16 a[64:79], v[84:87], v[72:75], a[64:79]
    ds_read_b128 v[36:39], v10 offset:2048
    ds_read_b64_tr_b16 v[48:49], v14 offset:0
    ds_read_b64_tr_b16 v[50:51], v14 offset:2048
    v_mfma_f32_32x32x16_bf16 a[80:95], v[88:91], v[72:75], a[80:95]
    s_add_u32 m0, s40, 67584
    buffer_load_dwordx4 v6, s[12:15], s34 offen lds
    ds_read_b64_tr_b16 v[52:53], v16 offset:0
    v_mfma_f32_32x32x16_bf16 a[96:111], v[92:95], v[72:75], a[96:111]
    ds_read_b64_tr_b16 v[54:55], v16 offset:2048
    ds_read_b64_tr_b16 v[56:57], v18 offset:0
    s_add_u32 m0, s40, 68608
    buffer_load_dwordx4 v7, s[12:15], s34 offen lds
    v_mfma_f32_32x32x16_bf16 a[112:127], v[96:99], v[72:75], a[112:127]
    ds_read_b64_tr_b16 v[58:59], v18 offset:2048
    ds_read_b64_tr_b16 v[60:61], v20 offset:0
    ds_read_b64_tr_b16 v[62:63], v20 offset:2048
    s_add_u32 s33, s33, 64
    s_add_u32 s34, s34, s41
    s_add_u32 s42, s42, 1
    s_cmp_lt_u32 s42, 5
    s_cbranch_scc1 G_5_loop
    s_waitcnt vmcnt(0) lgkmcnt(0)
    s_nop 15
    s_nop 7
    s_barrier
    s_branch AH_4_epi
AH_4_v:
    s_mul_i32 s33, s4, 40960
    s_add_u32 s33, s33, s16
    s_lshl_b32 s37, s18, 3
    s_mul_i32 s34, s4, s37
    s_add_u32 s34, s34, s17
    s_mul_i32 s39, s4, 2048
    s_mul_i32 s40, s4, 4096
    s_add_u32 s40, s40, 8192
    s_lshl_b32 s41, s18, 5
    s_add_u32 m0, s39, 0
    s_add_u32 s38, s33, 0
    buffer_load_dwordx4 v2, s[8:11], s38 offen  lds
    s_add_u32 m0, s39, 1024
    s_add_u32 s38, s33, 20480
    buffer_load_dwordx4 v2, s[8:11], s38 offen  lds
    s_add_u32 m0, s40, 0
    buffer_load_dwordx4 v4, s[12:15], s34 offen lds
    s_add_u32 m0, s40, 1024
    buffer_load_dwordx4 v5, s[12:15], s34 offen lds
    s_add_u32 m0, s40, 2048
    buffer_load_dwordx4 v6, s[12:15], s34 offen lds
    s_add_u32 m0, s40, 3072
    buffer_load_dwordx4 v7, s[12:15], s34 offen lds
    s_add_u32 s33, s33, 64
    s_add_u32 s34, s34, s41
    s_add_u32 m0, s39, 32768
    s_add_u32 s38, s33, 0
    buffer_load_dwordx4 v2, s[8:11], s38 offen  lds
    s_add_u32 m0, s39, 33792
    s_add_u32 s38, s33, 20480
    buffer_load_dwordx4 v2, s[8:11], s38 offen  lds
    s_add_u32 m0, s40, 32768
    buffer_load_dwordx4 v4, s[12:15], s34 offen lds
    s_add_u32 m0, s40, 33792
    buffer_load_dwordx4 v5, s[12:15], s34 offen lds
    s_add_u32 m0, s40, 34816
    buffer_load_dwordx4 v6, s[12:15], s34 offen lds
    s_add_u32 m0, s40, 35840
    buffer_load_dwordx4 v7, s[12:15], s34 offen lds
    s_add_u32 s33, s33, 64
    s_add_u32 s34, s34, s41
    s_add_u32 m0, s39, 65536
    s_add_u32 s38, s33, 0
    buffer_load_dwordx4 v2, s[8:11], s38 offen  lds
    s_add_u32 m0, s39, 66560
    s_add_u32 s38, s33, 20480
    buffer_load_dwordx4 v2, s[8:11], s38 offen  lds
    s_add_u32 m0, s40, 65536
    buffer_load_dwordx4 v4, s[12:15], s34 offen lds
    s_add_u32 m0, s40, 66560
    buffer_load_dwordx4 v5, s[12:15], s34 offen lds
    s_add_u32 m0, s40, 67584
    buffer_load_dwordx4 v6, s[12:15], s34 offen lds
    s_add_u32 m0, s40, 68608
    buffer_load_dwordx4 v7, s[12:15], s34 offen lds
    s_add_u32 s33, s33, 64
    s_add_u32 s34, s34, s41
    v_accvgpr_write_b32 a0, 0
    v_accvgpr_write_b32 a1, 0
    v_accvgpr_write_b32 a2, 0
    v_accvgpr_write_b32 a3, 0
    v_accvgpr_write_b32 a4, 0
    v_accvgpr_write_b32 a5, 0
    v_accvgpr_write_b32 a6, 0
    v_accvgpr_write_b32 a7, 0
    v_accvgpr_write_b32 a8, 0
    v_accvgpr_write_b32 a9, 0
    v_accvgpr_write_b32 a10, 0
    v_accvgpr_write_b32 a11, 0
    v_accvgpr_write_b32 a12, 0
    v_accvgpr_write_b32 a13, 0
    v_accvgpr_write_b32 a14, 0
    v_accvgpr_write_b32 a15, 0
    v_accvgpr_write_b32 a16, 0
    v_accvgpr_write_b32 a17, 0
    v_accvgpr_write_b32 a18, 0
    v_accvgpr_write_b32 a19, 0
    v_accvgpr_write_b32 a20, 0
    v_accvgpr_write_b32 a21, 0
    v_accvgpr_write_b32 a22, 0
    v_accvgpr_write_b32 a23, 0
    v_accvgpr_write_b32 a24, 0
    v_accvgpr_write_b32 a25, 0
    v_accvgpr_write_b32 a26, 0
    v_accvgpr_write_b32 a27, 0
    v_accvgpr_write_b32 a28, 0
    v_accvgpr_write_b32 a29, 0
    v_accvgpr_write_b32 a30, 0
    v_accvgpr_write_b32 a31, 0
    v_accvgpr_write_b32 a32, 0
    v_accvgpr_write_b32 a33, 0
    v_accvgpr_write_b32 a34, 0
    v_accvgpr_write_b32 a35, 0
    v_accvgpr_write_b32 a36, 0
    v_accvgpr_write_b32 a37, 0
    v_accvgpr_write_b32 a38, 0
    v_accvgpr_write_b32 a39, 0
    v_accvgpr_write_b32 a40, 0
    v_accvgpr_write_b32 a41, 0
    v_accvgpr_write_b32 a42, 0
    v_accvgpr_write_b32 a43, 0
    v_accvgpr_write_b32 a44, 0
    v_accvgpr_write_b32 a45, 0
    v_accvgpr_write_b32 a46, 0
    v_accvgpr_write_b32 a47, 0
    v_accvgpr_write_b32 a48, 0
    v_accvgpr_write_b32 a49, 0
    v_accvgpr_write_b32 a50, 0
    v_accvgpr_write_b32 a51, 0
    v_accvgpr_write_b32 a52, 0
    v_accvgpr_write_b32 a53, 0
    v_accvgpr_write_b32 a54, 0
    v_accvgpr_write_b32 a55, 0
    v_accvgpr_write_b32 a56, 0
    v_accvgpr_write_b32 a57, 0
    v_accvgpr_write_b32 a58, 0
    v_accvgpr_write_b32 a59, 0
    v_accvgpr_write_b32 a60, 0
    v_accvgpr_write_b32 a61, 0
    v_accvgpr_write_b32 a62, 0
    v_accvgpr_write_b32 a63, 0
    v_accvgpr_write_b32 a64, 0
    v_accvgpr_write_b32 a65, 0
    v_accvgpr_write_b32 a66, 0
    v_accvgpr_write_b32 a67, 0
    v_accvgpr_write_b32 a68, 0
    v_accvgpr_write_b32 a69, 0
    v_accvgpr_write_b32 a70, 0
    v_accvgpr_write_b32 a71, 0
    v_accvgpr_write_b32 a72, 0
    v_accvgpr_write_b32 a73, 0
    v_accvgpr_write_b32 a74, 0
    v_accvgpr_write_b32 a75, 0
    v_accvgpr_write_b32 a76, 0
    v_accvgpr_write_b32 a77, 0
    v_accvgpr_write_b32 a78, 0
    v_accvgpr_write_b32 a79, 0
    v_accvgpr_write_b32 a80, 0
    v_accvgpr_write_b32 a81, 0
    v_accvgpr_write_b32 a82, 0
    v_accvgpr_write_b32 a83, 0
    v_accvgpr_write_b32 a84, 0
    v_accvgpr_write_b32 a85, 0
    v_accvgpr_write_b32 a86, 0
    v_accvgpr_write_b32 a87, 0
    v_accvgpr_write_b32 a88, 0
    v_accvgpr_write_b32 a89, 0
    v_accvgpr_write_b32 a90, 0
    v_accvgpr_write_b32 a91, 0
    v_accvgpr_write_b32 a92, 0
    v_accvgpr_write_b32 a93, 0
    v_accvgpr_write_b32 a94, 0
    v_accvgpr_write_b32 a95, 0
    v_accvgpr_write_b32 a96, 0
    v_accvgpr_write_b32 a97, 0
    v_accvgpr_write_b32 a98, 0
    v_accvgpr_write_b32 a99, 0
    v_accvgpr_write_b32 a100, 0
    v_accvgpr_write_b32 a101, 0
    v_accvgpr_write_b32 a102, 0
    v_accvgpr_write_b32 a103, 0
    v_accvgpr_write_b32 a104, 0
    v_accvgpr_write_b32 a105, 0
    v_accvgpr_write_b32 a106, 0
    v_accvgpr_write_b32 a107, 0
    v_accvgpr_write_b32 a108, 0
    v_accvgpr_write_b32 a109, 0
    v_accvgpr_write_b32 a110, 0
    v_accvgpr_write_b32 a111, 0
    v_accvgpr_write_b32 a112, 0
    v_accvgpr_write_b32 a113, 0
    v_accvgpr_write_b32 a114, 0
    v_accvgpr_write_b32 a115, 0
    v_accvgpr_write_b32 a116, 0
    v_accvgpr_write_b32 a117, 0
    v_accvgpr_write_b32 a118, 0
    v_accvgpr_write_b32 a119, 0
    v_accvgpr_write_b32 a120, 0
    v_accvgpr_write_b32 a121, 0
    v_accvgpr_write_b32 a122, 0
    v_accvgpr_write_b32 a123, 0
    v_accvgpr_write_b32 a124, 0
    v_accvgpr_write_b32 a125, 0
    v_accvgpr_write_b32 a126, 0
    v_accvgpr_write_b32 a127, 0
    s_waitcnt vmcnt(12)
    s_barrier
    ds_read_b128 v[32:35], v10 offset:0
    ds_read_b128 v[36:39], v10 offset:2048
    ds_read_b64_tr_b16 v[48:49], v14 offset:0
    ds_read_b64_tr_b16 v[50:51], v14 offset:2048
    ds_read_b64_tr_b16 v[52:53], v16 offset:0
    ds_read_b64_tr_b16 v[54:55], v16 offset:2048
    ds_read_b64_tr_b16 v[56:57], v18 offset:0
    ds_read_b64_tr_b16 v[58:59], v18 offset:2048
    ds_read_b64_tr_b16 v[60:61], v20 offset:0
    ds_read_b64_tr_b16 v[62:63], v20 offset:2048
    s_mov_b32 s42, 0
G_6_loop:
    s_waitcnt lgkmcnt(0)
    v_mfma_f32_32x32x16_bf16 a[0:15], v[32:35], v[48:51], a[0:15]
    ds_read_b128 v[68:71], v12 offset:0
    v_mfma_f32_32x32x16_bf16 a[16:31], v[32:35], v[52:55], a[16:31]
    s_add_u32 m0, s39, 98304
    s_add_u32 s38, s33, 0
    buffer_load_dwordx4 v2, s[8:11], s38 offen  lds
    ds_read_b128 v[72:75], v12 offset:2048
    v_mfma_f32_32x32x16_bf16 a[32:47], v[32:35], v[56:59], a[32:47]
    ds_read_b64_tr_b16 v[84:85], v14 offset:8192
    v_mfma_f32_32x32x16_bf16 a[48:63], v[32:35], v[60:63], a[48:63]
    ds_read_b64_tr_b16 v[86:87], v14 offset:10240
    s_add_u32 m0, s39, 99328
    s_add_u32 s38, s33, 20480
    buffer_load_dwordx4 v2, s[8:11], s38 offen  lds
    v_mfma_f32_32x32x16_bf16 a[64:79], v[36:39], v[48:51], a[64:79]
    ds_read_b64_tr_b16 v[88:89], v16 offset:8192
    ds_read_b64_tr_b16 v[90:91], v16 offset:10240
    v_mfma_f32_32x32x16_bf16 a[80:95], v[36:39], v[52:55], a[80:95]
    ds_read_b64_tr_b16 v[92:93], v18 offset:8192
    v_mfma_f32_32x32x16_bf16 a[96:111], v[36:39], v[56:59], a[96:111]
    s_add_u32 m0, s40, 98304
    buffer_load_dwordx4 v4, s[12:15], s34 offen lds
    ds_read_b64_tr_b16 v[94:95], v18 offset:10240
    v_mfma_f32_32x32x16_bf16 a[112:127], v[36:39], v[60:63], a[112:127]
    ds_read_b64_tr_b16 v[96:97], v20 offset:8192
    ds_read_b64_tr_b16 v[98:99], v20 offset:10240
    s_waitcnt lgkmcnt(0)
    v_mfma_f32_32x32x16_bf16 a[0:15], v[68:71], v[84:87], a[0:15]
    v_mfma_f32_32x32x16_bf16 a[16:31], v[68:71], v[88:91], a[16:31]
    v_mfma_f32_32x32x16_bf16 a[32:47], v[68:71], v[92:95], a[32:47]
    s_waitcnt vmcnt(9)
    s_barrier
    v_mfma_f32_32x32x16_bf16 a[48:63], v[68:71], v[96:99], a[48:63]
    ds_read_b128 v[32:35], v10 offset:32768
    s_add_u32 m0, s40, 99328
    buffer_load_dwordx4 v5, s[12:15], s34 offen lds
    v_mfma_f32_32x32x16_bf16 a[64:79], v[72:75], v[84:87], a[64:79]
    ds_read_b128 v[36:39], v10 offset:34816
    ds_read_b64_tr_b16 v[48:49], v14 offset:32768
    ds_read_b64_tr_b16 v[50:51], v14 offset:34816
    v_mfma_f32_32x32x16_bf16 a[80:95], v[72:75], v[88:91], a[80:95]
    s_add_u32 m0, s40, 100352
    buffer_load_dwordx4 v6, s[12:15], s34 offen lds
    ds_read_b64_tr_b16 v[52:53], v16 offset:32768
    v_mfma_f32_32x32x16_bf16 a[96:111], v[72:75], v[92:95], a[96:111]
    ds_read_b64_tr_b16 v[54:55], v16 offset:34816
    ds_read_b64_tr_b16 v[56:57], v18 offset:32768
    s_add_u32 m0, s40, 101376
    buffer_load_dwordx4 v7, s[12:15], s34 offen lds
    v_mfma_f32_32x32x16_bf16 a[112:127], v[72:75], v[96:99], a[112:127]
    ds_read_b64_tr_b16 v[58:59], v18 offset:34816
    ds_read_b64_tr_b16 v[60:61], v20 offset:32768
    ds_read_b64_tr_b16 v[62:63], v20 offset:34816
    s_add_u32 s33, s33, 64
    s_add_u32 s34, s34, s41
    s_cmp_eq_u32 s42, 4
    s_cselect_b32 s10, 0, s10
    s_cselect_b32 s14, 0, s14
    s_waitcnt lgkmcnt(0)
    v_mfma_f32_32x32x16_bf16 a[0:15], v[32:35], v[48:51], a[0:15]
    ds_read_b128 v[68:71], v12 offset:32768
    v_mfma_f32_32x32x16_bf16 a[16:31], v[32:35], v[52:55], a[16:31]
    s_add_u32 m0, s39, 0
    s_add_u32 s38, s33, 0
    buffer_load_dwordx4 v2, s[8:11], s38 offen  lds
    ds_read_b128 v[72:75], v12 offset:34816
    v_mfma_f32_32x32x16_bf16 a[32:47], v[32:35], v[56:59], a[32:47]
    ds_read_b64_tr_b16 v[84:85], v14 offset:40960
    v_mfma_f32_32x32x16_bf16 a[48:63], v[32:35], v[60:63], a[48:63]
    ds_read_b64_tr_b16 v[86:87], v14 offset:43008
    s_add_u32 m0, s39, 1024
    s_add_u32 s38, s33, 20480
    buffer_load_dwordx4 v2, s[8:11], s38 offen  lds
    v_mfma_f32_32x32x16_bf16 a[64:79], v[36:39], v[48:51], a[64:79]
    ds_read_b64_tr_b16 v[88:89], v16 offset:40960
    ds_read_b64_tr_b16 v[90:91], v16 offset:43008
    v_mfma_f32_32x32x16_bf16 a[80:95], v[36:39], v[52:55], a[80:95]
    ds_read_b64_tr_b16 v[92:93], v18 offset:40960
    v_mfma_f32_32x32x16_bf16 a[96:111], v[36:39], v[56:59], a[96:111]
    s_add_u32 m0, s40, 0
    buffer_load_dwordx4 v4, s[12:15], s34 offen lds
    ds_read_b64_tr_b16 v[94:95], v18 offset:43008
    v_mfma_f32_32x32x16_bf16 a[112:127], v[36:39], v[60:63], a[112:127]
    ds_read_b64_tr_b16 v[96:97], v20 offset:40960
    ds_read_b64_tr_b16 v[98:99], v20 offset:43008
    s_waitcnt lgkmcnt(0)
    v_mfma_f32_32x32x16_bf16 a[0:15], v[68:71], v[84:87], a[0:15]
    v_mfma_f32_32x32x16_bf16 a[16:31], v[68:71], v[88:91], a[16:31]
    v_mfma_f32_32x32x16_bf16 a[32:47], v[68:71], v[92:95], a[32:47]
    s_waitcnt vmcnt(9)
    s_barrier
    v_mfma_f32_32x32x16_bf16 a[48:63], v[68:71], v[96:99], a[48:63]
    ds_read_b128 v[32:35], v11 offset:0
    s_add_u32 m0, s40, 1024
    buffer_load_dwordx4 v5, s[12:15], s34 offen lds
    v_mfma_f32_32x32x16_bf16 a[64:79], v[72:75], v[84:87], a[64:79]
    ds_read_b128 v[36:39], v11 offset:2048
    ds_read_b64_tr_b16 v[48:49], v15 offset:0
    ds_read_b64_tr_b16 v[50:51], v15 offset:2048
    v_mfma_f32_32x32x16_bf16 a[80:95], v[72:75], v[88:91], a[80:95]
    s_add_u32 m0, s40, 2048
    buffer_load_dwordx4 v6, s[12:15], s34 offen lds
    ds_read_b64_tr_b16 v[52:53], v17 offset:0
    v_mfma_f32_32x32x16_bf16 a[96:111], v[72:75], v[92:95], a[96:111]
    ds_read_b64_tr_b16 v[54:55], v17 offset:2048
    ds_read_b64_tr_b16 v[56:57], v19 offset:0
    s_add_u32 m0, s40, 3072
    buffer_load_dwordx4 v7, s[12:15], s34 offen lds
    v_mfma_f32_32x32x16_bf16 a[112:127], v[72:75], v[96:99], a[112:127]
    ds_read_b64_tr_b16 v[58:59], v19 offset:2048
    ds_read_b64_tr_b16 v[60:61], v21 offset:0
    ds_read_b64_tr_b16 v[62:63], v21 offset:2048
    s_add_u32 s33, s33, 64
    s_add_u32 s34, s34, s41
    s_waitcnt lgkmcnt(0)
    v_mfma_f32_32x32x16_bf16 a[0:15], v[32:35], v[48:51], a[0:15]
    ds_read_b128 v[68:71], v13 offset:0
    v_mfma_f32_32x32x16_bf16 a[16:31], v[32:35], v[52:55], a[16:31]
    s_add_u32 m0, s39, 32768
    s_add_u32 s38, s33, 0
    buffer_load_dwordx4 v2, s[8:11], s38 offen  lds
    ds_read_b128 v[72:75], v13 offset:2048
    v_mfma_f32_32x32x16_bf16 a[32:47], v[32:35], v[56:59], a[32:47]
    ds_read_b64_tr_b16 v[84:85], v15 offset:8192
    v_mfma_f32_32x32x16_bf16 a[48:63], v[32:35], v[60:63], a[48:63]
    ds_read_b64_tr_b16 v[86:87], v15 offset:10240
    s_add_u32 m0, s39, 33792
    s_add_u32 s38, s33, 20480
    buffer_load_dwordx4 v2, s[8:11], s38 offen  lds
    v_mfma_f32_32x32x16_bf16 a[64:79], v[36:39], v[48:51], a[64:79]
    ds_read_b64_tr_b16 v[88:89], v17 offset:8192
    ds_read_b64_tr_b16 v[90:91], v17 offset:10240
    v_mfma_f32_32x32x16_bf16 a[80:95], v[36:39], v[52:55], a[80:95]
    ds_read_b64_tr_b16 v[92:93], v19 offset:8192
    v_mfma_f32_32x32x16_bf16 a[96:111], v[36:39], v[56:59], a[96:111]
    s_add_u32 m0, s40, 32768
    buffer_load_dwordx4 v4, s[12:15], s34 offen lds
    ds_read_b64_tr_b16 v[94:95], v19 offset:10240
    v_mfma_f32_32x32x16_bf16 a[112:127], v[36:39], v[60:63], a[112:127]
    ds_read_b64_tr_b16 v[96:97], v21 offset:8192
    ds_read_b64_tr_b16 v[98:99], v21 offset:10240
    s_waitcnt lgkmcnt(0)
    v_mfma_f32_32x32x16_bf16 a[0:15], v[68:71], v[84:87], a[0:15]
    v_mfma_f32_32x32x16_bf16 a[16:31], v[68:71], v[88:91], a[16:31]
    v_mfma_f32_32x32x16_bf16 a[32:47], v[68:71], v[92:95], a[32:47]
    s_waitcnt vmcnt(9)
    s_barrier
    v_mfma_f32_32x32x16_bf16 a[48:63], v[68:71], v[96:99], a[48:63]
    ds_read_b128 v[32:35], v11 offset:32768
    s_add_u32 m0, s40, 33792
    buffer_load_dwordx4 v5, s[12:15], s34 offen lds
    v_mfma_f32_32x32x16_bf16 a[64:79], v[72:75], v[84:87], a[64:79]
    ds_read_b128 v[36:39], v11 offset:34816
    ds_read_b64_tr_b16 v[48:49], v15 offset:32768
    ds_read_b64_tr_b16 v[50:51], v15 offset:34816
    v_mfma_f32_32x32x16_bf16 a[80:95], v[72:75], v[88:91], a[80:95]
    s_add_u32 m0, s40, 34816
    buffer_load_dwordx4 v6, s[12:15], s34 offen lds
    ds_read_b64_tr_b16 v[52:53], v17 offset:32768
    v_mfma_f32_32x32x16_bf16 a[96:111], v[72:75], v[92:95], a[96:111]
    ds_read_b64_tr_b16 v[54:55], v17 offset:34816
    ds_read_b64_tr_b16 v[56:57], v19 offset:32768
    s_add_u32 m0, s40, 35840
    buffer_load_dwordx4 v7, s[12:15], s34 offen lds
    v_mfma_f32_32x32x16_bf16 a[112:127], v[72:75], v[96:99], a[112:127]
    ds_read_b64_tr_b16 v[58:59], v19 offset:34816
    ds_read_b64_tr_b16 v[60:61], v21 offset:32768
    ds_read_b64_tr_b16 v[62:63], v21 offset:34816
    s_add_u32 s33, s33, 64
    s_add_u32 s34, s34, s41
    s_waitcnt lgkmcnt(0)
    v_mfma_f32_32x32x16_bf16 a[0:15], v[32:35], v[48:51], a[0:15]
    ds_read_b128 v[68:71], v13 offset:32768
    v_mfma_f32_32x32x16_bf16 a[16:31], v[32:35], v[52:55], a[16:31]
    s_add_u32 m0, s39, 65536
    s_add_u32 s38, s33, 0
    buffer_load_dwordx4 v2, s[8:11], s38 offen  lds
    ds_read_b128 v[72:75], v13 offset:34816
    v_mfma_f32_32x32x16_bf16 a[32:47], v[32:35], v[56:59], a[32:47]
    ds_read_b64_tr_b16 v[84:85], v15 offset:40960
    v_mfma_f32_32x32x16_bf16 a[48:63], v[32:35], v[60:63], a[48:63]
    ds_read_b64_tr_b16 v[86:87], v15 offset:43008
    s_add_u32 m0, s39, 66560
    s_add_u32 s38, s33, 20480
    buffer_load_dwordx4 v2, s[8:11], s38 offen  lds
    v_mfma_f32_32x32x16_bf16 a[64:79], v[36:39], v[48:51], a[64:79]
    ds_read_b64_tr_b16 v[88:89], v17 offset:40960
    ds_read_b64_tr_b16 v[90:91], v17 offset:43008
    v_mfma_f32_32x32x16_bf16 a[80:95], v[36:39], v[52:55], a[80:95]
    ds_read_b64_tr_b16 v[92:93], v19 offset:40960
    v_mfma_f32_32x32x16_bf16 a[96:111], v[36:39], v[56:59], a[96:111]
    s_add_u32 m0, s40, 65536
    buffer_load_dwordx4 v4, s[12:15], s34 offen lds
    ds_read_b64_tr_b16 v[94:95], v19 offset:43008
    v_mfma_f32_32x32x16_bf16 a[112:127], v[36:39], v[60:63], a[112:127]
    ds_read_b64_tr_b16 v[96:97], v21 offset:40960
    ds_read_b64_tr_b16 v[98:99], v21 offset:43008
    s_waitcnt lgkmcnt(0)
    v_mfma_f32_32x32x16_bf16 a[0:15], v[68:71], v[84:87], a[0:15]
    v_mfma_f32_32x32x16_bf16 a[16:31], v[68:71], v[88:91], a[16:31]
    v_mfma_f32_32x32x16_bf16 a[32:47], v[68:71], v[92:95], a[32:47]
    s_waitcnt vmcnt(9)
    s_barrier
    v_mfma_f32_32x32x16_bf16 a[48:63], v[68:71], v[96:99], a[48:63]
    ds_read_b128 v[32:35], v10 offset:0
    s_add_u32 m0, s40, 66560
    buffer_load_dwordx4 v5, s[12:15], s34 offen lds
    v_mfma_f32_32x32x16_bf16 a[64:79], v[72:75], v[84:87], a[64:79]
    ds_read_b128 v[36:39], v10 offset:2048
    ds_read_b64_tr_b16 v[48:49], v14 offset:0
    ds_read_b64_tr_b16 v[50:51], v14 offset:2048
    v_mfma_f32_32x32x16_bf16 a[80:95], v[72:75], v[88:91], a[80:95]
    s_add_u32 m0, s40, 67584
    buffer_load_dwordx4 v6, s[12:15], s34 offen lds
    ds_read_b64_tr_b16 v[52:53], v16 offset:0
    v_mfma_f32_32x32x16_bf16 a[96:111], v[72:75], v[92:95], a[96:111]
    ds_read_b64_tr_b16 v[54:55], v16 offset:2048
    ds_read_b64_tr_b16 v[56:57], v18 offset:0
    s_add_u32 m0, s40, 68608
    buffer_load_dwordx4 v7, s[12:15], s34 offen lds
    v_mfma_f32_32x32x16_bf16 a[112:127], v[72:75], v[96:99], a[112:127]
    ds_read_b64_tr_b16 v[58:59], v18 offset:2048
    ds_read_b64_tr_b16 v[60:61], v20 offset:0
    ds_read_b64_tr_b16 v[62:63], v20 offset:2048
    s_add_u32 s33, s33, 64
    s_add_u32 s34, s34, s41
    s_add_u32 s42, s42, 1
    s_cmp_lt_u32 s42, 5
    s_cbranch_scc1 G_6_loop
    s_waitcnt vmcnt(0) lgkmcnt(0)
    s_nop 15
    s_nop 7
    s_barrier
AH_4_epi:
    s_and_b32 s30, s4, 1
    s_mul_i32 s30, s30, 524288
    s_lshr_b32 s31, s4, 1
    s_lshl_b32 s31, s31, 13
    s_add_u32 s30, s30, s31
    s_add_u32 s30, s30, s24
    v_and_b32 v1, 63, v0
    v_lshlrev_b32 v2, 4, v1
    v_accvgpr_read_b32 v104, a0
    v_accvgpr_read_b32 v105, a1
    v_accvgpr_read_b32 v106, a2
    v_accvgpr_read_b32 v107, a3
    v_accvgpr_read_b32 v108, a4
    v_accvgpr_read_b32 v109, a5
    v_accvgpr_read_b32 v110, a6
    v_accvgpr_read_b32 v111, a7
    v_accvgpr_read_b32 v112, a8
    v_accvgpr_read_b32 v113, a9
    v_accvgpr_read_b32 v114, a10
    v_accvgpr_read_b32 v115, a11
    v_accvgpr_read_b32 v116, a12
    v_accvgpr_read_b32 v117, a13
    v_accvgpr_read_b32 v118, a14
    v_accvgpr_read_b32 v119, a15
    v_cvt_pk_bf16_f32 v128, v104, v105
    v_cvt_pk_bf16_f32 v129, v106, v107
    v_cvt_pk_bf16_f32 v130, v108, v109
    v_cvt_pk_bf16_f32 v131, v110, v111
    v_cvt_pk_bf16_f32 v132, v112, v113
    v_cvt_pk_bf16_f32 v133, v114, v115
    v_cvt_pk_bf16_f32 v134, v116, v117
    v_cvt_pk_bf16_f32 v135, v118, v119
    s_add_u32 s31, s30, 0
    buffer_store_dwordx4 v[128:131], v2, s[20:23], s31 offen sc1
    buffer_store_dwordx4 v[132:135], v2, s[20:23], s31 offen offset:1024 sc1
    v_accvgpr_read_b32 v104, a16
    v_accvgpr_read_b32 v105, a17
    v_accvgpr_read_b32 v106, a18
    v_accvgpr_read_b32 v107, a19
    v_accvgpr_read_b32 v108, a20
    v_accvgpr_read_b32 v109, a21
    v_accvgpr_read_b32 v110, a22
    v_accvgpr_read_b32 v111, a23
    v_accvgpr_read_b32 v112, a24
    v_accvgpr_read_b32 v113, a25
    v_accvgpr_read_b32 v114, a26
    v_accvgpr_read_b32 v115, a27
    v_accvgpr_read_b32 v116, a28
    v_accvgpr_read_b32 v117, a29
    v_accvgpr_read_b32 v118, a30
    v_accvgpr_read_b32 v119, a31
    v_cvt_pk_bf16_f32 v136, v104, v105
    v_cvt_pk_bf16_f32 v137, v106, v107
    v_cvt_pk_bf16_f32 v138, v108, v109
    v_cvt_pk_bf16_f32 v139, v110, v111
    v_cvt_pk_bf16_f32 v140, v112, v113
    v_cvt_pk_bf16_f32 v141, v114, v115
    v_cvt_pk_bf16_f32 v142, v116, v117
    v_cvt_pk_bf16_f32 v143, v118, v119
    s_add_u32 s31, s30, 2048
    buffer_store_dwordx4 v[136:139], v2, s[20:23], s31 offen sc1
    buffer_store_dwordx4 v[140:143], v2, s[20:23], s31 offen offset:1024 sc1
    v_accvgpr_read_b32 v104, a32
    v_accvgpr_read_b32 v105, a33
    v_accvgpr_read_b32 v106, a34
    v_accvgpr_read_b32 v107, a35
    v_accvgpr_read_b32 v108, a36
    v_accvgpr_read_b32 v109, a37
    v_accvgpr_read_b32 v110, a38
    v_accvgpr_read_b32 v111, a39
    v_accvgpr_read_b32 v112, a40
    v_accvgpr_read_b32 v113, a41
    v_accvgpr_read_b32 v114, a42
    v_accvgpr_read_b32 v115, a43
    v_accvgpr_read_b32 v116, a44
    v_accvgpr_read_b32 v117, a45
    v_accvgpr_read_b32 v118, a46
    v_accvgpr_read_b32 v119, a47
    v_cvt_pk_bf16_f32 v144, v104, v105
    v_cvt_pk_bf16_f32 v145, v106, v107
    v_cvt_pk_bf16_f32 v146, v108, v109
    v_cvt_pk_bf16_f32 v147, v110, v111
    v_cvt_pk_bf16_f32 v148, v112, v113
    v_cvt_pk_bf16_f32 v149, v114, v115
    v_cvt_pk_bf16_f32 v150, v116, v117
    v_cvt_pk_bf16_f32 v151, v118, v119
    s_add_u32 s31, s30, 4096
    buffer_store_dwordx4 v[144:147], v2, s[20:23], s31 offen sc1
    buffer_store_dwordx4 v[148:151], v2, s[20:23], s31 offen offset:1024 sc1
    v_accvgpr_read_b32 v104, a48
    v_accvgpr_read_b32 v105, a49
    v_accvgpr_read_b32 v106, a50
    v_accvgpr_read_b32 v107, a51
    v_accvgpr_read_b32 v108, a52
    v_accvgpr_read_b32 v109, a53
    v_accvgpr_read_b32 v110, a54
    v_accvgpr_read_b32 v111, a55
    v_accvgpr_read_b32 v112, a56
    v_accvgpr_read_b32 v113, a57
    v_accvgpr_read_b32 v114, a58
    v_accvgpr_read_b32 v115, a59
    v_accvgpr_read_b32 v116, a60
    v_accvgpr_read_b32 v117, a61
    v_accvgpr_read_b32 v118, a62
    v_accvgpr_read_b32 v119, a63
    v_cvt_pk_bf16_f32 v152, v104, v105
    v_cvt_pk_bf16_f32 v153, v106, v107
    v_cvt_pk_bf16_f32 v154, v108, v109
    v_cvt_pk_bf16_f32 v155, v110, v111
    v_cvt_pk_bf16_f32 v156, v112, v113
    v_cvt_pk_bf16_f32 v157, v114, v115
    v_cvt_pk_bf16_f32 v158, v116, v117
    v_cvt_pk_bf16_f32 v159, v118, v119
    s_add_u32 s31, s30, 6144
    buffer_store_dwordx4 v[152:155], v2, s[20:23], s31 offen sc1
    buffer_store_dwordx4 v[156:159], v2, s[20:23], s31 offen offset:1024 sc1
    v_accvgpr_read_b32 v104, a64
    v_accvgpr_read_b32 v105, a65
    v_accvgpr_read_b32 v106, a66
    v_accvgpr_read_b32 v107, a67
    v_accvgpr_read_b32 v108, a68
    v_accvgpr_read_b32 v109, a69
    v_accvgpr_read_b32 v110, a70
    v_accvgpr_read_b32 v111, a71
    v_accvgpr_read_b32 v112, a72
    v_accvgpr_read_b32 v113, a73
    v_accvgpr_read_b32 v114, a74
    v_accvgpr_read_b32 v115, a75
    v_accvgpr_read_b32 v116, a76
    v_accvgpr_read_b32 v117, a77
    v_accvgpr_read_b32 v118, a78
    v_accvgpr_read_b32 v119, a79
    v_cvt_pk_bf16_f32 v128, v104, v105
    v_cvt_pk_bf16_f32 v129, v106, v107
    v_cvt_pk_bf16_f32 v130, v108, v109
    v_cvt_pk_bf16_f32 v131, v110, v111
    v_cvt_pk_bf16_f32 v132, v112, v113
    v_cvt_pk_bf16_f32 v133, v114, v115
    v_cvt_pk_bf16_f32 v134, v116, v117
    v_cvt_pk_bf16_f32 v135, v118, v119
    s_add_u32 s31, s30, 262144
    buffer_store_dwordx4 v[128:131], v2, s[20:23], s31 offen sc1
    buffer_store_dwordx4 v[132:135], v2, s[20:23], s31 offen offset:1024 sc1
    v_accvgpr_read_b32 v104, a80
    v_accvgpr_read_b32 v105, a81
    v_accvgpr_read_b32 v106, a82
    v_accvgpr_read_b32 v107, a83
    v_accvgpr_read_b32 v108, a84
    v_accvgpr_read_b32 v109, a85
    v_accvgpr_read_b32 v110, a86
    v_accvgpr_read_b32 v111, a87
    v_accvgpr_read_b32 v112, a88
    v_accvgpr_read_b32 v113, a89
    v_accvgpr_read_b32 v114, a90
    v_accvgpr_read_b32 v115, a91
    v_accvgpr_read_b32 v116, a92
    v_accvgpr_read_b32 v117, a93
    v_accvgpr_read_b32 v118, a94
    v_accvgpr_read_b32 v119, a95
    v_cvt_pk_bf16_f32 v136, v104, v105
    v_cvt_pk_bf16_f32 v137, v106, v107
    v_cvt_pk_bf16_f32 v138, v108, v109
    v_cvt_pk_bf16_f32 v139, v110, v111
    v_cvt_pk_bf16_f32 v140, v112, v113
    v_cvt_pk_bf16_f32 v141, v114, v115
    v_cvt_pk_bf16_f32 v142, v116, v117
    v_cvt_pk_bf16_f32 v143, v118, v119
    s_add_u32 s31, s30, 264192
    buffer_store_dwordx4 v[136:139], v2, s[20:23], s31 offen sc1
    buffer_store_dwordx4 v[140:143], v2, s[20:23], s31 offen offset:1024 sc1
    v_accvgpr_read_b32 v104, a96
    v_accvgpr_read_b32 v105, a97
    v_accvgpr_read_b32 v106, a98
    v_accvgpr_read_b32 v107, a99
    v_accvgpr_read_b32 v108, a100
    v_accvgpr_read_b32 v109, a101
    v_accvgpr_read_b32 v110, a102
    v_accvgpr_read_b32 v111, a103
    v_accvgpr_read_b32 v112, a104
    v_accvgpr_read_b32 v113, a105
    v_accvgpr_read_b32 v114, a106
    v_accvgpr_read_b32 v115, a107
    v_accvgpr_read_b32 v116, a108
    v_accvgpr_read_b32 v117, a109
    v_accvgpr_read_b32 v118, a110
    v_accvgpr_read_b32 v119, a111
    v_cvt_pk_bf16_f32 v144, v104, v105
    v_cvt_pk_bf16_f32 v145, v106, v107
    v_cvt_pk_bf16_f32 v146, v108, v109
    v_cvt_pk_bf16_f32 v147, v110, v111
    v_cvt_pk_bf16_f32 v148, v112, v113
    v_cvt_pk_bf16_f32 v149, v114, v115
    v_cvt_pk_bf16_f32 v150, v116, v117
    v_cvt_pk_bf16_f32 v151, v118, v119
    s_add_u32 s31, s30, 266240
    buffer_store_dwordx4 v[144:147], v2, s[20:23], s31 offen sc1
    buffer_store_dwordx4 v[148:151], v2, s[20:23], s31 offen offset:1024 sc1
    v_accvgpr_read_b32 v104, a112
    v_accvgpr_read_b32 v105, a113
    v_accvgpr_read_b32 v106, a114
    v_accvgpr_read_b32 v107, a115
    v_accvgpr_read_b32 v108, a116
    v_accvgpr_read_b32 v109, a117
    v_accvgpr_read_b32 v110, a118
    v_accvgpr_read_b32 v111, a119
    v_accvgpr_read_b32 v112, a120
    v_accvgpr_read_b32 v113, a121
    v_accvgpr_read_b32 v114, a122
    v_accvgpr_read_b32 v115, a123
    v_accvgpr_read_b32 v116, a124
    v_accvgpr_read_b32 v117, a125
    v_accvgpr_read_b32 v118, a126
    v_accvgpr_read_b32 v119, a127
    v_cvt_pk_bf16_f32 v152, v104, v105
    v_cvt_pk_bf16_f32 v153, v106, v107
    v_cvt_pk_bf16_f32 v154, v108, v109
    v_cvt_pk_bf16_f32 v155, v110, v111
    v_cvt_pk_bf16_f32 v156, v112, v113
    v_cvt_pk_bf16_f32 v157, v114, v115
    v_cvt_pk_bf16_f32 v158, v116, v117
    v_cvt_pk_bf16_f32 v159, v118, v119
    s_add_u32 s31, s30, 268288
    buffer_store_dwordx4 v[152:155], v2, s[20:23], s31 offen sc1
    buffer_store_dwordx4 v[156:159], v2, s[20:23], s31 offen offset:1024 sc1
    s_branch M_fin
M_ap:
    s_mul_i32 s44, s6, 48
    s_add_u32 s44, s44, s7
    s_lshl_b32 s44, s44, 2
    s_add_u32 s99, s44, 100663296
    s_lshr_b32 s27, s7, 4
    s_and_b32 s7, s7, 15
    s_load_dwordx2 s[8:9], s[0:1], 0
    s_load_dwordx2 s[20:21], s[0:1], 96
    s_cmp_eq_u32 s27, 0
    s_cselect_b32 s28, 24, 32
    s_cmp_eq_u32 s27, 2
    s_cselect_b32 s28, 16, s28
    s_load_dwordx2 s[12:13], s[0:1], s28
    s_mov_b32 s24, 16777216
    s_cmp_eq_u32 s27, 1
    s_cselect_b32 s24, 33554432, s24
    s_cmp_eq_u32 s27, 2
    s_cselect_b32 s24, 0, s24
    s_mul_i32 s16, s6, 327680
    s_lshl_b32 s17, s7, 9
    s_mov_b32 s18, 8192
    s_lshl_b32 s29, s6, 21
    s_add_u32 s24, s24, s29
    s_lshl_b32 s29, s7, 14
    s_add_u32 s24, s24, s29
    s_waitcnt lgkmcnt(0)
    s_mov_b32 s10, 2621440
    s_mov_b32 s11, 0x20000
    s_mov_b32 s14, 5242880
    s_mov_b32 s15, 0x20000
    s_mov_b32 s22, 0x10000000
    s_mov_b32 s23, 0x20000
    v_and_b32 v1, 63, v0
    v_lshrrev_b32 v20, 2, v1
    v_and_b32 v21, 3, v1
    v_lshrrev_b32 v22, 4, v1
    v_xor_b32 v23, v21, v22
    v_mul_u32_u24 v24, 1280, v20
    v_lshl_add_u32 v2, v23, 4, v24
    v_add_u32 v20, 0, v1
    v_lshrrev_b32 v21, 5, v20
    v_and_b32 v22, 31, v20
    v_and_b32 v23, 3, v21
    v_lshlrev_b32 v23, 2, v23
    v_xor_b32 v22, v22, v23
    v_mul_lo_u32 v21, v21, s18
    v_lshl_add_u32 v4, v22, 4, v21
    v_add_u32 v20, 64, v1
    v_lshrrev_b32 v21, 5, v20
    v_and_b32 v22, 31, v20
    v_and_b32 v23, 3, v21
    v_lshlrev_b32 v23, 2, v23
    v_xor_b32 v22, v22, v23
    v_mul_lo_u32 v21, v21, s18
    v_lshl_add_u32 v5, v22, 4, v21
    v_add_u32 v20, 128, v1
    v_lshrrev_b32 v21, 5, v20
    v_and_b32 v22, 31, v20
    v_and_b32 v23, 3, v21
    v_lshlrev_b32 v23, 2, v23
    v_xor_b32 v22, v22, v23
    v_mul_lo_u32 v21, v21, s18
    v_lshl_add_u32 v6, v22, 4, v21
    v_add_u32 v20, 192, v1
    v_lshrrev_b32 v21, 5, v20
    v_and_b32 v22, 31, v20
    v_and_b32 v23, 3, v21
    v_lshlrev_b32 v23, 2, v23
    v_xor_b32 v22, v22, v23
    v_mul_lo_u32 v21, v21, s18
    v_lshl_add_u32 v7, v22, 4, v21
    s_and_b32 s30, s4, 1
    s_mul_i32 s30, s30, 8192
    v_and_b32 v20, 31, v1
    v_lshrrev_b32 v21, 5, v1
    v_bfe_u32 v22, v20, 2, 2
    v_lshlrev_b32 v20, 6, v20
    v_add_u32 v20, s30, v20
    v_add_u32 v23, 0, v21
    v_xor_b32 v23, v23, v22
    v_lshl_add_u32 v10, v23, 4, v20
    v_add_u32 v11, 0x10000, v10
    v_add_u32 v23, 2, v21
    v_xor_b32 v23, v23, v22
    v_lshl_add_u32 v12, v23, 4, v20
    v_add_u32 v13, 0x10000, v12
    s_lshr_b32 s31, s4, 1
    s_mul_i32 s31, s31, 16
    v_bfe_u32 v20, v1, 2, 2
    v_and_b32 v21, 3, v1
    v_bfe_u32 v22, v1, 4, 1
    v_lshrrev_b32 v23, 5, v1
    v_lshl_add_u32 v24, v23, 3, v20
    v_mul_u32_u24 v24, 512, v24
    v_add_u32 v24, 16384, v24
    v_and_b32 v25, 1, v21
    v_lshl_add_u32 v24, v25, 3, v24
    v_lshrrev_b32 v25, 1, v21
    v_lshl_add_u32 v25, v22, 1, v25
    v_add_u32 v25, s31, v25
    v_lshlrev_b32 v26, 2, v20
    v_add_u32 v27, 0, v25
    v_xor_b32 v27, v27, v26
    v_lshl_add_u32 v14, v27, 4, v24
    v_add_u32 v15, 0x10000, v14
    v_add_u32 v27, 4, v25
    v_xor_b32 v27, v27, v26
    v_lshl_add_u32 v16, v27, 4, v24
    v_add_u32 v17, 0x10000, v16
    v_add_u32 v27, 8, v25
    v_xor_b32 v27, v27, v26
    v_lshl_add_u32 v18, v27, 4, v24
    v_add_u32 v19, 0x10000, v18
    v_add_u32 v27, 12, v25
    v_xor_b32 v27, v27, v26
    v_lshl_add_u32 v20, v27, 4, v24
    v_add_u32 v21, 0x10000, v20
    s_cmp_eq_u32 s27, 1
    s_cbranch_scc1 AP_7_v
    s_mul_i32 s33, s4, 81920
    s_add_u32 s33, s33, s16
    s_lshl_b32 s37, s18, 3
    s_mul_i32 s34, s4, s37
    s_add_u32 s34, s34, s17
    s_mul_i32 s39, s4, 4096
    s_mul_i32 s40, s4, 4096
    s_add_u32 s40, s40, 16384
    s_lshl_b32 s41, s18, 5
    s_add_u32 m0, s39, 0
    s_add_u32 s38, s33, 0
    buffer_load_dwordx4 v2, s[8:11], s38 offen  lds
    s_add_u32 m0, s39, 1024
    s_add_u32 s38, s33, 20480
    buffer_load_dwordx4 v2, s[8:11], s38 offen  lds
    s_add_u32 m0, s39, 2048
    s_add_u32 s38, s33, 40960
    buffer_load_dwordx4 v2, s[8:11], s38 offen  lds
    s_add_u32 m0, s39, 3072
    s_add_u32 s38, s33, 61440
    buffer_load_dwordx4 v2, s[8:11], s38 offen  lds
    s_add_u32 m0, s40, 0
    buffer_load_dwordx4 v4, s[12:15], s34 offen lds
    s_add_u32 m0, s40, 1024
    buffer_load_dwordx4 v5, s[12:15], s34 offen lds
    s_add_u32 m0, s40, 2048
    buffer_load_dwordx4 v6, s[12:15], s34 offen lds
    s_add_u32 m0, s40, 3072
    buffer_load_dwordx4 v7, s[12:15], s34 offen lds
    s_add_u32 s33, s33, 64
    s_add_u32 s34, s34, s41
    s_add_u32 m0, s39, 32768
    s_add_u32 s38, s33, 0
    buffer_load_dwordx4 v2, s[8:11], s38 offen  lds
    s_add_u32 m0, s39, 33792
    s_add_u32 s38, s33, 20480
    buffer_load_dwordx4 v2, s[8:11], s38 offen  lds
    s_add_u32 m0, s39, 34816
    s_add_u32 s38, s33, 40960
    buffer_load_dwordx4 v2, s[8:11], s38 offen  lds
    s_add_u32 m0, s39, 35840
    s_add_u32 s38, s33, 61440
    buffer_load_dwordx4 v2, s[8:11], s38 offen  lds
    s_add_u32 m0, s40, 32768
    buffer_load_dwordx4 v4, s[12:15], s34 offen lds
    s_add_u32 m0, s40, 33792
    buffer_load_dwordx4 v5, s[12:15], s34 offen lds
    s_add_u32 m0, s40, 34816
    buffer_load_dwordx4 v6, s[12:15], s34 offen lds
    s_add_u32 m0, s40, 35840
    buffer_load_dwordx4 v7, s[12:15], s34 offen lds
    s_add_u32 s33, s33, 64
    s_add_u32 s34, s34, s41
    s_add_u32 m0, s39, 65536
    s_add_u32 s38, s33, 0
    buffer_load_dwordx4 v2, s[8:11], s38 offen  lds
    s_add_u32 m0, s39, 66560
    s_add_u32 s38, s33, 20480
    buffer_load_dwordx4 v2, s[8:11], s38 offen  lds
    s_add_u32 m0, s39, 67584
    s_add_u32 s38, s33, 40960
    buffer_load_dwordx4 v2, s[8:11], s38 offen  lds
    s_add_u32 m0, s39, 68608
    s_add_u32 s38, s33, 61440
    buffer_load_dwordx4 v2, s[8:11], s38 offen  lds
    s_add_u32 m0, s40, 65536
    buffer_load_dwordx4 v4, s[12:15], s34 offen lds
    s_add_u32 m0, s40, 66560
    buffer_load_dwordx4 v5, s[12:15], s34 offen lds
    s_add_u32 m0, s40, 67584
    buffer_load_dwordx4 v6, s[12:15], s34 offen lds
    s_add_u32 m0, s40, 68608
    buffer_load_dwordx4 v7, s[12:15], s34 offen lds
    s_add_u32 s33, s33, 64
    s_add_u32 s34, s34, s41
    v_accvgpr_write_b32 a0, 0
    v_accvgpr_write_b32 a1, 0
    v_accvgpr_write_b32 a2, 0
    v_accvgpr_write_b32 a3, 0
    v_accvgpr_write_b32 a4, 0
    v_accvgpr_write_b32 a5, 0
    v_accvgpr_write_b32 a6, 0
    v_accvgpr_write_b32 a7, 0
    v_accvgpr_write_b32 a8, 0
    v_accvgpr_write_b32 a9, 0
    v_accvgpr_write_b32 a10, 0
    v_accvgpr_write_b32 a11, 0
    v_accvgpr_write_b32 a12, 0
    v_accvgpr_write_b32 a13, 0
    v_accvgpr_write_b32 a14, 0
    v_accvgpr_write_b32 a15, 0
    v_accvgpr_write_b32 a16, 0
    v_accvgpr_write_b32 a17, 0
    v_accvgpr_write_b32 a18, 0
    v_accvgpr_write_b32 a19, 0
    v_accvgpr_write_b32 a20, 0
    v_accvgpr_write_b32 a21, 0
    v_accvgpr_write_b32 a22, 0
    v_accvgpr_write_b32 a23, 0
    v_accvgpr_write_b32 a24, 0
    v_accvgpr_write_b32 a25, 0
    v_accvgpr_write_b32 a26, 0
    v_accvgpr_write_b32 a27, 0
    v_accvgpr_write_b32 a28, 0
    v_accvgpr_write_b32 a29, 0
    v_accvgpr_write_b32 a30, 0
    v_accvgpr_write_b32 a31, 0
    v_accvgpr_write_b32 a32, 0
    v_accvgpr_write_b32 a33, 0
    v_accvgpr_write_b32 a34, 0
    v_accvgpr_write_b32 a35, 0
    v_accvgpr_write_b32 a36, 0
    v_accvgpr_write_b32 a37, 0
    v_accvgpr_write_b32 a38, 0
    v_accvgpr_write_b32 a39, 0
    v_accvgpr_write_b32 a40, 0
    v_accvgpr_write_b32 a41, 0
    v_accvgpr_write_b32 a42, 0
    v_accvgpr_write_b32 a43, 0
    v_accvgpr_write_b32 a44, 0
    v_accvgpr_write_b32 a45, 0
    v_accvgpr_write_b32 a46, 0
    v_accvgpr_write_b32 a47, 0
    v_accvgpr_write_b32 a48, 0
    v_accvgpr_write_b32 a49, 0
    v_accvgpr_write_b32 a50, 0
    v_accvgpr_write_b32 a51, 0
    v_accvgpr_write_b32 a52, 0
    v_accvgpr_write_b32 a53, 0
    v_accvgpr_write_b32 a54, 0
    v_accvgpr_write_b32 a55, 0
    v_accvgpr_write_b32 a56, 0
    v_accvgpr_write_b32 a57, 0
    v_accvgpr_write_b32 a58, 0
    v_accvgpr_write_b32 a59, 0
    v_accvgpr_write_b32 a60, 0
    v_accvgpr_write_b32 a61, 0
    v_accvgpr_write_b32 a62, 0
    v_accvgpr_write_b32 a63, 0
    v_accvgpr_write_b32 a64, 0
    v_accvgpr_write_b32 a65, 0
    v_accvgpr_write_b32 a66, 0
    v_accvgpr_write_b32 a67, 0
    v_accvgpr_write_b32 a68, 0
    v_accvgpr_write_b32 a69, 0
    v_accvgpr_write_b32 a70, 0
    v_accvgpr_write_b32 a71, 0
    v_accvgpr_write_b32 a72, 0
    v_accvgpr_write_b32 a73, 0
    v_accvgpr_write_b32 a74, 0
    v_accvgpr_write_b32 a75, 0
    v_accvgpr_write_b32 a76, 0
    v_accvgpr_write_b32 a77, 0
    v_accvgpr_write_b32 a78, 0
    v_accvgpr_write_b32 a79, 0
    v_accvgpr_write_b32 a80, 0
    v_accvgpr_write_b32 a81, 0
    v_accvgpr_write_b32 a82, 0
    v_accvgpr_write_b32 a83, 0
    v_accvgpr_write_b32 a84, 0
    v_accvgpr_write_b32 a85, 0
    v_accvgpr_write_b32 a86, 0
    v_accvgpr_write_b32 a87, 0
    v_accvgpr_write_b32 a88, 0
    v_accvgpr_write_b32 a89, 0
    v_accvgpr_write_b32 a90, 0
    v_accvgpr_write_b32 a91, 0
    v_accvgpr_write_b32 a92, 0
    v_accvgpr_write_b32 a93, 0
    v_accvgpr_write_b32 a94, 0
    v_accvgpr_write_b32 a95, 0
    v_accvgpr_write_b32 a96, 0
    v_accvgpr_write_b32 a97, 0
    v_accvgpr_write_b32 a98, 0
    v_accvgpr_write_b32 a99, 0
    v_accvgpr_write_b32 a100, 0
    v_accvgpr_write_b32 a101, 0
    v_accvgpr_write_b32 a102, 0
    v_accvgpr_write_b32 a103, 0
    v_accvgpr_write_b32 a104, 0
    v_accvgpr_write_b32 a105, 0
    v_accvgpr_write_b32 a106, 0
    v_accvgpr_write_b32 a107, 0
    v_accvgpr_write_b32 a108, 0
    v_accvgpr_write_b32 a109, 0
    v_accvgpr_write_b32 a110, 0
    v_accvgpr_write_b32 a111, 0
    v_accvgpr_write_b32 a112, 0
    v_accvgpr_write_b32 a113, 0
    v_accvgpr_write_b32 a114, 0
    v_accvgpr_write_b32 a115, 0
    v_accvgpr_write_b32 a116, 0
    v_accvgpr_write_b32 a117, 0
    v_accvgpr_write_b32 a118, 0
    v_accvgpr_write_b32 a119, 0
    v_accvgpr_write_b32 a120, 0
    v_accvgpr_write_b32 a121, 0
    v_accvgpr_write_b32 a122, 0
    v_accvgpr_write_b32 a123, 0
    v_accvgpr_write_b32 a124, 0
    v_accvgpr_write_b32 a125, 0
    v_accvgpr_write_b32 a126, 0
    v_accvgpr_write_b32 a127, 0
    v_accvgpr_write_b32 a128, 0
    v_accvgpr_write_b32 a129, 0
    v_accvgpr_write_b32 a130, 0
    v_accvgpr_write_b32 a131, 0
    v_accvgpr_write_b32 a132, 0
    v_accvgpr_write_b32 a133, 0
    v_accvgpr_write_b32 a134, 0
    v_accvgpr_write_b32 a135, 0
    v_accvgpr_write_b32 a136, 0
    v_accvgpr_write_b32 a137, 0
    v_accvgpr_write_b32 a138, 0
    v_accvgpr_write_b32 a139, 0
    v_accvgpr_write_b32 a140, 0
    v_accvgpr_write_b32 a141, 0
    v_accvgpr_write_b32 a142, 0
    v_accvgpr_write_b32 a143, 0
    v_accvgpr_write_b32 a144, 0
    v_accvgpr_write_b32 a145, 0
    v_accvgpr_write_b32 a146, 0
    v_accvgpr_write_b32 a147, 0
    v_accvgpr_write_b32 a148, 0
    v_accvgpr_write_b32 a149, 0
    v_accvgpr_write_b32 a150, 0
    v_accvgpr_write_b32 a151, 0
    v_accvgpr_write_b32 a152, 0
    v_accvgpr_write_b32 a153, 0
    v_accvgpr_write_b32 a154, 0
    v_accvgpr_write_b32 a155, 0
    v_accvgpr_write_b32 a156, 0
    v_accvgpr_write_b32 a157, 0
    v_accvgpr_write_b32 a158, 0
    v_accvgpr_write_b32 a159, 0
    v_accvgpr_write_b32 a160, 0
    v_accvgpr_write_b32 a161, 0
    v_accvgpr_write_b32 a162, 0
    v_accvgpr_write_b32 a163, 0
    v_accvgpr_write_b32 a164, 0
    v_accvgpr_write_b32 a165, 0
    v_accvgpr_write_b32 a166, 0
    v_accvgpr_write_b32 a167, 0
    v_accvgpr_write_b32 a168, 0
    v_accvgpr_write_b32 a169, 0
    v_accvgpr_write_b32 a170, 0
    v_accvgpr_write_b32 a171, 0
    v_accvgpr_write_b32 a172, 0
    v_accvgpr_write_b32 a173, 0
    v_accvgpr_write_b32 a174, 0
    v_accvgpr_write_b32 a175, 0
    v_accvgpr_write_b32 a176, 0
    v_accvgpr_write_b32 a177, 0
    v_accvgpr_write_b32 a178, 0
    v_accvgpr_write_b32 a179, 0
    v_accvgpr_write_b32 a180, 0
    v_accvgpr_write_b32 a181, 0
    v_accvgpr_write_b32 a182, 0
    v_accvgpr_write_b32 a183, 0
    v_accvgpr_write_b32 a184, 0
    v_accvgpr_write_b32 a185, 0
    v_accvgpr_write_b32 a186, 0
    v_accvgpr_write_b32 a187, 0
    v_accvgpr_write_b32 a188, 0
    v_accvgpr_write_b32 a189, 0
    v_accvgpr_write_b32 a190, 0
    v_accvgpr_write_b32 a191, 0
    v_accvgpr_write_b32 a192, 0
    v_accvgpr_write_b32 a193, 0
    v_accvgpr_write_b32 a194, 0
    v_accvgpr_write_b32 a195, 0
    v_accvgpr_write_b32 a196, 0
    v_accvgpr_write_b32 a197, 0
    v_accvgpr_write_b32 a198, 0
    v_accvgpr_write_b32 a199, 0
    v_accvgpr_write_b32 a200, 0
    v_accvgpr_write_b32 a201, 0
    v_accvgpr_write_b32 a202, 0
    v_accvgpr_write_b32 a203, 0
    v_accvgpr_write_b32 a204, 0
    v_accvgpr_write_b32 a205, 0
    v_accvgpr_write_b32 a206, 0
    v_accvgpr_write_b32 a207, 0
    v_accvgpr_write_b32 a208, 0
    v_accvgpr_write_b32 a209, 0
    v_accvgpr_write_b32 a210, 0
    v_accvgpr_write_b32 a211, 0
    v_accvgpr_write_b32 a212, 0
    v_accvgpr_write_b32 a213, 0
    v_accvgpr_write_b32 a214, 0
    v_accvgpr_write_b32 a215, 0
    v_accvgpr_write_b32 a216, 0
    v_accvgpr_write_b32 a217, 0
    v_accvgpr_write_b32 a218, 0
    v_accvgpr_write_b32 a219, 0
    v_accvgpr_write_b32 a220, 0
    v_accvgpr_write_b32 a221, 0
    v_accvgpr_write_b32 a222, 0
    v_accvgpr_write_b32 a223, 0
    v_accvgpr_write_b32 a224, 0
    v_accvgpr_write_b32 a225, 0
    v_accvgpr_write_b32 a226, 0
    v_accvgpr_write_b32 a227, 0
    v_accvgpr_write_b32 a228, 0
    v_accvgpr_write_b32 a229, 0
    v_accvgpr_write_b32 a230, 0
    v_accvgpr_write_b32 a231, 0
    v_accvgpr_write_b32 a232, 0
    v_accvgpr_write_b32 a233, 0
    v_accvgpr_write_b32 a234, 0
    v_accvgpr_write_b32 a235, 0
    v_accvgpr_write_b32 a236, 0
    v_accvgpr_write_b32 a237, 0
    v_accvgpr_write_b32 a238, 0
    v_accvgpr_write_b32 a239, 0
    v_accvgpr_write_b32 a240, 0
    v_accvgpr_write_b32 a241, 0
    v_accvgpr_write_b32 a242, 0
    v_accvgpr_write_b32 a243, 0
    v_accvgpr_write_b32 a244, 0
    v_accvgpr_write_b32 a245, 0
    v_accvgpr_write_b32 a246, 0
    v_accvgpr_write_b32 a247, 0
    v_accvgpr_write_b32 a248, 0
    v_accvgpr_write_b32 a249, 0
    v_accvgpr_write_b32 a250, 0
    v_accvgpr_write_b32 a251, 0
    v_accvgpr_write_b32 a252, 0
    v_accvgpr_write_b32 a253, 0
    v_accvgpr_write_b32 a254, 0
    v_accvgpr_write_b32 a255, 0
    s_waitcnt vmcnt(16)
    s_barrier
    ds_read_b128 v[32:35], v10 offset:0
    ds_read_b128 v[36:39], v10 offset:2048
    ds_read_b128 v[40:43], v10 offset:4096
    ds_read_b128 v[44:47], v10 offset:6144
    ds_read_b64_tr_b16 v[48:49], v14 offset:0
    ds_read_b64_tr_b16 v[50:51], v14 offset:2048
    ds_read_b64_tr_b16 v[52:53], v16 offset:0
    ds_read_b64_tr_b16 v[54:55], v16 offset:2048
    ds_read_b64_tr_b16 v[56:57], v18 offset:0
    ds_read_b64_tr_b16 v[58:59], v18 offset:2048
    ds_read_b64_tr_b16 v[60:61], v20 offset:0
    ds_read_b64_tr_b16 v[62:63], v20 offset:2048
    s_mov_b32 s42, 0
G_8_loop:
    s_waitcnt lgkmcnt(0)
    v_mfma_f32_32x32x16_bf16 a[0:15], v[48:51], v[32:35], a[0:15]
    ds_read_b128 v[68:71], v12 offset:0
    v_mfma_f32_32x32x16_bf16 a[16:31], v[52:55], v[32:35], a[16:31]
    s_add_u32 m0, s39, 98304
    s_add_u32 s38, s33, 0
    buffer_load_dwordx4 v2, s[8:11], s38 offen  lds
    v_mfma_f32_32x32x16_bf16 a[32:47], v[56:59], v[32:35], a[32:47]
    ds_read_b128 v[72:75], v12 offset:2048
    v_mfma_f32_32x32x16_bf16 a[48:63], v[60:63], v[32:35], a[48:63]
    ds_read_b128 v[76:79], v12 offset:4096
    v_mfma_f32_32x32x16_bf16 a[64:79], v[48:51], v[36:39], a[64:79]
    ds_read_b128 v[80:83], v12 offset:6144
    v_mfma_f32_32x32x16_bf16 a[80:95], v[52:55], v[36:39], a[80:95]
    s_add_u32 m0, s39, 99328
    s_add_u32 s38, s33, 20480
    buffer_load_dwordx4 v2, s[8:11], s38 offen  lds
    v_mfma_f32_32x32x16_bf16 a[96:111], v[56:59], v[36:39], a[96:111]
    ds_read_b64_tr_b16 v[84:85], v14 offset:8192
    v_mfma_f32_32x32x16_bf16 a[112:127], v[60:63], v[36:39], a[112:127]
    ds_read_b64_tr_b16 v[86:87], v14 offset:10240
    v_mfma_f32_32x32x16_bf16 a[128:143], v[48:51], v[40:43], a[128:143]
    ds_read_b64_tr_b16 v[88:89], v16 offset:8192
    v_mfma_f32_32x32x16_bf16 a[144:159], v[52:55], v[40:43], a[144:159]
    s_add_u32 m0, s39, 100352
    s_add_u32 s38, s33, 40960
    buffer_load_dwordx4 v2, s[8:11], s38 offen  lds
    v_mfma_f32_32x32x16_bf16 a[160:175], v[56:59], v[40:43], a[160:175]
    ds_read_b64_tr_b16 v[90:91], v16 offset:10240
    v_mfma_f32_32x32x16_bf16 a[176:191], v[60:63], v[40:43], a[176:191]
    ds_read_b64_tr_b16 v[92:93], v18 offset:8192
    v_mfma_f32_32x32x16_bf16 a[192:207], v[48:51], v[44:47], a[192:207]
    ds_read_b64_tr_b16 v[94:95], v18 offset:10240
    v_mfma_f32_32x32x16_bf16 a[208:223], v[52:55], v[44:47], a[208:223]
    s_add_u32 m0, s39, 101376
    s_add_u32 s38, s33, 61440
    buffer_load_dwordx4 v2, s[8:11], s38 offen  lds
    v_mfma_f32_32x32x16_bf16 a[224:239], v[56:59], v[44:47], a[224:239]
    ds_read_b64_tr_b16 v[96:97], v20 offset:8192
    v_mfma_f32_32x32x16_bf16 a[240:255], v[60:63], v[44:47], a[240:255]
    ds_read_b64_tr_b16 v[98:99], v20 offset:10240
    s_waitcnt lgkmcnt(0)
    v_mfma_f32_32x32x16_bf16 a[0:15], v[84:87], v[68:71], a[0:15]
    v_mfma_f32_32x32x16_bf16 a[16:31], v[88:91], v[68:71], a[16:31]
    v_mfma_f32_32x32x16_bf16 a[32:47], v[92:95], v[68:71], a[32:47]
    s_waitcnt vmcnt(12)
    s_barrier
    v_mfma_f32_32x32x16_bf16 a[48:63], v[96:99], v[68:71], a[48:63]
    ds_read_b128 v[32:35], v10 offset:32768
    v_mfma_f32_32x32x16_bf16 a[64:79], v[84:87], v[72:75], a[64:79]
    s_add_u32 m0, s40, 98304
    buffer_load_dwordx4 v4, s[12:15], s34 offen lds
    v_mfma_f32_32x32x16_bf16 a[80:95], v[88:91], v[72:75], a[80:95]
    ds_read_b128 v[36:39], v10 offset:34816
    v_mfma_f32_32x32x16_bf16 a[96:111], v[92:95], v[72:75], a[96:111]
    ds_read_b128 v[40:43], v10 offset:36864
    v_mfma_f32_32x32x16_bf16 a[112:127], v[96:99], v[72:75], a[112:127]
    ds_read_b128 v[44:47], v10 offset:38912
    s_add_u32 m0, s40, 99328
    buffer_load_dwordx4 v5, s[12:15], s34 offen lds
    v_mfma_f32_32x32x16_bf16 a[128:143], v[84:87], v[76:79], a[128:143]
    ds_read_b64_tr_b16 v[48:49], v14 offset:32768
    v_mfma_f32_32x32x16_bf16 a[144:159], v[88:91], v[76:79], a[144:159]
    ds_read_b64_tr_b16 v[50:51], v14 offset:34816
    v_mfma_f32_32x32x16_bf16 a[160:175], v[92:95], v[76:79], a[160:175]
    ds_read_b64_tr_b16 v[52:53], v16 offset:32768
    v_mfma_f32_32x32x16_bf16 a[176:191], v[96:99], v[76:79], a[176:191]
    s_add_u32 m0, s40, 100352
    buffer_load_dwordx4 v6, s[12:15], s34 offen lds
    ds_read_b64_tr_b16 v[54:55], v16 offset:34816
    v_mfma_f32_32x32x16_bf16 a[192:207], v[84:87], v[80:83], a[192:207]
    ds_read_b64_tr_b16 v[56:57], v18 offset:32768
    v_mfma_f32_32x32x16_bf16 a[208:223], v[88:91], v[80:83], a[208:223]
    ds_read_b64_tr_b16 v[58:59], v18 offset:34816
    v_mfma_f32_32x32x16_bf16 a[224:239], v[92:95], v[80:83], a[224:239]
    s_add_u32 m0, s40, 101376
    buffer_load_dwordx4 v7, s[12:15], s34 offen lds
    v_mfma_f32_32x32x16_bf16 a[240:255], v[96:99], v[80:83], a[240:255]
    ds_read_b64_tr_b16 v[60:61], v20 offset:32768
    ds_read_b64_tr_b16 v[62:63], v20 offset:34816
    s_add_u32 s33, s33, 64
    s_add_u32 s34, s34, s41
    s_cmp_eq_u32 s42, 4
    s_cselect_b32 s10, 0, s10
    s_cselect_b32 s14, 0, s14
    s_waitcnt lgkmcnt(0)
    v_mfma_f32_32x32x16_bf16 a[0:15], v[48:51], v[32:35], a[0:15]
    ds_read_b128 v[68:71], v12 offset:32768
    v_mfma_f32_32x32x16_bf16 a[16:31], v[52:55], v[32:35], a[16:31]
    s_add_u32 m0, s39, 0
    s_add_u32 s38, s33, 0
    buffer_load_dwordx4 v2, s[8:11], s38 offen  lds
    v_mfma_f32_32x32x16_bf16 a[32:47], v[56:59], v[32:35], a[32:47]
    ds_read_b128 v[72:75], v12 offset:34816
    v_mfma_f32_32x32x16_bf16 a[48:63], v[60:63], v[32:35], a[48:63]
    ds_read_b128 v[76:79], v12 offset:36864
    v_mfma_f32_32x32x16_bf16 a[64:79], v[48:51], v[36:39], a[64:79]
    ds_read_b128 v[80:83], v12 offset:38912
    v_mfma_f32_32x32x16_bf16 a[80:95], v[52:55], v[36:39], a[80:95]
    s_add_u32 m0, s39, 1024
    s_add_u32 s38, s33, 20480
    buffer_load_dwordx4 v2, s[8:11], s38 offen  lds
    v_mfma_f32_32x32x16_bf16 a[96:111], v[56:59], v[36:39], a[96:111]
    ds_read_b64_tr_b16 v[84:85], v14 offset:40960
    v_mfma_f32_32x32x16_bf16 a[112:127], v[60:63], v[36:39], a[112:127]
    ds_read_b64_tr_b16 v[86:87], v14 offset:43008
    v_mfma_f32_32x32x16_bf16 a[128:143], v[48:51], v[40:43], a[128:143]
    ds_read_b64_tr_b16 v[88:89], v16 offset:40960
    v_mfma_f32_32x32x16_bf16 a[144:159], v[52:55], v[40:43], a[144:159]
    s_add_u32 m0, s39, 2048
    s_add_u32 s38, s33, 40960
    buffer_load_dwordx4 v2, s[8:11], s38 offen  lds
    v_mfma_f32_32x32x16_bf16 a[160:175], v[56:59], v[40:43], a[160:175]
    ds_read_b64_tr_b16 v[90:91], v16 offset:43008
    v_mfma_f32_32x32x16_bf16 a[176:191], v[60:63], v[40:43], a[176:191]
    ds_read_b64_tr_b16 v[92:93], v18 offset:40960
    v_mfma_f32_32x32x16_bf16 a[192:207], v[48:51], v[44:47], a[192:207]
    ds_read_b64_tr_b16 v[94:95], v18 offset:43008
    v_mfma_f32_32x32x16_bf16 a[208:223], v[52:55], v[44:47], a[208:223]
    s_add_u32 m0, s39, 3072
    s_add_u32 s38, s33, 61440
    buffer_load_dwordx4 v2, s[8:11], s38 offen  lds
    v_mfma_f32_32x32x16_bf16 a[224:239], v[56:59], v[44:47], a[224:239]
    ds_read_b64_tr_b16 v[96:97], v20 offset:40960
    v_mfma_f32_32x32x16_bf16 a[240:255], v[60:63], v[44:47], a[240:255]
    ds_read_b64_tr_b16 v[98:99], v20 offset:43008
    s_waitcnt lgkmcnt(0)
    v_mfma_f32_32x32x16_bf16 a[0:15], v[84:87], v[68:71], a[0:15]
    v_mfma_f32_32x32x16_bf16 a[16:31], v[88:91], v[68:71], a[16:31]
    v_mfma_f32_32x32x16_bf16 a[32:47], v[92:95], v[68:71], a[32:47]
    s_waitcnt vmcnt(12)
    s_barrier
    v_mfma_f32_32x32x16_bf16 a[48:63], v[96:99], v[68:71], a[48:63]
    ds_read_b128 v[32:35], v11 offset:0
    v_mfma_f32_32x32x16_bf16 a[64:79], v[84:87], v[72:75], a[64:79]
    s_add_u32 m0, s40, 0
    buffer_load_dwordx4 v4, s[12:15], s34 offen lds
    v_mfma_f32_32x32x16_bf16 a[80:95], v[88:91], v[72:75], a[80:95]
    ds_read_b128 v[36:39], v11 offset:2048
    v_mfma_f32_32x32x16_bf16 a[96:111], v[92:95], v[72:75], a[96:111]
    ds_read_b128 v[40:43], v11 offset:4096
    v_mfma_f32_32x32x16_bf16 a[112:127], v[96:99], v[72:75], a[112:127]
    ds_read_b128 v[44:47], v11 offset:6144
    s_add_u32 m0, s40, 1024
    buffer_load_dwordx4 v5, s[12:15], s34 offen lds
    v_mfma_f32_32x32x16_bf16 a[128:143], v[84:87], v[76:79], a[128:143]
    ds_read_b64_tr_b16 v[48:49], v15 offset:0
    v_mfma_f32_32x32x16_bf16 a[144:159], v[88:91], v[76:79], a[144:159]
    ds_read_b64_tr_b16 v[50:51], v15 offset:2048
    v_mfma_f32_32x32x16_bf16 a[160:175], v[92:95], v[76:79], a[160:175]
    ds_read_b64_tr_b16 v[52:53], v17 offset:0
    v_mfma_f32_32x32x16_bf16 a[176:191], v[96:99], v[76:79], a[176:191]
    s_add_u32 m0, s40, 2048
    buffer_load_dwordx4 v6, s[12:15], s34 offen lds
    ds_read_b64_tr_b16 v[54:55], v17 offset:2048
    v_mfma_f32_32x32x16_bf16 a[192:207], v[84:87], v[80:83], a[192:207]
    ds_read_b64_tr_b16 v[56:57], v19 offset:0
    v_mfma_f32_32x32x16_bf16 a[208:223], v[88:91], v[80:83], a[208:223]
    ds_read_b64_tr_b16 v[58:59], v19 offset:2048
    v_mfma_f32_32x32x16_bf16 a[224:239], v[92:95], v[80:83], a[224:239]
    s_add_u32 m0, s40, 3072
    buffer_load_dwordx4 v7, s[12:15], s34 offen lds
    v_mfma_f32_32x32x16_bf16 a[240:255], v[96:99], v[80:83], a[240:255]
    ds_read_b64_tr_b16 v[60:61], v21 offset:0
    ds_read_b64_tr_b16 v[62:63], v21 offset:2048
    s_add_u32 s33, s33, 64
    s_add_u32 s34, s34, s41
    s_waitcnt lgkmcnt(0)
    v_mfma_f32_32x32x16_bf16 a[0:15], v[48:51], v[32:35], a[0:15]
    ds_read_b128 v[68:71], v13 offset:0
    v_mfma_f32_32x32x16_bf16 a[16:31], v[52:55], v[32:35], a[16:31]
    s_add_u32 m0, s39, 32768
    s_add_u32 s38, s33, 0
    buffer_load_dwordx4 v2, s[8:11], s38 offen  lds
    v_mfma_f32_32x32x16_bf16 a[32:47], v[56:59], v[32:35], a[32:47]
    ds_read_b128 v[72:75], v13 offset:2048
    v_mfma_f32_32x32x16_bf16 a[48:63], v[60:63], v[32:35], a[48:63]
    ds_read_b128 v[76:79], v13 offset:4096
    v_mfma_f32_32x32x16_bf16 a[64:79], v[48:51], v[36:39], a[64:79]
    ds_read_b128 v[80:83], v13 offset:6144
    v_mfma_f32_32x32x16_bf16 a[80:95], v[52:55], v[36:39], a[80:95]
    s_add_u32 m0, s39, 33792
    s_add_u32 s38, s33, 20480
    buffer_load_dwordx4 v2, s[8:11], s38 offen  lds
    v_mfma_f32_32x32x16_bf16 a[96:111], v[56:59], v[36:39], a[96:111]
    ds_read_b64_tr_b16 v[84:85], v15 offset:8192
    v_mfma_f32_32x32x16_bf16 a[112:127], v[60:63], v[36:39], a[112:127]
    ds_read_b64_tr_b16 v[86:87], v15 offset:10240
    v_mfma_f32_32x32x16_bf16 a[128:143], v[48:51], v[40:43], a[128:143]
    ds_read_b64_tr_b16 v[88:89], v17 offset:8192
    v_mfma_f32_32x32x16_bf16 a[144:159], v[52:55], v[40:43], a[144:159]
    s_add_u32 m0, s39, 34816
    s_add_u32 s38, s33, 40960
    buffer_load_dwordx4 v2, s[8:11], s38 offen  lds
    v_mfma_f32_32x32x16_bf16 a[160:175], v[56:59], v[40:43], a[160:175]
    ds_read_b64_tr_b16 v[90:91], v17 offset:10240
    v_mfma_f32_32x32x16_bf16 a[176:191], v[60:63], v[40:43], a[176:191]
    ds_read_b64_tr_b16 v[92:93], v19 offset:8192
    v_mfma_f32_32x32x16_bf16 a[192:207], v[48:51], v[44:47], a[192:207]
    ds_read_b64_tr_b16 v[94:95], v19 offset:10240
    v_mfma_f32_32x32x16_bf16 a[208:223], v[52:55], v[44:47], a[208:223]
    s_add_u32 m0, s39, 35840
    s_add_u32 s38, s33, 61440
    buffer_load_dwordx4 v2, s[8:11], s38 offen  lds
    v_mfma_f32_32x32x16_bf16 a[224:239], v[56:59], v[44:47], a[224:239]
    ds_read_b64_tr_b16 v[96:97], v21 offset:8192
    v_mfma_f32_32x32x16_bf16 a[240:255], v[60:63], v[44:47], a[240:255]
    ds_read_b64_tr_b16 v[98:99], v21 offset:10240
    s_waitcnt lgkmcnt(0)
    v_mfma_f32_32x32x16_bf16 a[0:15], v[84:87], v[68:71], a[0:15]
    v_mfma_f32_32x32x16_bf16 a[16:31], v[88:91], v[68:71], a[16:31]
    v_mfma_f32_32x32x16_bf16 a[32:47], v[92:95], v[68:71], a[32:47]
    s_waitcnt vmcnt(12)
    s_barrier
    v_mfma_f32_32x32x16_bf16 a[48:63], v[96:99], v[68:71], a[48:63]
    ds_read_b128 v[32:35], v11 offset:32768
    v_mfma_f32_32x32x16_bf16 a[64:79], v[84:87], v[72:75], a[64:79]
    s_add_u32 m0, s40, 32768
    buffer_load_dwordx4 v4, s[12:15], s34 offen lds
    v_mfma_f32_32x32x16_bf16 a[80:95], v[88:91], v[72:75], a[80:95]
    ds_read_b128 v[36:39], v11 offset:34816
    v_mfma_f32_32x32x16_bf16 a[96:111], v[92:95], v[72:75], a[96:111]
    ds_read_b128 v[40:43], v11 offset:36864
    v_mfma_f32_32x32x16_bf16 a[112:127], v[96:99], v[72:75], a[112:127]
    ds_read_b128 v[44:47], v11 offset:38912
    s_add_u32 m0, s40, 33792
    buffer_load_dwordx4 v5, s[12:15], s34 offen lds
    v_mfma_f32_32x32x16_bf16 a[128:143], v[84:87], v[76:79], a[128:143]
    ds_read_b64_tr_b16 v[48:49], v15 offset:32768
    v_mfma_f32_32x32x16_bf16 a[144:159], v[88:91], v[76:79], a[144:159]
    ds_read_b64_tr_b16 v[50:51], v15 offset:34816
    v_mfma_f32_32x32x16_bf16 a[160:175], v[92:95], v[76:79], a[160:175]
    ds_read_b64_tr_b16 v[52:53], v17 offset:32768
    v_mfma_f32_32x32x16_bf16 a[176:191], v[96:99], v[76:79], a[176:191]
    s_add_u32 m0, s40, 34816
    buffer_load_dwordx4 v6, s[12:15], s34 offen lds
    ds_read_b64_tr_b16 v[54:55], v17 offset:34816
    v_mfma_f32_32x32x16_bf16 a[192:207], v[84:87], v[80:83], a[192:207]
    ds_read_b64_tr_b16 v[56:57], v19 offset:32768
    v_mfma_f32_32x32x16_bf16 a[208:223], v[88:91], v[80:83], a[208:223]
    ds_read_b64_tr_b16 v[58:59], v19 offset:34816
    v_mfma_f32_32x32x16_bf16 a[224:239], v[92:95], v[80:83], a[224:239]
    s_add_u32 m0, s40, 35840
    buffer_load_dwordx4 v7, s[12:15], s34 offen lds
    v_mfma_f32_32x32x16_bf16 a[240:255], v[96:99], v[80:83], a[240:255]
    ds_read_b64_tr_b16 v[60:61], v21 offset:32768
    ds_read_b64_tr_b16 v[62:63], v21 offset:34816
    s_add_u32 s33, s33, 64
    s_add_u32 s34, s34, s41
    s_waitcnt lgkmcnt(0)
    v_mfma_f32_32x32x16_bf16 a[0:15], v[48:51], v[32:35], a[0:15]
    ds_read_b128 v[68:71], v13 offset:32768
    v_mfma_f32_32x32x16_bf16 a[16:31], v[52:55], v[32:35], a[16:31]
    s_add_u32 m0, s39, 65536
    s_add_u32 s38, s33, 0
    buffer_load_dwordx4 v2, s[8:11], s38 offen  lds
    v_mfma_f32_32x32x16_bf16 a[32:47], v[56:59], v[32:35], a[32:47]
    ds_read_b128 v[72:75], v13 offset:34816
    v_mfma_f32_32x32x16_bf16 a[48:63], v[60:63], v[32:35], a[48:63]
    ds_read_b128 v[76:79], v13 offset:36864
    v_mfma_f32_32x32x16_bf16 a[64:79], v[48:51], v[36:39], a[64:79]
    ds_read_b128 v[80:83], v13 offset:38912
    v_mfma_f32_32x32x16_bf16 a[80:95], v[52:55], v[36:39], a[80:95]
    s_add_u32 m0, s39, 66560
    s_add_u32 s38, s33, 20480
    buffer_load_dwordx4 v2, s[8:11], s38 offen  lds
    v_mfma_f32_32x32x16_bf16 a[96:111], v[56:59], v[36:39], a[96:111]
    ds_read_b64_tr_b16 v[84:85], v15 offset:40960
    v_mfma_f32_32x32x16_bf16 a[112:127], v[60:63], v[36:39], a[112:127]
    ds_read_b64_tr_b16 v[86:87], v15 offset:43008
    v_mfma_f32_32x32x16_bf16 a[128:143], v[48:51], v[40:43], a[128:143]
    ds_read_b64_tr_b16 v[88:89], v17 offset:40960
    v_mfma_f32_32x32x16_bf16 a[144:159], v[52:55], v[40:43], a[144:159]
    s_add_u32 m0, s39, 67584
    s_add_u32 s38, s33, 40960
    buffer_load_dwordx4 v2, s[8:11], s38 offen  lds
    v_mfma_f32_32x32x16_bf16 a[160:175], v[56:59], v[40:43], a[160:175]
    ds_read_b64_tr_b16 v[90:91], v17 offset:43008
    v_mfma_f32_32x32x16_bf16 a[176:191], v[60:63], v[40:43], a[176:191]
    ds_read_b64_tr_b16 v[92:93], v19 offset:40960
    v_mfma_f32_32x32x16_bf16 a[192:207], v[48:51], v[44:47], a[192:207]
    ds_read_b64_tr_b16 v[94:95], v19 offset:43008
    v_mfma_f32_32x32x16_bf16 a[208:223], v[52:55], v[44:47], a[208:223]
    s_add_u32 m0, s39, 68608
    s_add_u32 s38, s33, 61440
    buffer_load_dwordx4 v2, s[8:11], s38 offen  lds
    v_mfma_f32_32x32x16_bf16 a[224:239], v[56:59], v[44:47], a[224:239]
    ds_read_b64_tr_b16 v[96:97], v21 offset:40960
    v_mfma_f32_32x32x16_bf16 a[240:255], v[60:63], v[44:47], a[240:255]
    ds_read_b64_tr_b16 v[98:99], v21 offset:43008
    s_waitcnt lgkmcnt(0)
    v_mfma_f32_32x32x16_bf16 a[0:15], v[84:87], v[68:71], a[0:15]
    v_mfma_f32_32x32x16_bf16 a[16:31], v[88:91], v[68:71], a[16:31]
    v_mfma_f32_32x32x16_bf16 a[32:47], v[92:95], v[68:71], a[32:47]
    s_waitcnt vmcnt(12)
    s_barrier
    v_mfma_f32_32x32x16_bf16 a[48:63], v[96:99], v[68:71], a[48:63]
    ds_read_b128 v[32:35], v10 offset:0
    v_mfma_f32_32x32x16_bf16 a[64:79], v[84:87], v[72:75], a[64:79]
    s_add_u32 m0, s40, 65536
    buffer_load_dwordx4 v4, s[12:15], s34 offen lds
    v_mfma_f32_32x32x16_bf16 a[80:95], v[88:91], v[72:75], a[80:95]
    ds_read_b128 v[36:39], v10 offset:2048
    v_mfma_f32_32x32x16_bf16 a[96:111], v[92:95], v[72:75], a[96:111]
    ds_read_b128 v[40:43], v10 offset:4096
    v_mfma_f32_32x32x16_bf16 a[112:127], v[96:99], v[72:75], a[112:127]
    ds_read_b128 v[44:47], v10 offset:6144
    s_add_u32 m0, s40, 66560
    buffer_load_dwordx4 v5, s[12:15], s34 offen lds
    v_mfma_f32_32x32x16_bf16 a[128:143], v[84:87], v[76:79], a[128:143]
    ds_read_b64_tr_b16 v[48:49], v14 offset:0
    v_mfma_f32_32x32x16_bf16 a[144:159], v[88:91], v[76:79], a[144:159]
    ds_read_b64_tr_b16 v[50:51], v14 offset:2048
    v_mfma_f32_32x32x16_bf16 a[160:175], v[92:95], v[76:79], a[160:175]
    ds_read_b64_tr_b16 v[52:53], v16 offset:0
    v_mfma_f32_32x32x16_bf16 a[176:191], v[96:99], v[76:79], a[176:191]
    s_add_u32 m0, s40, 67584
    buffer_load_dwordx4 v6, s[12:15], s34 offen lds
    ds_read_b64_tr_b16 v[54:55], v16 offset:2048
    v_mfma_f32_32x32x16_bf16 a[192:207], v[84:87], v[80:83], a[192:207]
    ds_read_b64_tr_b16 v[56:57], v18 offset:0
    v_mfma_f32_32x32x16_bf16 a[208:223], v[88:91], v[80:83], a[208:223]
    ds_read_b64_tr_b16 v[58:59], v18 offset:2048
    v_mfma_f32_32x32x16_bf16 a[224:239], v[92:95], v[80:83], a[224:239]
    s_add_u32 m0, s40, 68608
    buffer_load_dwordx4 v7, s[12:15], s34 offen lds
    v_mfma_f32_32x32x16_bf16 a[240:255], v[96:99], v[80:83], a[240:255]
    ds_read_b64_tr_b16 v[60:61], v20 offset:0
    ds_read_b64_tr_b16 v[62:63], v20 offset:2048
    s_add_u32 s33, s33, 64
    s_add_u32 s34, s34, s41
    s_add_u32 s42, s42, 1
    s_cmp_lt_u32 s42, 5
    s_cbranch_scc1 G_8_loop
    s_waitcnt vmcnt(0) lgkmcnt(0)
    s_nop 15
    s_nop 7
    s_barrier
    s_branch AP_7_epi
AP_7_v:
    s_mul_i32 s33, s4, 81920
    s_add_u32 s33, s33, s16
    s_lshl_b32 s37, s18, 3
    s_mul_i32 s34, s4, s37
    s_add_u32 s34, s34, s17
    s_mul_i32 s39, s4, 4096
    s_mul_i32 s40, s4, 4096
    s_add_u32 s40, s40, 16384
    s_lshl_b32 s41, s18, 5
    s_add_u32 m0, s39, 0
    s_add_u32 s38, s33, 0
    buffer_load_dwordx4 v2, s[8:11], s38 offen  lds
    s_add_u32 m0, s39, 1024
    s_add_u32 s38, s33, 20480
    buffer_load_dwordx4 v2, s[8:11], s38 offen  lds
    s_add_u32 m0, s39, 2048
    s_add_u32 s38, s33, 40960
    buffer_load_dwordx4 v2, s[8:11], s38 offen  lds
    s_add_u32 m0, s39, 3072
    s_add_u32 s38, s33, 61440
    buffer_load_dwordx4 v2, s[8:11], s38 offen  lds
    s_add_u32 m0, s40, 0
    buffer_load_dwordx4 v4, s[12:15], s34 offen lds
    s_add_u32 m0, s40, 1024
    buffer_load_dwordx4 v5, s[12:15], s34 offen lds
    s_add_u32 m0, s40, 2048
    buffer_load_dwordx4 v6, s[12:15], s34 offen lds
    s_add_u32 m0, s40, 3072
    buffer_load_dwordx4 v7, s[12:15], s34 offen lds
    s_add_u32 s33, s33, 64
    s_add_u32 s34, s34, s41
    s_add_u32 m0, s39, 32768
    s_add_u32 s38, s33, 0
    buffer_load_dwordx4 v2, s[8:11], s38 offen  lds
    s_add_u32 m0, s39, 33792
    s_add_u32 s38, s33, 20480
    buffer_load_dwordx4 v2, s[8:11], s38 offen  lds
    s_add_u32 m0, s39, 34816
    s_add_u32 s38, s33, 40960
    buffer_load_dwordx4 v2, s[8:11], s38 offen  lds
    s_add_u32 m0, s39, 35840
    s_add_u32 s38, s33, 61440
    buffer_load_dwordx4 v2, s[8:11], s38 offen  lds
    s_add_u32 m0, s40, 32768
    buffer_load_dwordx4 v4, s[12:15], s34 offen lds
    s_add_u32 m0, s40, 33792
    buffer_load_dwordx4 v5, s[12:15], s34 offen lds
    s_add_u32 m0, s40, 34816
    buffer_load_dwordx4 v6, s[12:15], s34 offen lds
    s_add_u32 m0, s40, 35840
    buffer_load_dwordx4 v7, s[12:15], s34 offen lds
    s_add_u32 s33, s33, 64
    s_add_u32 s34, s34, s41
    s_add_u32 m0, s39, 65536
    s_add_u32 s38, s33, 0
    buffer_load_dwordx4 v2, s[8:11], s38 offen  lds
    s_add_u32 m0, s39, 66560
    s_add_u32 s38, s33, 20480
    buffer_load_dwordx4 v2, s[8:11], s38 offen  lds
    s_add_u32 m0, s39, 67584
    s_add_u32 s38, s33, 40960
    buffer_load_dwordx4 v2, s[8:11], s38 offen  lds
    s_add_u32 m0, s39, 68608
    s_add_u32 s38, s33, 61440
    buffer_load_dwordx4 v2, s[8:11], s38 offen  lds
    s_add_u32 m0, s40, 65536
    buffer_load_dwordx4 v4, s[12:15], s34 offen lds
    s_add_u32 m0, s40, 66560
    buffer_load_dwordx4 v5, s[12:15], s34 offen lds
    s_add_u32 m0, s40, 67584
    buffer_load_dwordx4 v6, s[12:15], s34 offen lds
    s_add_u32 m0, s40, 68608
    buffer_load_dwordx4 v7, s[12:15], s34 offen lds
    s_add_u32 s33, s33, 64
    s_add_u32 s34, s34, s41
    v_accvgpr_write_b32 a0, 0
    v_accvgpr_write_b32 a1, 0
    v_accvgpr_write_b32 a2, 0
    v_accvgpr_write_b32 a3, 0
    v_accvgpr_write_b32 a4, 0
    v_accvgpr_write_b32 a5, 0
    v_accvgpr_write_b32 a6, 0
    v_accvgpr_write_b32 a7, 0
    v_accvgpr_write_b32 a8, 0
    v_accvgpr_write_b32 a9, 0
    v_accvgpr_write_b32 a10, 0
    v_accvgpr_write_b32 a11, 0
    v_accvgpr_write_b32 a12, 0
    v_accvgpr_write_b32 a13, 0
    v_accvgpr_write_b32 a14, 0
    v_accvgpr_write_b32 a15, 0
    v_accvgpr_write_b32 a16, 0
    v_accvgpr_write_b32 a17, 0
    v_accvgpr_write_b32 a18, 0
    v_accvgpr_write_b32 a19, 0
    v_accvgpr_write_b32 a20, 0
    v_accvgpr_write_b32 a21, 0
    v_accvgpr_write_b32 a22, 0
    v_accvgpr_write_b32 a23, 0
    v_accvgpr_write_b32 a24, 0
    v_accvgpr_write_b32 a25, 0
    v_accvgpr_write_b32 a26, 0
    v_accvgpr_write_b32 a27, 0
    v_accvgpr_write_b32 a28, 0
    v_accvgpr_write_b32 a29, 0
    v_accvgpr_write_b32 a30, 0
    v_accvgpr_write_b32 a31, 0
    v_accvgpr_write_b32 a32, 0
    v_accvgpr_write_b32 a33, 0
    v_accvgpr_write_b32 a34, 0
    v_accvgpr_write_b32 a35, 0
    v_accvgpr_write_b32 a36, 0
    v_accvgpr_write_b32 a37, 0
    v_accvgpr_write_b32 a38, 0
    v_accvgpr_write_b32 a39, 0
    v_accvgpr_write_b32 a40, 0
    v_accvgpr_write_b32 a41, 0
    v_accvgpr_write_b32 a42, 0
    v_accvgpr_write_b32 a43, 0
    v_accvgpr_write_b32 a44, 0
    v_accvgpr_write_b32 a45, 0
    v_accvgpr_write_b32 a46, 0
    v_accvgpr_write_b32 a47, 0
    v_accvgpr_write_b32 a48, 0
    v_accvgpr_write_b32 a49, 0
    v_accvgpr_write_b32 a50, 0
    v_accvgpr_write_b32 a51, 0
    v_accvgpr_write_b32 a52, 0
    v_accvgpr_write_b32 a53, 0
    v_accvgpr_write_b32 a54, 0
    v_accvgpr_write_b32 a55, 0
    v_accvgpr_write_b32 a56, 0
    v_accvgpr_write_b32 a57, 0
    v_accvgpr_write_b32 a58, 0
    v_accvgpr_write_b32 a59, 0
    v_accvgpr_write_b32 a60, 0
    v_accvgpr_write_b32 a61, 0
    v_accvgpr_write_b32 a62, 0
    v_accvgpr_write_b32 a63, 0
    v_accvgpr_write_b32 a64, 0
    v_accvgpr_write_b32 a65, 0
    v_accvgpr_write_b32 a66, 0
    v_accvgpr_write_b32 a67, 0
    v_accvgpr_write_b32 a68, 0
    v_accvgpr_write_b32 a69, 0
    v_accvgpr_write_b32 a70, 0
    v_accvgpr_write_b32 a71, 0
    v_accvgpr_write_b32 a72, 0
    v_accvgpr_write_b32 a73, 0
    v_accvgpr_write_b32 a74, 0
    v_accvgpr_write_b32 a75, 0
    v_accvgpr_write_b32 a76, 0
    v_accvgpr_write_b32 a77, 0
    v_accvgpr_write_b32 a78, 0
    v_accvgpr_write_b32 a79, 0
    v_accvgpr_write_b32 a80, 0
    v_accvgpr_write_b32 a81, 0
    v_accvgpr_write_b32 a82, 0
    v_accvgpr_write_b32 a83, 0
    v_accvgpr_write_b32 a84, 0
    v_accvgpr_write_b32 a85, 0
    v_accvgpr_write_b32 a86, 0
    v_accvgpr_write_b32 a87, 0
    v_accvgpr_write_b32 a88, 0
    v_accvgpr_write_b32 a89, 0
    v_accvgpr_write_b32 a90, 0
    v_accvgpr_write_b32 a91, 0
    v_accvgpr_write_b32 a92, 0
    v_accvgpr_write_b32 a93, 0
    v_accvgpr_write_b32 a94, 0
    v_accvgpr_write_b32 a95, 0
    v_accvgpr_write_b32 a96, 0
    v_accvgpr_write_b32 a97, 0
    v_accvgpr_write_b32 a98, 0
    v_accvgpr_write_b32 a99, 0
    v_accvgpr_write_b32 a100, 0
    v_accvgpr_write_b32 a101, 0
    v_accvgpr_write_b32 a102, 0
    v_accvgpr_write_b32 a103, 0
    v_accvgpr_write_b32 a104, 0
    v_accvgpr_write_b32 a105, 0
    v_accvgpr_write_b32 a106, 0
    v_accvgpr_write_b32 a107, 0
    v_accvgpr_write_b32 a108, 0
    v_accvgpr_write_b32 a109, 0
    v_accvgpr_write_b32 a110, 0
    v_accvgpr_write_b32 a111, 0
    v_accvgpr_write_b32 a112, 0
    v_accvgpr_write_b32 a113, 0
    v_accvgpr_write_b32 a114, 0
    v_accvgpr_write_b32 a115, 0
    v_accvgpr_write_b32 a116, 0
    v_accvgpr_write_b32 a117, 0
    v_accvgpr_write_b32 a118, 0
    v_accvgpr_write_b32 a119, 0
    v_accvgpr_write_b32 a120, 0
    v_accvgpr_write_b32 a121, 0
    v_accvgpr_write_b32 a122, 0
    v_accvgpr_write_b32 a123, 0
    v_accvgpr_write_b32 a124, 0
    v_accvgpr_write_b32 a125, 0
    v_accvgpr_write_b32 a126, 0
    v_accvgpr_write_b32 a127, 0
    v_accvgpr_write_b32 a128, 0
    v_accvgpr_write_b32 a129, 0
    v_accvgpr_write_b32 a130, 0
    v_accvgpr_write_b32 a131, 0
    v_accvgpr_write_b32 a132, 0
    v_accvgpr_write_b32 a133, 0
    v_accvgpr_write_b32 a134, 0
    v_accvgpr_write_b32 a135, 0
    v_accvgpr_write_b32 a136, 0
    v_accvgpr_write_b32 a137, 0
    v_accvgpr_write_b32 a138, 0
    v_accvgpr_write_b32 a139, 0
    v_accvgpr_write_b32 a140, 0
    v_accvgpr_write_b32 a141, 0
    v_accvgpr_write_b32 a142, 0
    v_accvgpr_write_b32 a143, 0
    v_accvgpr_write_b32 a144, 0
    v_accvgpr_write_b32 a145, 0
    v_accvgpr_write_b32 a146, 0
    v_accvgpr_write_b32 a147, 0
    v_accvgpr_write_b32 a148, 0
    v_accvgpr_write_b32 a149, 0
    v_accvgpr_write_b32 a150, 0
    v_accvgpr_write_b32 a151, 0
    v_accvgpr_write_b32 a152, 0
    v_accvgpr_write_b32 a153, 0
    v_accvgpr_write_b32 a154, 0
    v_accvgpr_write_b32 a155, 0
    v_accvgpr_write_b32 a156, 0
    v_accvgpr_write_b32 a157, 0
    v_accvgpr_write_b32 a158, 0
    v_accvgpr_write_b32 a159, 0
    v_accvgpr_write_b32 a160, 0
    v_accvgpr_write_b32 a161, 0
    v_accvgpr_write_b32 a162, 0
    v_accvgpr_write_b32 a163, 0
    v_accvgpr_write_b32 a164, 0
    v_accvgpr_write_b32 a165, 0
    v_accvgpr_write_b32 a166, 0
    v_accvgpr_write_b32 a167, 0
    v_accvgpr_write_b32 a168, 0
    v_accvgpr_write_b32 a169, 0
    v_accvgpr_write_b32 a170, 0
    v_accvgpr_write_b32 a171, 0
    v_accvgpr_write_b32 a172, 0
    v_accvgpr_write_b32 a173, 0
    v_accvgpr_write_b32 a174, 0
    v_accvgpr_write_b32 a175, 0
    v_accvgpr_write_b32 a176, 0
    v_accvgpr_write_b32 a177, 0
    v_accvgpr_write_b32 a178, 0
    v_accvgpr_write_b32 a179, 0
    v_accvgpr_write_b32 a180, 0
    v_accvgpr_write_b32 a181, 0
    v_accvgpr_write_b32 a182, 0
    v_accvgpr_write_b32 a183, 0
    v_accvgpr_write_b32 a184, 0
    v_accvgpr_write_b32 a185, 0
    v_accvgpr_write_b32 a186, 0
    v_accvgpr_write_b32 a187, 0
    v_accvgpr_write_b32 a188, 0
    v_accvgpr_write_b32 a189, 0
    v_accvgpr_write_b32 a190, 0
    v_accvgpr_write_b32 a191, 0
    v_accvgpr_write_b32 a192, 0
    v_accvgpr_write_b32 a193, 0
    v_accvgpr_write_b32 a194, 0
    v_accvgpr_write_b32 a195, 0
    v_accvgpr_write_b32 a196, 0
    v_accvgpr_write_b32 a197, 0
    v_accvgpr_write_b32 a198, 0
    v_accvgpr_write_b32 a199, 0
    v_accvgpr_write_b32 a200, 0
    v_accvgpr_write_b32 a201, 0
    v_accvgpr_write_b32 a202, 0
    v_accvgpr_write_b32 a203, 0
    v_accvgpr_write_b32 a204, 0
    v_accvgpr_write_b32 a205, 0
    v_accvgpr_write_b32 a206, 0
    v_accvgpr_write_b32 a207, 0
    v_accvgpr_write_b32 a208, 0
    v_accvgpr_write_b32 a209, 0
    v_accvgpr_write_b32 a210, 0
    v_accvgpr_write_b32 a211, 0
    v_accvgpr_write_b32 a212, 0
    v_accvgpr_write_b32 a213, 0
    v_accvgpr_write_b32 a214, 0
    v_accvgpr_write_b32 a215, 0
    v_accvgpr_write_b32 a216, 0
    v_accvgpr_write_b32 a217, 0
    v_accvgpr_write_b32 a218, 0
    v_accvgpr_write_b32 a219, 0
    v_accvgpr_write_b32 a220, 0
    v_accvgpr_write_b32 a221, 0
    v_accvgpr_write_b32 a222, 0
    v_accvgpr_write_b32 a223, 0
    v_accvgpr_write_b32 a224, 0
    v_accvgpr_write_b32 a225, 0
    v_accvgpr_write_b32 a226, 0
    v_accvgpr_write_b32 a227, 0
    v_accvgpr_write_b32 a228, 0
    v_accvgpr_write_b32 a229, 0
    v_accvgpr_write_b32 a230, 0
    v_accvgpr_write_b32 a231, 0
    v_accvgpr_write_b32 a232, 0
    v_accvgpr_write_b32 a233, 0
    v_accvgpr_write_b32 a234, 0
    v_accvgpr_write_b32 a235, 0
    v_accvgpr_write_b32 a236, 0
    v_accvgpr_write_b32 a237, 0
    v_accvgpr_write_b32 a238, 0
    v_accvgpr_write_b32 a239, 0
    v_accvgpr_write_b32 a240, 0
    v_accvgpr_write_b32 a241, 0
    v_accvgpr_write_b32 a242, 0
    v_accvgpr_write_b32 a243, 0
    v_accvgpr_write_b32 a244, 0
    v_accvgpr_write_b32 a245, 0
    v_accvgpr_write_b32 a246, 0
    v_accvgpr_write_b32 a247, 0
    v_accvgpr_write_b32 a248, 0
    v_accvgpr_write_b32 a249, 0
    v_accvgpr_write_b32 a250, 0
    v_accvgpr_write_b32 a251, 0
    v_accvgpr_write_b32 a252, 0
    v_accvgpr_write_b32 a253, 0
    v_accvgpr_write_b32 a254, 0
    v_accvgpr_write_b32 a255, 0
    s_waitcnt vmcnt(16)
    s_barrier
    ds_read_b128 v[32:35], v10 offset:0
    ds_read_b128 v[36:39], v10 offset:2048
    ds_read_b128 v[40:43], v10 offset:4096
    ds_read_b128 v[44:47], v10 offset:6144
    ds_read_b64_tr_b16 v[48:49], v14 offset:0
    ds_read_b64_tr_b16 v[50:51], v14 offset:2048
    ds_read_b64_tr_b16 v[52:53], v16 offset:0
    ds_read_b64_tr_b16 v[54:55], v16 offset:2048
    ds_read_b64_tr_b16 v[56:57], v18 offset:0
    ds_read_b64_tr_b16 v[58:59], v18 offset:2048
    ds_read_b64_tr_b16 v[60:61], v20 offset:0
    ds_read_b64_tr_b16 v[62:63], v20 offset:2048
    s_mov_b32 s42, 0
G_9_loop:
    s_waitcnt lgkmcnt(0)
    v_mfma_f32_32x32x16_bf16 a[0:15], v[32:35], v[48:51], a[0:15]
    ds_read_b128 v[68:71], v12 offset:0
    v_mfma_f32_32x32x16_bf16 a[16:31], v[32:35], v[52:55], a[16:31]
    s_add_u32 m0, s39, 98304
    s_add_u32 s38, s33, 0
    buffer_load_dwordx4 v2, s[8:11], s38 offen  lds
    v_mfma_f32_32x32x16_bf16 a[32:47], v[32:35], v[56:59], a[32:47]
    ds_read_b128 v[72:75], v12 offset:2048
    v_mfma_f32_32x32x16_bf16 a[48:63], v[32:35], v[60:63], a[48:63]
    ds_read_b128 v[76:79], v12 offset:4096
    v_mfma_f32_32x32x16_bf16 a[64:79], v[36:39], v[48:51], a[64:79]
    ds_read_b128 v[80:83], v12 offset:6144
    v_mfma_f32_32x32x16_bf16 a[80:95], v[36:39], v[52:55], a[80:95]
    s_add_u32 m0, s39, 99328
    s_add_u32 s38, s33, 20480
    buffer_load_dwordx4 v2, s[8:11], s38 offen  lds
    v_mfma_f32_32x32x16_bf16 a[96:111], v[36:39], v[56:59], a[96:111]
    ds_read_b64_tr_b16 v[84:85], v14 offset:8192
    v_mfma_f32_32x32x16_bf16 a[112:127], v[36:39], v[60:63], a[112:127]
    ds_read_b64_tr_b16 v[86:87], v14 offset:10240
    v_mfma_f32_32x32x16_bf16 a[128:143], v[40:43], v[48:51], a[128:143]
    ds_read_b64_tr_b16 v[88:89], v16 offset:8192
    v_mfma_f32_32x32x16_bf16 a[144:159], v[40:43], v[52:55], a[144:159]
    s_add_u32 m0, s39, 100352
    s_add_u32 s38, s33, 40960
    buffer_load_dwordx4 v2, s[8:11], s38 offen  lds
    v_mfma_f32_32x32x16_bf16 a[160:175], v[40:43], v[56:59], a[160:175]
    ds_read_b64_tr_b16 v[90:91], v16 offset:10240
    v_mfma_f32_32x32x16_bf16 a[176:191], v[40:43], v[60:63], a[176:191]
    ds_read_b64_tr_b16 v[92:93], v18 offset:8192
    v_mfma_f32_32x32x16_bf16 a[192:207], v[44:47], v[48:51], a[192:207]
    ds_read_b64_tr_b16 v[94:95], v18 offset:10240
    v_mfma_f32_32x32x16_bf16 a[208:223], v[44:47], v[52:55], a[208:223]
    s_add_u32 m0, s39, 101376
    s_add_u32 s38, s33, 61440
    buffer_load_dwordx4 v2, s[8:11], s38 offen  lds
    v_mfma_f32_32x32x16_bf16 a[224:239], v[44:47], v[56:59], a[224:239]
    ds_read_b64_tr_b16 v[96:97], v20 offset:8192
    v_mfma_f32_32x32x16_bf16 a[240:255], v[44:47], v[60:63], a[240:255]
    ds_read_b64_tr_b16 v[98:99], v20 offset:10240
    s_waitcnt lgkmcnt(0)
    v_mfma_f32_32x32x16_bf16 a[0:15], v[68:71], v[84:87], a[0:15]
    v_mfma_f32_32x32x16_bf16 a[16:31], v[68:71], v[88:91], a[16:31]
    v_mfma_f32_32x32x16_bf16 a[32:47], v[68:71], v[92:95], a[32:47]
    s_waitcnt vmcnt(12)
    s_barrier
    v_mfma_f32_32x32x16_bf16 a[48:63], v[68:71], v[96:99], a[48:63]
    ds_read_b128 v[32:35], v10 offset:32768
    v_mfma_f32_32x32x16_bf16 a[64:79], v[72:75], v[84:87], a[64:79]
    s_add_u32 m0, s40, 98304
    buffer_load_dwordx4 v4, s[12:15], s34 offen lds
    v_mfma_f32_32x32x16_bf16 a[80:95], v[72:75], v[88:91], a[80:95]
    ds_read_b128 v[36:39], v10 offset:34816
    v_mfma_f32_32x32x16_bf16 a[96:111], v[72:75], v[92:95], a[96:111]
    ds_read_b128 v[40:43], v10 offset:36864
    v_mfma_f32_32x32x16_bf16 a[112:127], v[72:75], v[96:99], a[112:127]
    ds_read_b128 v[44:47], v10 offset:38912
    s_add_u32 m0, s40, 99328
    buffer_load_dwordx4 v5, s[12:15], s34 offen lds
    v_mfma_f32_32x32x16_bf16 a[128:143], v[76:79], v[84:87], a[128:143]
    ds_read_b64_tr_b16 v[48:49], v14 offset:32768
    v_mfma_f32_32x32x16_bf16 a[144:159], v[76:79], v[88:91], a[144:159]
    ds_read_b64_tr_b16 v[50:51], v14 offset:34816
    v_mfma_f32_32x32x16_bf16 a[160:175], v[76:79], v[92:95], a[160:175]
    ds_read_b64_tr_b16 v[52:53], v16 offset:32768
    v_mfma_f32_32x32x16_bf16 a[176:191], v[76:79], v[96:99], a[176:191]
    s_add_u32 m0, s40, 100352
    buffer_load_dwordx4 v6, s[12:15], s34 offen lds
    ds_read_b64_tr_b16 v[54:55], v16 offset:34816
    v_mfma_f32_32x32x16_bf16 a[192:207], v[80:83], v[84:87], a[192:207]
    ds_read_b64_tr_b16 v[56:57], v18 offset:32768
    v_mfma_f32_32x32x16_bf16 a[208:223], v[80:83], v[88:91], a[208:223]
    ds_read_b64_tr_b16 v[58:59], v18 offset:34816
    v_mfma_f32_32x32x16_bf16 a[224:239], v[80:83], v[92:95], a[224:239]
    s_add_u32 m0, s40, 101376
    buffer_load_dwordx4 v7, s[12:15], s34 offen lds
    v_mfma_f32_32x32x16_bf16 a[240:255], v[80:83], v[96:99], a[240:255]
    ds_read_b64_tr_b16 v[60:61], v20 offset:32768
    ds_read_b64_tr_b16 v[62:63], v20 offset:34816
    s_add_u32 s33, s33, 64
    s_add_u32 s34, s34, s41
    s_cmp_eq_u32 s42, 4
    s_cselect_b32 s10, 0, s10
    s_cselect_b32 s14, 0, s14
    s_waitcnt lgkmcnt(0)
    v_mfma_f32_32x32x16_bf16 a[0:15], v[32:35], v[48:51], a[0:15]
    ds_read_b128 v[68:71], v12 offset:32768
    v_mfma_f32_32x32x16_bf16 a[16:31], v[32:35], v[52:55], a[16:31]
    s_add_u32 m0, s39, 0
    s_add_u32 s38, s33, 0
    buffer_load_dwordx4 v2, s[8:11], s38 offen  lds
    v_mfma_f32_32x32x16_bf16 a[32:47], v[32:35], v[56:59], a[32:47]
    ds_read_b128 v[72:75], v12 offset:34816
    v_mfma_f32_32x32x16_bf16 a[48:63], v[32:35], v[60:63], a[48:63]
    ds_read_b128 v[76:79], v12 offset:36864
    v_mfma_f32_32x32x16_bf16 a[64:79], v[36:39], v[48:51], a[64:79]
    ds_read_b128 v[80:83], v12 offset:38912
    v_mfma_f32_32x32x16_bf16 a[80:95], v[36:39], v[52:55], a[80:95]
    s_add_u32 m0, s39, 1024
    s_add_u32 s38, s33, 20480
    buffer_load_dwordx4 v2, s[8:11], s38 offen  lds
    v_mfma_f32_32x32x16_bf16 a[96:111], v[36:39], v[56:59], a[96:111]
    ds_read_b64_tr_b16 v[84:85], v14 offset:40960
    v_mfma_f32_32x32x16_bf16 a[112:127], v[36:39], v[60:63], a[112:127]
    ds_read_b64_tr_b16 v[86:87], v14 offset:43008
    v_mfma_f32_32x32x16_bf16 a[128:143], v[40:43], v[48:51], a[128:143]
    ds_read_b64_tr_b16 v[88:89], v16 offset:40960
    v_mfma_f32_32x32x16_bf16 a[144:159], v[40:43], v[52:55], a[144:159]
    s_add_u32 m0, s39, 2048
    s_add_u32 s38, s33, 40960
    buffer_load_dwordx4 v2, s[8:11], s38 offen  lds
    v_mfma_f32_32x32x16_bf16 a[160:175], v[40:43], v[56:59], a[160:175]
    ds_read_b64_tr_b16 v[90:91], v16 offset:43008
    v_mfma_f32_32x32x16_bf16 a[176:191], v[40:43], v[60:63], a[176:191]
    ds_read_b64_tr_b16 v[92:93], v18 offset:40960
    v_mfma_f32_32x32x16_bf16 a[192:207], v[44:47], v[48:51], a[192:207]
    ds_read_b64_tr_b16 v[94:95], v18 offset:43008
    v_mfma_f32_32x32x16_bf16 a[208:223], v[44:47], v[52:55], a[208:223]
    s_add_u32 m0, s39, 3072
    s_add_u32 s38, s33, 61440
    buffer_load_dwordx4 v2, s[8:11], s38 offen  lds
    v_mfma_f32_32x32x16_bf16 a[224:239], v[44:47], v[56:59], a[224:239]
    ds_read_b64_tr_b16 v[96:97], v20 offset:40960
    v_mfma_f32_32x32x16_bf16 a[240:255], v[44:47], v[60:63], a[240:255]
    ds_read_b64_tr_b16 v[98:99], v20 offset:43008
    s_waitcnt lgkmcnt(0)
    v_mfma_f32_32x32x16_bf16 a[0:15], v[68:71], v[84:87], a[0:15]
    v_mfma_f32_32x32x16_bf16 a[16:31], v[68:71], v[88:91], a[16:31]
    v_mfma_f32_32x32x16_bf16 a[32:47], v[68:71], v[92:95], a[32:47]
    s_waitcnt vmcnt(12)
    s_barrier
    v_mfma_f32_32x32x16_bf16 a[48:63], v[68:71], v[96:99], a[48:63]
    ds_read_b128 v[32:35], v11 offset:0
    v_mfma_f32_32x32x16_bf16 a[64:79], v[72:75], v[84:87], a[64:79]
    s_add_u32 m0, s40, 0
    buffer_load_dwordx4 v4, s[12:15], s34 offen lds
    v_mfma_f32_32x32x16_bf16 a[80:95], v[72:75], v[88:91], a[80:95]
    ds_read_b128 v[36:39], v11 offset:2048
    v_mfma_f32_32x32x16_bf16 a[96:111], v[72:75], v[92:95], a[96:111]
    ds_read_b128 v[40:43], v11 offset:4096
    v_mfma_f32_32x32x16_bf16 a[112:127], v[72:75], v[96:99], a[112:127]
    ds_read_b128 v[44:47], v11 offset:6144
    s_add_u32 m0, s40, 1024
    buffer_load_dwordx4 v5, s[12:15], s34 offen lds
    v_mfma_f32_32x32x16_bf16 a[128:143], v[76:79], v[84:87], a[128:143]
    ds_read_b64_tr_b16 v[48:49], v15 offset:0
    v_mfma_f32_32x32x16_bf16 a[144:159], v[76:79], v[88:91], a[144:159]
    ds_read_b64_tr_b16 v[50:51], v15 offset:2048
    v_mfma_f32_32x32x16_bf16 a[160:175], v[76:79], v[92:95], a[160:175]
    ds_read_b64_tr_b16 v[52:53], v17 offset:0
    v_mfma_f32_32x32x16_bf16 a[176:191], v[76:79], v[96:99], a[176:191]
    s_add_u32 m0, s40, 2048
    buffer_load_dwordx4 v6, s[12:15], s34 offen lds
    ds_read_b64_tr_b16 v[54:55], v17 offset:2048
    v_mfma_f32_32x32x16_bf16 a[192:207], v[80:83], v[84:87], a[192:207]
    ds_read_b64_tr_b16 v[56:57], v19 offset:0
    v_mfma_f32_32x32x16_bf16 a[208:223], v[80:83], v[88:91], a[208:223]
    ds_read_b64_tr_b16 v[58:59], v19 offset:2048
    v_mfma_f32_32x32x16_bf16 a[224:239], v[80:83], v[92:95], a[224:239]
    s_add_u32 m0, s40, 3072
    buffer_load_dwordx4 v7, s[12:15], s34 offen lds
    v_mfma_f32_32x32x16_bf16 a[240:255], v[80:83], v[96:99], a[240:255]
    ds_read_b64_tr_b16 v[60:61], v21 offset:0
    ds_read_b64_tr_b16 v[62:63], v21 offset:2048
    s_add_u32 s33, s33, 64
    s_add_u32 s34, s34, s41
    s_waitcnt lgkmcnt(0)
    v_mfma_f32_32x32x16_bf16 a[0:15], v[32:35], v[48:51], a[0:15]
    ds_read_b128 v[68:71], v13 offset:0
    v_mfma_f32_32x32x16_bf16 a[16:31], v[32:35], v[52:55], a[16:31]
    s_add_u32 m0, s39, 32768
    s_add_u32 s38, s33, 0
    buffer_load_dwordx4 v2, s[8:11], s38 offen  lds
    v_mfma_f32_32x32x16_bf16 a[32:47], v[32:35], v[56:59], a[32:47]
    ds_read_b128 v[72:75], v13 offset:2048
    v_mfma_f32_32x32x16_bf16 a[48:63], v[32:35], v[60:63], a[48:63]
    ds_read_b128 v[76:79], v13 offset:4096
    v_mfma_f32_32x32x16_bf16 a[64:79], v[36:39], v[48:51], a[64:79]
    ds_read_b128 v[80:83], v13 offset:6144
    v_mfma_f32_32x32x16_bf16 a[80:95], v[36:39], v[52:55], a[80:95]
    s_add_u32 m0, s39, 33792
    s_add_u32 s38, s33, 20480
    buffer_load_dwordx4 v2, s[8:11], s38 offen  lds
    v_mfma_f32_32x32x16_bf16 a[96:111], v[36:39], v[56:59], a[96:111]
    ds_read_b64_tr_b16 v[84:85], v15 offset:8192
    v_mfma_f32_32x32x16_bf16 a[112:127], v[36:39], v[60:63], a[112:127]
    ds_read_b64_tr_b16 v[86:87], v15 offset:10240
    v_mfma_f32_32x32x16_bf16 a[128:143], v[40:43], v[48:51], a[128:143]
    ds_read_b64_tr_b16 v[88:89], v17 offset:8192
    v_mfma_f32_32x32x16_bf16 a[144:159], v[40:43], v[52:55], a[144:159]
    s_add_u32 m0, s39, 34816
    s_add_u32 s38, s33, 40960
    buffer_load_dwordx4 v2, s[8:11], s38 offen  lds
    v_mfma_f32_32x32x16_bf16 a[160:175], v[40:43], v[56:59], a[160:175]
    ds_read_b64_tr_b16 v[90:91], v17 offset:10240
    v_mfma_f32_32x32x16_bf16 a[176:191], v[40:43], v[60:63], a[176:191]
    ds_read_b64_tr_b16 v[92:93], v19 offset:8192
    v_mfma_f32_32x32x16_bf16 a[192:207], v[44:47], v[48:51], a[192:207]
    ds_read_b64_tr_b16 v[94:95], v19 offset:10240
    v_mfma_f32_32x32x16_bf16 a[208:223], v[44:47], v[52:55], a[208:223]
    s_add_u32 m0, s39, 35840
    s_add_u32 s38, s33, 61440
    buffer_load_dwordx4 v2, s[8:11], s38 offen  lds
    v_mfma_f32_32x32x16_bf16 a[224:239], v[44:47], v[56:59], a[224:239]
    ds_read_b64_tr_b16 v[96:97], v21 offset:8192
    v_mfma_f32_32x32x16_bf16 a[240:255], v[44:47], v[60:63], a[240:255]
    ds_read_b64_tr_b16 v[98:99], v21 offset:10240
    s_waitcnt lgkmcnt(0)
    v_mfma_f32_32x32x16_bf16 a[0:15], v[68:71], v[84:87], a[0:15]
    v_mfma_f32_32x32x16_bf16 a[16:31], v[68:71], v[88:91], a[16:31]
    v_mfma_f32_32x32x16_bf16 a[32:47], v[68:71], v[92:95], a[32:47]
    s_waitcnt vmcnt(12)
    s_barrier
    v_mfma_f32_32x32x16_bf16 a[48:63], v[68:71], v[96:99], a[48:63]
    ds_read_b128 v[32:35], v11 offset:32768
    v_mfma_f32_32x32x16_bf16 a[64:79], v[72:75], v[84:87], a[64:79]
    s_add_u32 m0, s40, 32768
    buffer_load_dwordx4 v4, s[12:15], s34 offen lds
    v_mfma_f32_32x32x16_bf16 a[80:95], v[72:75], v[88:91], a[80:95]
    ds_read_b128 v[36:39], v11 offset:34816
    v_mfma_f32_32x32x16_bf16 a[96:111], v[72:75], v[92:95], a[96:111]
    ds_read_b128 v[40:43], v11 offset:36864
    v_mfma_f32_32x32x16_bf16 a[112:127], v[72:75], v[96:99], a[112:127]
    ds_read_b128 v[44:47], v11 offset:38912
    s_add_u32 m0, s40, 33792
    buffer_load_dwordx4 v5, s[12:15], s34 offen lds
    v_mfma_f32_32x32x16_bf16 a[128:143], v[76:79], v[84:87], a[128:143]
    ds_read_b64_tr_b16 v[48:49], v15 offset:32768
    v_mfma_f32_32x32x16_bf16 a[144:159], v[76:79], v[88:91], a[144:159]
    ds_read_b64_tr_b16 v[50:51], v15 offset:34816
    v_mfma_f32_32x32x16_bf16 a[160:175], v[76:79], v[92:95], a[160:175]
    ds_read_b64_tr_b16 v[52:53], v17 offset:32768
    v_mfma_f32_32x32x16_bf16 a[176:191], v[76:79], v[96:99], a[176:191]
    s_add_u32 m0, s40, 34816
    buffer_load_dwordx4 v6, s[12:15], s34 offen lds
    ds_read_b64_tr_b16 v[54:55], v17 offset:34816
    v_mfma_f32_32x32x16_bf16 a[192:207], v[80:83], v[84:87], a[192:207]
    ds_read_b64_tr_b16 v[56:57], v19 offset:32768
    v_mfma_f32_32x32x16_bf16 a[208:223], v[80:83], v[88:91], a[208:223]
    ds_read_b64_tr_b16 v[58:59], v19 offset:34816
    v_mfma_f32_32x32x16_bf16 a[224:239], v[80:83], v[92:95], a[224:239]
    s_add_u32 m0, s40, 35840
    buffer_load_dwordx4 v7, s[12:15], s34 offen lds
    v_mfma_f32_32x32x16_bf16 a[240:255], v[80:83], v[96:99], a[240:255]
    ds_read_b64_tr_b16 v[60:61], v21 offset:32768
    ds_read_b64_tr_b16 v[62:63], v21 offset:34816
    s_add_u32 s33, s33, 64
    s_add_u32 s34, s34, s41
    s_waitcnt lgkmcnt(0)
    v_mfma_f32_32x32x16_bf16 a[0:15], v[32:35], v[48:51], a[0:15]
    ds_read_b128 v[68:71], v13 offset:32768
    v_mfma_f32_32x32x16_bf16 a[16:31], v[32:35], v[52:55], a[16:31]
    s_add_u32 m0, s39, 65536
    s_add_u32 s38, s33, 0
    buffer_load_dwordx4 v2, s[8:11], s38 offen  lds
    v_mfma_f32_32x32x16_bf16 a[32:47], v[32:35], v[56:59], a[32:47]
    ds_read_b128 v[72:75], v13 offset:34816
    v_mfma_f32_32x32x16_bf16 a[48:63], v[32:35], v[60:63], a[48:63]
    ds_read_b128 v[76:79], v13 offset:36864
    v_mfma_f32_32x32x16_bf16 a[64:79], v[36:39], v[48:51], a[64:79]
    ds_read_b128 v[80:83], v13 offset:38912
    v_mfma_f32_32x32x16_bf16 a[80:95], v[36:39], v[52:55], a[80:95]
    s_add_u32 m0, s39, 66560
    s_add_u32 s38, s33, 20480
    buffer_load_dwordx4 v2, s[8:11], s38 offen  lds
    v_mfma_f32_32x32x16_bf16 a[96:111], v[36:39], v[56:59], a[96:111]
    ds_read_b64_tr_b16 v[84:85], v15 offset:40960
    v_mfma_f32_32x32x16_bf16 a[112:127], v[36:39], v[60:63], a[112:127]
    ds_read_b64_tr_b16 v[86:87], v15 offset:43008
    v_mfma_f32_32x32x16_bf16 a[128:143], v[40:43], v[48:51], a[128:143]
    ds_read_b64_tr_b16 v[88:89], v17 offset:40960
    v_mfma_f32_32x32x16_bf16 a[144:159], v[40:43], v[52:55], a[144:159]
    s_add_u32 m0, s39, 67584
    s_add_u32 s38, s33, 40960
    buffer_load_dwordx4 v2, s[8:11], s38 offen  lds
    v_mfma_f32_32x32x16_bf16 a[160:175], v[40:43], v[56:59], a[160:175]
    ds_read_b64_tr_b16 v[90:91], v17 offset:43008
    v_mfma_f32_32x32x16_bf16 a[176:191], v[40:43], v[60:63], a[176:191]
    ds_read_b64_tr_b16 v[92:93], v19 offset:40960
    v_mfma_f32_32x32x16_bf16 a[192:207], v[44:47], v[48:51], a[192:207]
    ds_read_b64_tr_b16 v[94:95], v19 offset:43008
    v_mfma_f32_32x32x16_bf16 a[208:223], v[44:47], v[52:55], a[208:223]
    s_add_u32 m0, s39, 68608
    s_add_u32 s38, s33, 61440
    buffer_load_dwordx4 v2, s[8:11], s38 offen  lds
    v_mfma_f32_32x32x16_bf16 a[224:239], v[44:47], v[56:59], a[224:239]
    ds_read_b64_tr_b16 v[96:97], v21 offset:40960
    v_mfma_f32_32x32x16_bf16 a[240:255], v[44:47], v[60:63], a[240:255]
    ds_read_b64_tr_b16 v[98:99], v21 offset:43008
    s_waitcnt lgkmcnt(0)
    v_mfma_f32_32x32x16_bf16 a[0:15], v[68:71], v[84:87], a[0:15]
    v_mfma_f32_32x32x16_bf16 a[16:31], v[68:71], v[88:91], a[16:31]
    v_mfma_f32_32x32x16_bf16 a[32:47], v[68:71], v[92:95], a[32:47]
    s_waitcnt vmcnt(12)
    s_barrier
    v_mfma_f32_32x32x16_bf16 a[48:63], v[68:71], v[96:99], a[48:63]
    ds_read_b128 v[32:35], v10 offset:0
    v_mfma_f32_32x32x16_bf16 a[64:79], v[72:75], v[84:87], a[64:79]
    s_add_u32 m0, s40, 65536
    buffer_load_dwordx4 v4, s[12:15], s34 offen lds
    v_mfma_f32_32x32x16_bf16 a[80:95], v[72:75], v[88:91], a[80:95]
    ds_read_b128 v[36:39], v10 offset:2048
    v_mfma_f32_32x32x16_bf16 a[96:111], v[72:75], v[92:95], a[96:111]
    ds_read_b128 v[40:43], v10 offset:4096
    v_mfma_f32_32x32x16_bf16 a[112:127], v[72:75], v[96:99], a[112:127]
    ds_read_b128 v[44:47], v10 offset:6144
    s_add_u32 m0, s40, 66560
    buffer_load_dwordx4 v5, s[12:15], s34 offen lds
    v_mfma_f32_32x32x16_bf16 a[128:143], v[76:79], v[84:87], a[128:143]
    ds_read_b64_tr_b16 v[48:49], v14 offset:0
    v_mfma_f32_32x32x16_bf16 a[144:159], v[76:79], v[88:91], a[144:159]
    ds_read_b64_tr_b16 v[50:51], v14 offset:2048
    v_mfma_f32_32x32x16_bf16 a[160:175], v[76:79], v[92:95], a[160:175]
    ds_read_b64_tr_b16 v[52:53], v16 offset:0
    v_mfma_f32_32x32x16_bf16 a[176:191], v[76:79], v[96:99], a[176:191]
    s_add_u32 m0, s40, 67584
    buffer_load_dwordx4 v6, s[12:15], s34 offen lds
    ds_read_b64_tr_b16 v[54:55], v16 offset:2048
    v_mfma_f32_32x32x16_bf16 a[192:207], v[80:83], v[84:87], a[192:207]
    ds_read_b64_tr_b16 v[56:57], v18 offset:0
    v_mfma_f32_32x32x16_bf16 a[208:223], v[80:83], v[88:91], a[208:223]
    ds_read_b64_tr_b16 v[58:59], v18 offset:2048
    v_mfma_f32_32x32x16_bf16 a[224:239], v[80:83], v[92:95], a[224:239]
    s_add_u32 m0, s40, 68608
    buffer_load_dwordx4 v7, s[12:15], s34 offen lds
    v_mfma_f32_32x32x16_bf16 a[240:255], v[80:83], v[96:99], a[240:255]
    ds_read_b64_tr_b16 v[60:61], v20 offset:0
    ds_read_b64_tr_b16 v[62:63], v20 offset:2048
    s_add_u32 s33, s33, 64
    s_add_u32 s34, s34, s41
    s_add_u32 s42, s42, 1
    s_cmp_lt_u32 s42, 5
    s_cbranch_scc1 G_9_loop
    s_waitcnt vmcnt(0) lgkmcnt(0)
    s_nop 15
    s_nop 7
    s_barrier
AP_7_epi:
    s_and_b32 s30, s4, 1
    s_mul_i32 s30, s30, 1048576
    s_lshr_b32 s31, s4, 1
    s_lshl_b32 s31, s31, 13
    s_add_u32 s30, s30, s31
    s_add_u32 s30, s30, s24
    v_and_b32 v1, 63, v0
    v_lshlrev_b32 v2, 4, v1
    v_accvgpr_read_b32 v104, a0
    v_accvgpr_read_b32 v105, a1
    v_accvgpr_read_b32 v106, a2
    v_accvgpr_read_b32 v107, a3
    v_accvgpr_read_b32 v108, a4
    v_accvgpr_read_b32 v109, a5
    v_accvgpr_read_b32 v110, a6
    v_accvgpr_read_b32 v111, a7
    v_accvgpr_read_b32 v112, a8
    v_accvgpr_read_b32 v113, a9
    v_accvgpr_read_b32 v114, a10
    v_accvgpr_read_b32 v115, a11
    v_accvgpr_read_b32 v116, a12
    v_accvgpr_read_b32 v117, a13
    v_accvgpr_read_b32 v118, a14
    v_accvgpr_read_b32 v119, a15
    v_cvt_pk_bf16_f32 v128, v104, v105
    v_cvt_pk_bf16_f32 v129, v106, v107
    v_cvt_pk_bf16_f32 v130, v108, v109
    v_cvt_pk_bf16_f32 v131, v110, v111
    v_cvt_pk_bf16_f32 v132, v112, v113
    v_cvt_pk_bf16_f32 v133, v114, v115
    v_cvt_pk_bf16_f32 v134, v116, v117
    v_cvt_pk_bf16_f32 v135, v118, v119
    s_add_u32 s31, s30, 0
    buffer_store_dwordx4 v[128:131], v2, s[20:23], s31 offen sc1
    buffer_store_dwordx4 v[132:135], v2, s[20:23], s31 offen offset:1024 sc1
    v_accvgpr_read_b32 v104, a16
    v_accvgpr_read_b32 v105, a17
    v_accvgpr_read_b32 v106, a18
    v_accvgpr_read_b32 v107, a19
    v_accvgpr_read_b32 v108, a20
    v_accvgpr_read_b32 v109, a21
    v_accvgpr_read_b32 v110, a22
    v_accvgpr_read_b32 v111, a23
    v_accvgpr_read_b32 v112, a24
    v_accvgpr_read_b32 v113, a25
    v_accvgpr_read_b32 v114, a26
    v_accvgpr_read_b32 v115, a27
    v_accvgpr_read_b32 v116, a28
    v_accvgpr_read_b32 v117, a29
    v_accvgpr_read_b32 v118, a30
    v_accvgpr_read_b32 v119, a31
    v_cvt_pk_bf16_f32 v136, v104, v105
    v_cvt_pk_bf16_f32 v137, v106, v107
    v_cvt_pk_bf16_f32 v138, v108, v109
    v_cvt_pk_bf16_f32 v139, v110, v111
    v_cvt_pk_bf16_f32 v140, v112, v113
    v_cvt_pk_bf16_f32 v141, v114, v115
    v_cvt_pk_bf16_f32 v142, v116, v117
    v_cvt_pk_bf16_f32 v143, v118, v119
    s_add_u32 s31, s30, 2048
    buffer_store_dwordx4 v[136:139], v2, s[20:23], s31 offen sc1
    buffer_store_dwordx4 v[140:143], v2, s[20:23], s31 offen offset:1024 sc1
    v_accvgpr_read_b32 v104, a32
    v_accvgpr_read_b32 v105, a33
    v_accvgpr_read_b32 v106, a34
    v_accvgpr_read_b32 v107, a35
    v_accvgpr_read_b32 v108, a36
    v_accvgpr_read_b32 v109, a37
    v_accvgpr_read_b32 v110, a38
    v_accvgpr_read_b32 v111, a39
    v_accvgpr_read_b32 v112, a40
    v_accvgpr_read_b32 v113, a41
    v_accvgpr_read_b32 v114, a42
    v_accvgpr_read_b32 v115, a43
    v_accvgpr_read_b32 v116, a44
    v_accvgpr_read_b32 v117, a45
    v_accvgpr_read_b32 v118, a46
    v_accvgpr_read_b32 v119, a47
    v_cvt_pk_bf16_f32 v144, v104, v105
    v_cvt_pk_bf16_f32 v145, v106, v107
    v_cvt_pk_bf16_f32 v146, v108, v109
    v_cvt_pk_bf16_f32 v147, v110, v111
    v_cvt_pk_bf16_f32 v148, v112, v113
    v_cvt_pk_bf16_f32 v149, v114, v115
    v_cvt_pk_bf16_f32 v150, v116, v117
    v_cvt_pk_bf16_f32 v151, v118, v119
    s_add_u32 s31, s30, 4096
    buffer_store_dwordx4 v[144:147], v2, s[20:23], s31 offen sc1
    buffer_store_dwordx4 v[148:151], v2, s[20:23], s31 offen offset:1024 sc1
    v_accvgpr_read_b32 v104, a48
    v_accvgpr_read_b32 v105, a49
    v_accvgpr_read_b32 v106, a50
    v_accvgpr_read_b32 v107, a51
    v_accvgpr_read_b32 v108, a52
    v_accvgpr_read_b32 v109, a53
    v_accvgpr_read_b32 v110, a54
    v_accvgpr_read_b32 v111, a55
    v_accvgpr_read_b32 v112, a56
    v_accvgpr_read_b32 v113, a57
    v_accvgpr_read_b32 v114, a58
    v_accvgpr_read_b32 v115, a59
    v_accvgpr_read_b32 v116, a60
    v_accvgpr_read_b32 v117, a61
    v_accvgpr_read_b32 v118, a62
    v_accvgpr_read_b32 v119, a63
    v_cvt_pk_bf16_f32 v152, v104, v105
    v_cvt_pk_bf16_f32 v153, v106, v107
    v_cvt_pk_bf16_f32 v154, v108, v109
    v_cvt_pk_bf16_f32 v155, v110, v111
    v_cvt_pk_bf16_f32 v156, v112, v113
    v_cvt_pk_bf16_f32 v157, v114, v115
    v_cvt_pk_bf16_f32 v158, v116, v117
    v_cvt_pk_bf16_f32 v159, v118, v119
    s_add_u32 s31, s30, 6144
    buffer_store_dwordx4 v[152:155], v2, s[20:23], s31 offen sc1
    buffer_store_dwordx4 v[156:159], v2, s[20:23], s31 offen offset:1024 sc1
    v_accvgpr_read_b32 v104, a64
    v_accvgpr_read_b32 v105, a65
    v_accvgpr_read_b32 v106, a66
    v_accvgpr_read_b32 v107, a67
    v_accvgpr_read_b32 v108, a68
    v_accvgpr_read_b32 v109, a69
    v_accvgpr_read_b32 v110, a70
    v_accvgpr_read_b32 v111, a71
    v_accvgpr_read_b32 v112, a72
    v_accvgpr_read_b32 v113, a73
    v_accvgpr_read_b32 v114, a74
    v_accvgpr_read_b32 v115, a75
    v_accvgpr_read_b32 v116, a76
    v_accvgpr_read_b32 v117, a77
    v_accvgpr_read_b32 v118, a78
    v_accvgpr_read_b32 v119, a79
    v_cvt_pk_bf16_f32 v128, v104, v105
    v_cvt_pk_bf16_f32 v129, v106, v107
    v_cvt_pk_bf16_f32 v130, v108, v109
    v_cvt_pk_bf16_f32 v131, v110, v111
    v_cvt_pk_bf16_f32 v132, v112, v113
    v_cvt_pk_bf16_f32 v133, v114, v115
    v_cvt_pk_bf16_f32 v134, v116, v117
    v_cvt_pk_bf16_f32 v135, v118, v119
    s_add_u32 s31, s30, 262144
    buffer_store_dwordx4 v[128:131], v2, s[20:23], s31 offen sc1
    buffer_store_dwordx4 v[132:135], v2, s[20:23], s31 offen offset:1024 sc1
    v_accvgpr_read_b32 v104, a80
    v_accvgpr_read_b32 v105, a81
    v_accvgpr_read_b32 v106, a82
    v_accvgpr_read_b32 v107, a83
    v_accvgpr_read_b32 v108, a84
    v_accvgpr_read_b32 v109, a85
    v_accvgpr_read_b32 v110, a86
    v_accvgpr_read_b32 v111, a87
    v_accvgpr_read_b32 v112, a88
    v_accvgpr_read_b32 v113, a89
    v_accvgpr_read_b32 v114, a90
    v_accvgpr_read_b32 v115, a91
    v_accvgpr_read_b32 v116, a92
    v_accvgpr_read_b32 v117, a93
    v_accvgpr_read_b32 v118, a94
    v_accvgpr_read_b32 v119, a95
    v_cvt_pk_bf16_f32 v136, v104, v105
    v_cvt_pk_bf16_f32 v137, v106, v107
    v_cvt_pk_bf16_f32 v138, v108, v109
    v_cvt_pk_bf16_f32 v139, v110, v111
    v_cvt_pk_bf16_f32 v140, v112, v113
    v_cvt_pk_bf16_f32 v141, v114, v115
    v_cvt_pk_bf16_f32 v142, v116, v117
    v_cvt_pk_bf16_f32 v143, v118, v119
    s_add_u32 s31, s30, 264192
    buffer_store_dwordx4 v[136:139], v2, s[20:23], s31 offen sc1
    buffer_store_dwordx4 v[140:143], v2, s[20:23], s31 offen offset:1024 sc1
    v_accvgpr_read_b32 v104, a96
    v_accvgpr_read_b32 v105, a97
    v_accvgpr_read_b32 v106, a98
    v_accvgpr_read_b32 v107, a99
    v_accvgpr_read_b32 v108, a100
    v_accvgpr_read_b32 v109, a101
    v_accvgpr_read_b32 v110, a102
    v_accvgpr_read_b32 v111, a103
    v_accvgpr_read_b32 v112, a104
    v_accvgpr_read_b32 v113, a105
    v_accvgpr_read_b32 v114, a106
    v_accvgpr_read_b32 v115, a107
    v_accvgpr_read_b32 v116, a108
    v_accvgpr_read_b32 v117, a109
    v_accvgpr_read_b32 v118, a110
    v_accvgpr_read_b32 v119, a111
    v_cvt_pk_bf16_f32 v144, v104, v105
    v_cvt_pk_bf16_f32 v145, v106, v107
    v_cvt_pk_bf16_f32 v146, v108, v109
    v_cvt_pk_bf16_f32 v147, v110, v111
    v_cvt_pk_bf16_f32 v148, v112, v113
    v_cvt_pk_bf16_f32 v149, v114, v115
    v_cvt_pk_bf16_f32 v150, v116, v117
    v_cvt_pk_bf16_f32 v151, v118, v119
    s_add_u32 s31, s30, 266240
    buffer_store_dwordx4 v[144:147], v2, s[20:23], s31 offen sc1
    buffer_store_dwordx4 v[148:151], v2, s[20:23], s31 offen offset:1024 sc1
    v_accvgpr_read_b32 v104, a112
    v_accvgpr_read_b32 v105, a113
    v_accvgpr_read_b32 v106, a114
    v_accvgpr_read_b32 v107, a115
    v_accvgpr_read_b32 v108, a116
    v_accvgpr_read_b32 v109, a117
    v_accvgpr_read_b32 v110, a118
    v_accvgpr_read_b32 v111, a119
    v_accvgpr_read_b32 v112, a120
    v_accvgpr_read_b32 v113, a121
    v_accvgpr_read_b32 v114, a122
    v_accvgpr_read_b32 v115, a123
    v_accvgpr_read_b32 v116, a124
    v_accvgpr_read_b32 v117, a125
    v_accvgpr_read_b32 v118, a126
    v_accvgpr_read_b32 v119, a127
    v_cvt_pk_bf16_f32 v152, v104, v105
    v_cvt_pk_bf16_f32 v153, v106, v107
    v_cvt_pk_bf16_f32 v154, v108, v109
    v_cvt_pk_bf16_f32 v155, v110, v111
    v_cvt_pk_bf16_f32 v156, v112, v113
    v_cvt_pk_bf16_f32 v157, v114, v115
    v_cvt_pk_bf16_f32 v158, v116, v117
    v_cvt_pk_bf16_f32 v159, v118, v119
    s_add_u32 s31, s30, 268288
    buffer_store_dwordx4 v[152:155], v2, s[20:23], s31 offen sc1
    buffer_store_dwordx4 v[156:159], v2, s[20:23], s31 offen offset:1024 sc1
    v_accvgpr_read_b32 v104, a128
    v_accvgpr_read_b32 v105, a129
    v_accvgpr_read_b32 v106, a130
    v_accvgpr_read_b32 v107, a131
    v_accvgpr_read_b32 v108, a132
    v_accvgpr_read_b32 v109, a133
    v_accvgpr_read_b32 v110, a134
    v_accvgpr_read_b32 v111, a135
    v_accvgpr_read_b32 v112, a136
    v_accvgpr_read_b32 v113, a137
    v_accvgpr_read_b32 v114, a138
    v_accvgpr_read_b32 v115, a139
    v_accvgpr_read_b32 v116, a140
    v_accvgpr_read_b32 v117, a141
    v_accvgpr_read_b32 v118, a142
    v_accvgpr_read_b32 v119, a143
    v_cvt_pk_bf16_f32 v128, v104, v105
    v_cvt_pk_bf16_f32 v129, v106, v107
    v_cvt_pk_bf16_f32 v130, v108, v109
    v_cvt_pk_bf16_f32 v131, v110, v111
    v_cvt_pk_bf16_f32 v132, v112, v113
    v_cvt_pk_bf16_f32 v133, v114, v115
    v_cvt_pk_bf16_f32 v134, v116, v117
    v_cvt_pk_bf16_f32 v135, v118, v119
    s_add_u32 s31, s30, 524288
    buffer_store_dwordx4 v[128:131], v2, s[20:23], s31 offen sc1
    buffer_store_dwordx4 v[132:135], v2, s[20:23], s31 offen offset:1024 sc1
    v_accvgpr_read_b32 v104, a144
    v_accvgpr_read_b32 v105, a145
    v_accvgpr_read_b32 v106, a146
    v_accvgpr_read_b32 v107, a147
    v_accvgpr_read_b32 v108, a148
    v_accvgpr_read_b32 v109, a149
    v_accvgpr_read_b32 v110, a150
    v_accvgpr_read_b32 v111, a151
    v_accvgpr_read_b32 v112, a152
    v_accvgpr_read_b32 v113, a153
    v_accvgpr_read_b32 v114, a154
    v_accvgpr_read_b32 v115, a155
    v_accvgpr_read_b32 v116, a156
    v_accvgpr_read_b32 v117, a157
    v_accvgpr_read_b32 v118, a158
    v_accvgpr_read_b32 v119, a159
    v_cvt_pk_bf16_f32 v136, v104, v105
    v_cvt_pk_bf16_f32 v137, v106, v107
    v_cvt_pk_bf16_f32 v138, v108, v109
    v_cvt_pk_bf16_f32 v139, v110, v111
    v_cvt_pk_bf16_f32 v140, v112, v113
    v_cvt_pk_bf16_f32 v141, v114, v115
    v_cvt_pk_bf16_f32 v142, v116, v117
    v_cvt_pk_bf16_f32 v143, v118, v119
    s_add_u32 s31, s30, 526336
    buffer_store_dwordx4 v[136:139], v2, s[20:23], s31 offen sc1
    buffer_store_dwordx4 v[140:143], v2, s[20:23], s31 offen offset:1024 sc1
    v_accvgpr_read_b32 v104, a160
    v_accvgpr_read_b32 v105, a161
    v_accvgpr_read_b32 v106, a162
    v_accvgpr_read_b32 v107, a163
    v_accvgpr_read_b32 v108, a164
    v_accvgpr_read_b32 v109, a165
    v_accvgpr_read_b32 v110, a166
    v_accvgpr_read_b32 v111, a167
    v_accvgpr_read_b32 v112, a168
    v_accvgpr_read_b32 v113, a169
    v_accvgpr_read_b32 v114, a170
    v_accvgpr_read_b32 v115, a171
    v_accvgpr_read_b32 v116, a172
    v_accvgpr_read_b32 v117, a173
    v_accvgpr_read_b32 v118, a174
    v_accvgpr_read_b32 v119, a175
    v_cvt_pk_bf16_f32 v144, v104, v105
    v_cvt_pk_bf16_f32 v145, v106, v107
    v_cvt_pk_bf16_f32 v146, v108, v109
    v_cvt_pk_bf16_f32 v147, v110, v111
    v_cvt_pk_bf16_f32 v148, v112, v113
    v_cvt_pk_bf16_f32 v149, v114, v115
    v_cvt_pk_bf16_f32 v150, v116, v117
    v_cvt_pk_bf16_f32 v151, v118, v119
    s_add_u32 s31, s30, 528384
    buffer_store_dwordx4 v[144:147], v2, s[20:23], s31 offen sc1
    buffer_store_dwordx4 v[148:151], v2, s[20:23], s31 offen offset:1024 sc1
    v_accvgpr_read_b32 v104, a176
    v_accvgpr_read_b32 v105, a177
    v_accvgpr_read_b32 v106, a178
    v_accvgpr_read_b32 v107, a179
    v_accvgpr_read_b32 v108, a180
    v_accvgpr_read_b32 v109, a181
    v_accvgpr_read_b32 v110, a182
    v_accvgpr_read_b32 v111, a183
    v_accvgpr_read_b32 v112, a184
    v_accvgpr_read_b32 v113, a185
    v_accvgpr_read_b32 v114, a186
    v_accvgpr_read_b32 v115, a187
    v_accvgpr_read_b32 v116, a188
    v_accvgpr_read_b32 v117, a189
    v_accvgpr_read_b32 v118, a190
    v_accvgpr_read_b32 v119, a191
    v_cvt_pk_bf16_f32 v152, v104, v105
    v_cvt_pk_bf16_f32 v153, v106, v107
    v_cvt_pk_bf16_f32 v154, v108, v109
    v_cvt_pk_bf16_f32 v155, v110, v111
    v_cvt_pk_bf16_f32 v156, v112, v113
    v_cvt_pk_bf16_f32 v157, v114, v115
    v_cvt_pk_bf16_f32 v158, v116, v117
    v_cvt_pk_bf16_f32 v159, v118, v119
    s_add_u32 s31, s30, 530432
    buffer_store_dwordx4 v[152:155], v2, s[20:23], s31 offen sc1
    buffer_store_dwordx4 v[156:159], v2, s[20:23], s31 offen offset:1024 sc1
    v_accvgpr_read_b32 v104, a192
    v_accvgpr_read_b32 v105, a193
    v_accvgpr_read_b32 v106, a194
    v_accvgpr_read_b32 v107, a195
    v_accvgpr_read_b32 v108, a196
    v_accvgpr_read_b32 v109, a197
    v_accvgpr_read_b32 v110, a198
    v_accvgpr_read_b32 v111, a199
    v_accvgpr_read_b32 v112, a200
    v_accvgpr_read_b32 v113, a201
    v_accvgpr_read_b32 v114, a202
    v_accvgpr_read_b32 v115, a203
    v_accvgpr_read_b32 v116, a204
    v_accvgpr_read_b32 v117, a205
    v_accvgpr_read_b32 v118, a206
    v_accvgpr_read_b32 v119, a207
    v_cvt_pk_bf16_f32 v128, v104, v105
    v_cvt_pk_bf16_f32 v129, v106, v107
    v_cvt_pk_bf16_f32 v130, v108, v109
    v_cvt_pk_bf16_f32 v131, v110, v111
    v_cvt_pk_bf16_f32 v132, v112, v113
    v_cvt_pk_bf16_f32 v133, v114, v115
    v_cvt_pk_bf16_f32 v134, v116, v117
    v_cvt_pk_bf16_f32 v135, v118, v119
    s_add_u32 s31, s30, 786432
    buffer_store_dwordx4 v[128:131], v2, s[20:23], s31 offen sc1
    buffer_store_dwordx4 v[132:135], v2, s[20:23], s31 offen offset:1024 sc1
    v_accvgpr_read_b32 v104, a208
    v_accvgpr_read_b32 v105, a209
    v_accvgpr_read_b32 v106, a210
    v_accvgpr_read_b32 v107, a211
    v_accvgpr_read_b32 v108, a212
    v_accvgpr_read_b32 v109, a213
    v_accvgpr_read_b32 v110, a214
    v_accvgpr_read_b32 v111, a215
    v_accvgpr_read_b32 v112, a216
    v_accvgpr_read_b32 v113, a217
    v_accvgpr_read_b32 v114, a218
    v_accvgpr_read_b32 v115, a219
    v_accvgpr_read_b32 v116, a220
    v_accvgpr_read_b32 v117, a221
    v_accvgpr_read_b32 v118, a222
    v_accvgpr_read_b32 v119, a223
    v_cvt_pk_bf16_f32 v136, v104, v105
    v_cvt_pk_bf16_f32 v137, v106, v107
    v_cvt_pk_bf16_f32 v138, v108, v109
    v_cvt_pk_bf16_f32 v139, v110, v111
    v_cvt_pk_bf16_f32 v140, v112, v113
    v_cvt_pk_bf16_f32 v141, v114, v115
    v_cvt_pk_bf16_f32 v142, v116, v117
    v_cvt_pk_bf16_f32 v143, v118, v119
    s_add_u32 s31, s30, 788480
    buffer_store_dwordx4 v[136:139], v2, s[20:23], s31 offen sc1
    buffer_store_dwordx4 v[140:143], v2, s[20:23], s31 offen offset:1024 sc1
    v_accvgpr_read_b32 v104, a224
    v_accvgpr_read_b32 v105, a225
    v_accvgpr_read_b32 v106, a226
    v_accvgpr_read_b32 v107, a227
    v_accvgpr_read_b32 v108, a228
    v_accvgpr_read_b32 v109, a229
    v_accvgpr_read_b32 v110, a230
    v_accvgpr_read_b32 v111, a231
    v_accvgpr_read_b32 v112, a232
    v_accvgpr_read_b32 v113, a233
    v_accvgpr_read_b32 v114, a234
    v_accvgpr_read_b32 v115, a235
    v_accvgpr_read_b32 v116, a236
    v_accvgpr_read_b32 v117, a237
    v_accvgpr_read_b32 v118, a238
    v_accvgpr_read_b32 v119, a239
    v_cvt_pk_bf16_f32 v144, v104, v105
    v_cvt_pk_bf16_f32 v145, v106, v107
    v_cvt_pk_bf16_f32 v146, v108, v109
    v_cvt_pk_bf16_f32 v147, v110, v111
    v_cvt_pk_bf16_f32 v148, v112, v113
    v_cvt_pk_bf16_f32 v149, v114, v115
    v_cvt_pk_bf16_f32 v150, v116, v117
    v_cvt_pk_bf16_f32 v151, v118, v119
    s_add_u32 s31, s30, 790528
    buffer_store_dwordx4 v[144:147], v2, s[20:23], s31 offen sc1
    buffer_store_dwordx4 v[148:151], v2, s[20:23], s31 offen offset:1024 sc1
    v_accvgpr_read_b32 v104, a240
    v_accvgpr_read_b32 v105, a241
    v_accvgpr_read_b32 v106, a242
    v_accvgpr_read_b32 v107, a243
    v_accvgpr_read_b32 v108, a244
    v_accvgpr_read_b32 v109, a245
    v_accvgpr_read_b32 v110, a246
    v_accvgpr_read_b32 v111, a247
    v_accvgpr_read_b32 v112, a248
    v_accvgpr_read_b32 v113, a249
    v_accvgpr_read_b32 v114, a250
    v_accvgpr_read_b32 v115, a251
    v_accvgpr_read_b32 v116, a252
    v_accvgpr_read_b32 v117, a253
    v_accvgpr_read_b32 v118, a254
    v_accvgpr_read_b32 v119, a255
    v_cvt_pk_bf16_f32 v152, v104, v105
    v_cvt_pk_bf16_f32 v153, v106, v107
    v_cvt_pk_bf16_f32 v154, v108, v109
    v_cvt_pk_bf16_f32 v155, v110, v111
    v_cvt_pk_bf16_f32 v156, v112, v113
    v_cvt_pk_bf16_f32 v157, v114, v115
    v_cvt_pk_bf16_f32 v158, v116, v117
    v_cvt_pk_bf16_f32 v159, v118, v119
    s_add_u32 s31, s30, 792576
    buffer_store_dwordx4 v[152:155], v2, s[20:23], s31 offen sc1
    buffer_store_dwordx4 v[156:159], v2, s[20:23], s31 offen offset:1024 sc1
    s_branch M_fin
M_bq:
    s_sub_u32 s5, s5, 16
    s_mul_hi_u32 s6, s5, 0x2AAAAAAB
    s_mul_i32 s7, s6, 6
    s_sub_u32 s7, s5, s7
    s_lshl_b32 s44, s7, 4
    s_add_u32 s44, s44, s6
    s_lshl_b32 s44, s44, 2
    s_add_u32 s99, s44, 100667392
    s_mul_hi_u32 s6, s5, 0x2AAAAAAB
    s_mul_i32 s7, s6, 6
    s_sub_u32 s7, s5, s7
    s_load_dwordx2 s[8:9], s[0:1], 56
    s_load_dwordx2 s[12:13], s[0:1], 64
    s_load_dwordx2 s[20:21], s[0:1], 96
    s_lshr_b32 s27, s7, 1
    s_and_b32 s28, s7, 1
    s_mul_i32 s16, s6, 163840
    s_mul_i32 s17, s7, 640
    s_mov_b32 s18, 3840
    s_lshl_b32 s25, s6, 7
    s_waitcnt lgkmcnt(0)
    s_mov_b32 s10, 2621440
    s_mov_b32 s11, 0x20000
    s_mov_b32 s14, 2457600
    s_mov_b32 s15, 0x20000
    s_mov_b32 s22, 0x10000000
    s_mov_b32 s23, 0x20000
    v_and_b32 v1, 63, v0
    v_lshrrev_b32 v20, 2, v1
    v_and_b32 v21, 3, v1
    v_lshrrev_b32 v22, 4, v1
    v_xor_b32 v23, v21, v22
    v_mul_u32_u24 v24, 1280, v20
    v_lshl_add_u32 v2, v23, 4, v24
    v_add_u32 v20, 0, v1
    s_mov_b32 s30, 0xCCCCCCCD
    v_mul_hi_u32 v21, v20, s30
    v_lshrrev_b32 v21, 5, v21
    v_mul_u32_u24 v22, 40, v21
    v_sub_u32 v22, v20, v22
    v_and_b32 v23, 2, v21
    v_lshlrev_b32 v23, 1, v23
    v_xor_b32 v22, v22, v23
    v_mul_lo_u32 v21, v21, s18
    v_lshl_add_u32 v4, v22, 4, v21
    v_add_u32 v20, 64, v1
    s_mov_b32 s30, 0xCCCCCCCD
    v_mul_hi_u32 v21, v20, s30
    v_lshrrev_b32 v21, 5, v21
    v_mul_u32_u24 v22, 40, v21
    v_sub_u32 v22, v20, v22
    v_and_b32 v23, 2, v21
    v_lshlrev_b32 v23, 1, v23
    v_xor_b32 v22, v22, v23
    v_mul_lo_u32 v21, v21, s18
    v_lshl_add_u32 v5, v22, 4, v21
    v_add_u32 v20, 128, v1
    s_mov_b32 s30, 0xCCCCCCCD
    v_mul_hi_u32 v21, v20, s30
    v_lshrrev_b32 v21, 5, v21
    v_mul_u32_u24 v22, 40, v21
    v_sub_u32 v22, v20, v22
    v_and_b32 v23, 2, v21
    v_lshlrev_b32 v23, 1, v23
    v_xor_b32 v22, v22, v23
    v_mul_lo_u32 v21, v21, s18
    v_lshl_add_u32 v6, v22, 4, v21
    v_add_u32 v20, 192, v1
    s_mov_b32 s30, 0xCCCCCCCD
    v_mul_hi_u32 v21, v20, s30
    v_lshrrev_b32 v21, 5, v21
    v_mul_u32_u24 v22, 40, v21
    v_sub_u32 v22, v20, v22
    v_and_b32 v23, 2, v21
    v_lshlrev_b32 v23, 1, v23
    v_xor_b32 v22, v22, v23
    v_mul_lo_u32 v21, v21, s18
    v_lshl_add_u32 v7, v22, 4, v21
    v_add_u32 v20, 256, v1
    s_mov_b32 s30, 0xCCCCCCCD
    v_mul_hi_u32 v21, v20, s30
    v_lshrrev_b32 v21, 5, v21
    v_mul_u32_u24 v22, 40, v21
    v_sub_u32 v22, v20, v22
    v_and_b32 v23, 2, v21
    v_lshlrev_b32 v23, 1, v23
    v_xor_b32 v22, v22, v23
    v_mul_lo_u32 v21, v21, s18
    v_lshl_add_u32 v8, v22, 4, v21
    s_and_b32 s30, s4, 1
    s_mul_i32 s30, s30, 4096
    v_and_b32 v20, 31, v1
    v_lshrrev_b32 v21, 5, v1
    v_bfe_u32 v22, v20, 2, 2
    v_lshlrev_b32 v20, 6, v20
    v_add_u32 v20, s30, v20
    v_add_u32 v23, 0, v21
    v_xor_b32 v23, v23, v22
    v_lshl_add_u32 v10, v23, 4, v20
    v_add_u32 v11, 0x10000, v10
    v_add_u32 v23, 2, v21
    v_xor_b32 v23, v23, v22
    v_lshl_add_u32 v12, v23, 4, v20
    v_add_u32 v13, 0x10000, v12
    s_lshr_b32 s31, s4, 1
    s_mul_i32 s31, s31, 20
    v_bfe_u32 v20, v1, 2, 2
    v_and_b32 v21, 3, v1
    v_bfe_u32 v22, v1, 4, 1
    v_lshrrev_b32 v23, 5, v1
    v_lshl_add_u32 v24, v23, 3, v20
    v_mul_u32_u24 v24, 640, v24
    v_add_u32 v24, 8192, v24
    v_and_b32 v25, 1, v21
    v_lshl_add_u32 v24, v25, 3, v24
    v_lshrrev_b32 v25, 1, v21
    v_lshl_add_u32 v25, v22, 1, v25
    v_add_u32 v25, s31, v25
    v_and_b32 v26, 2, v20
    v_lshlrev_b32 v26, 1, v26
    v_add_u32 v27, 0, v25
    v_xor_b32 v27, v27, v26
    v_lshl_add_u32 v14, v27, 4, v24
    v_add_u32 v15, 0x10000, v14
    v_add_u32 v27, 4, v25
    v_xor_b32 v27, v27, v26
    v_lshl_add_u32 v16, v27, 4, v24
    v_add_u32 v17, 0x10000, v16
    v_add_u32 v27, 8, v25
    v_xor_b32 v27, v27, v26
    v_lshl_add_u32 v18, v27, 4, v24
    v_add_u32 v19, 0x10000, v18
    v_add_u32 v27, 12, v25
    v_xor_b32 v27, v27, v26
    v_lshl_add_u32 v20, v27, 4, v24
    v_add_u32 v21, 0x10000, v20
    v_add_u32 v27, 16, v25
    v_xor_b32 v27, v27, v26
    v_lshl_add_u32 v22, v27, 4, v24
    v_add_u32 v23, 0x10000, v22
    s_cmp_eq_u32 s27, 2
    s_cbranch_scc1 BQ_10_v
    s_mul_i32 s33, s4, 40960
    s_add_u32 s33, s33, s16
    s_lshl_b32 s37, s18, 3
    s_mul_i32 s34, s4, s37
    s_add_u32 s34, s34, s17
    s_mul_i32 s39, s4, 2048
    s_mul_i32 s40, s4, 5120
    s_add_u32 s40, s40, 8192
    s_lshl_b32 s41, s18, 5
    s_add_u32 m0, s39, 0
    s_add_u32 s38, s33, 0
    buffer_load_dwordx4 v2, s[8:11], s38 offen  lds
    s_add_u32 m0, s39, 1024
    s_add_u32 s38, s33, 20480
    buffer_load_dwordx4 v2, s[8:11], s38 offen  lds
    s_add_u32 m0, s40, 0
    buffer_load_dwordx4 v4, s[12:15], s34 offen lds
    s_add_u32 m0, s40, 1024
    buffer_load_dwordx4 v5, s[12:15], s34 offen lds
    s_add_u32 m0, s40, 2048
    buffer_load_dwordx4 v6, s[12:15], s34 offen lds
    s_add_u32 m0, s40, 3072
    buffer_load_dwordx4 v7, s[12:15], s34 offen lds
    s_add_u32 m0, s40, 4096
    buffer_load_dwordx4 v8, s[12:15], s34 offen lds
    s_add_u32 s33, s33, 64
    s_add_u32 s34, s34, s41
    s_add_u32 m0, s39, 32768
    s_add_u32 s38, s33, 0
    buffer_load_dwordx4 v2, s[8:11], s38 offen  lds
    s_add_u32 m0, s39, 33792
    s_add_u32 s38, s33, 20480
    buffer_load_dwordx4 v2, s[8:11], s38 offen  lds
    s_add_u32 m0, s40, 32768
    buffer_load_dwordx4 v4, s[12:15], s34 offen lds
    s_add_u32 m0, s40, 33792
    buffer_load_dwordx4 v5, s[12:15], s34 offen lds
    s_add_u32 m0, s40, 34816
    buffer_load_dwordx4 v6, s[12:15], s34 offen lds
    s_add_u32 m0, s40, 35840
    buffer_load_dwordx4 v7, s[12:15], s34 offen lds
    s_add_u32 m0, s40, 36864
    buffer_load_dwordx4 v8, s[12:15], s34 offen lds
    s_add_u32 s33, s33, 64
    s_add_u32 s34, s34, s41
    s_add_u32 m0, s39, 65536
    s_add_u32 s38, s33, 0
    buffer_load_dwordx4 v2, s[8:11], s38 offen  lds
    s_add_u32 m0, s39, 66560
    s_add_u32 s38, s33, 20480
    buffer_load_dwordx4 v2, s[8:11], s38 offen  lds
    s_add_u32 m0, s40, 65536
    buffer_load_dwordx4 v4, s[12:15], s34 offen lds
    s_add_u32 m0, s40, 66560
    buffer_load_dwordx4 v5, s[12:15], s34 offen lds
    s_add_u32 m0, s40, 67584
    buffer_load_dwordx4 v6, s[12:15], s34 offen lds
    s_add_u32 m0, s40, 68608
    buffer_load_dwordx4 v7, s[12:15], s34 offen lds
    s_add_u32 m0, s40, 69632
    buffer_load_dwordx4 v8, s[12:15], s34 offen lds
    s_add_u32 s33, s33, 64
    s_add_u32 s34, s34, s41
    v_accvgpr_write_b32 a0, 0
    v_accvgpr_write_b32 a1, 0
    v_accvgpr_write_b32 a2, 0
    v_accvgpr_write_b32 a3, 0
    v_accvgpr_write_b32 a4, 0
    v_accvgpr_write_b32 a5, 0
    v_accvgpr_write_b32 a6, 0
    v_accvgpr_write_b32 a7, 0
    v_accvgpr_write_b32 a8, 0
    v_accvgpr_write_b32 a9, 0
    v_accvgpr_write_b32 a10, 0
    v_accvgpr_write_b32 a11, 0
    v_accvgpr_write_b32 a12, 0
    v_accvgpr_write_b32 a13, 0
    v_accvgpr_write_b32 a14, 0
    v_accvgpr_write_b32 a15, 0
    v_accvgpr_write_b32 a16, 0
    v_accvgpr_write_b32 a17, 0
    v_accvgpr_write_b32 a18, 0
    v_accvgpr_write_b32 a19, 0
    v_accvgpr_write_b32 a20, 0
    v_accvgpr_write_b32 a21, 0
    v_accvgpr_write_b32 a22, 0
    v_accvgpr_write_b32 a23, 0
    v_accvgpr_write_b32 a24, 0
    v_accvgpr_write_b32 a25, 0
    v_accvgpr_write_b32 a26, 0
    v_accvgpr_write_b32 a27, 0
    v_accvgpr_write_b32 a28, 0
    v_accvgpr_write_b32 a29, 0
    v_accvgpr_write_b32 a30, 0
    v_accvgpr_write_b32 a31, 0
    v_accvgpr_write_b32 a32, 0
    v_accvgpr_write_b32 a33, 0
    v_accvgpr_write_b32 a34, 0
    v_accvgpr_write_b32 a35, 0
    v_accvgpr_write_b32 a36, 0
    v_accvgpr_write_b32 a37, 0
    v_accvgpr_write_b32 a38, 0
    v_accvgpr_write_b32 a39, 0
    v_accvgpr_write_b32 a40, 0
    v_accvgpr_write_b32 a41, 0
    v_accvgpr_write_b32 a42, 0
    v_accvgpr_write_b32 a43, 0
    v_accvgpr_write_b32 a44, 0
    v_accvgpr_write_b32 a45, 0
    v_accvgpr_write_b32 a46, 0
    v_accvgpr_write_b32 a47, 0
    v_accvgpr_write_b32 a48, 0
    v_accvgpr_write_b32 a49, 0
    v_accvgpr_write_b32 a50, 0
    v_accvgpr_write_b32 a51, 0
    v_accvgpr_write_b32 a52, 0
    v_accvgpr_write_b32 a53, 0
    v_accvgpr_write_b32 a54, 0
    v_accvgpr_write_b32 a55, 0
    v_accvgpr_write_b32 a56, 0
    v_accvgpr_write_b32 a57, 0
    v_accvgpr_write_b32 a58, 0
    v_accvgpr_write_b32 a59, 0
    v_accvgpr_write_b32 a60, 0
    v_accvgpr_write_b32 a61, 0
    v_accvgpr_write_b32 a62, 0
    v_accvgpr_write_b32 a63, 0
    v_accvgpr_write_b32 a64, 0
    v_accvgpr_write_b32 a65, 0
    v_accvgpr_write_b32 a66, 0
    v_accvgpr_write_b32 a67, 0
    v_accvgpr_write_b32 a68, 0
    v_accvgpr_write_b32 a69, 0
    v_accvgpr_write_b32 a70, 0
    v_accvgpr_write_b32 a71, 0
    v_accvgpr_write_b32 a72, 0
    v_accvgpr_write_b32 a73, 0
    v_accvgpr_write_b32 a74, 0
    v_accvgpr_write_b32 a75, 0
    v_accvgpr_write_b32 a76, 0
    v_accvgpr_write_b32 a77, 0
    v_accvgpr_write_b32 a78, 0
    v_accvgpr_write_b32 a79, 0
    v_accvgpr_write_b32 a80, 0
    v_accvgpr_write_b32 a81, 0
    v_accvgpr_write_b32 a82, 0
    v_accvgpr_write_b32 a83, 0
    v_accvgpr_write_b32 a84, 0
    v_accvgpr_write_b32 a85, 0
    v_accvgpr_write_b32 a86, 0
    v_accvgpr_write_b32 a87, 0
    v_accvgpr_write_b32 a88, 0
    v_accvgpr_write_b32 a89, 0
    v_accvgpr_write_b32 a90, 0
    v_accvgpr_write_b32 a91, 0
    v_accvgpr_write_b32 a92, 0
    v_accvgpr_write_b32 a93, 0
    v_accvgpr_write_b32 a94, 0
    v_accvgpr_write_b32 a95, 0
    v_accvgpr_write_b32 a96, 0
    v_accvgpr_write_b32 a97, 0
    v_accvgpr_write_b32 a98, 0
    v_accvgpr_write_b32 a99, 0
    v_accvgpr_write_b32 a100, 0
    v_accvgpr_write_b32 a101, 0
    v_accvgpr_write_b32 a102, 0
    v_accvgpr_write_b32 a103, 0
    v_accvgpr_write_b32 a104, 0
    v_accvgpr_write_b32 a105, 0
    v_accvgpr_write_b32 a106, 0
    v_accvgpr_write_b32 a107, 0
    v_accvgpr_write_b32 a108, 0
    v_accvgpr_write_b32 a109, 0
    v_accvgpr_write_b32 a110, 0
    v_accvgpr_write_b32 a111, 0
    v_accvgpr_write_b32 a112, 0
    v_accvgpr_write_b32 a113, 0
    v_accvgpr_write_b32 a114, 0
    v_accvgpr_write_b32 a115, 0
    v_accvgpr_write_b32 a116, 0
    v_accvgpr_write_b32 a117, 0
    v_accvgpr_write_b32 a118, 0
    v_accvgpr_write_b32 a119, 0
    v_accvgpr_write_b32 a120, 0
    v_accvgpr_write_b32 a121, 0
    v_accvgpr_write_b32 a122, 0
    v_accvgpr_write_b32 a123, 0
    v_accvgpr_write_b32 a124, 0
    v_accvgpr_write_b32 a125, 0
    v_accvgpr_write_b32 a126, 0
    v_accvgpr_write_b32 a127, 0
    v_accvgpr_write_b32 a128, 0
    v_accvgpr_write_b32 a129, 0
    v_accvgpr_write_b32 a130, 0
    v_accvgpr_write_b32 a131, 0
    v_accvgpr_write_b32 a132, 0
    v_accvgpr_write_b32 a133, 0
    v_accvgpr_write_b32 a134, 0
    v_accvgpr_write_b32 a135, 0
    v_accvgpr_write_b32 a136, 0
    v_accvgpr_write_b32 a137, 0
    v_accvgpr_write_b32 a138, 0
    v_accvgpr_write_b32 a139, 0
    v_accvgpr_write_b32 a140, 0
    v_accvgpr_write_b32 a141, 0
    v_accvgpr_write_b32 a142, 0
    v_accvgpr_write_b32 a143, 0
    v_accvgpr_write_b32 a144, 0
    v_accvgpr_write_b32 a145, 0
    v_accvgpr_write_b32 a146, 0
    v_accvgpr_write_b32 a147, 0
    v_accvgpr_write_b32 a148, 0
    v_accvgpr_write_b32 a149, 0
    v_accvgpr_write_b32 a150, 0
    v_accvgpr_write_b32 a151, 0
    v_accvgpr_write_b32 a152, 0
    v_accvgpr_write_b32 a153, 0
    v_accvgpr_write_b32 a154, 0
    v_accvgpr_write_b32 a155, 0
    v_accvgpr_write_b32 a156, 0
    v_accvgpr_write_b32 a157, 0
    v_accvgpr_write_b32 a158, 0
    v_accvgpr_write_b32 a159, 0
    s_waitcnt vmcnt(14)
    s_barrier
    ds_read_b128 v[32:35], v10 offset:0
    ds_read_b128 v[36:39], v10 offset:2048
    ds_read_b64_tr_b16 v[48:49], v14 offset:0
    ds_read_b64_tr_b16 v[50:51], v14 offset:2560
    ds_read_b64_tr_b16 v[52:53], v16 offset:0
    ds_read_b64_tr_b16 v[54:55], v16 offset:2560
    ds_read_b64_tr_b16 v[56:57], v18 offset:0
    ds_read_b64_tr_b16 v[58:59], v18 offset:2560
    ds_read_b64_tr_b16 v[60:61], v20 offset:0
    ds_read_b64_tr_b16 v[62:63], v20 offset:2560
    ds_read_b64_tr_b16 v[64:65], v22 offset:0
    ds_read_b64_tr_b16 v[66:67], v22 offset:2560
    s_mov_b32 s42, 0
G_11_loop:
    s_waitcnt lgkmcnt(0)
    v_mfma_f32_32x32x16_bf16 a[0:15], v[48:51], v[32:35], a[0:15]
    ds_read_b128 v[68:71], v12 offset:0
    v_mfma_f32_32x32x16_bf16 a[16:31], v[52:55], v[32:35], a[16:31]
    s_add_u32 m0, s39, 98304
    s_add_u32 s38, s33, 0
    buffer_load_dwordx4 v2, s[8:11], s38 offen  lds
    ds_read_b128 v[72:75], v12 offset:2048
    v_mfma_f32_32x32x16_bf16 a[32:47], v[56:59], v[32:35], a[32:47]
    ds_read_b64_tr_b16 v[84:85], v14 offset:10240
    v_mfma_f32_32x32x16_bf16 a[48:63], v[60:63], v[32:35], a[48:63]
    ds_read_b64_tr_b16 v[86:87], v14 offset:12800
    s_add_u32 m0, s39, 99328
    s_add_u32 s38, s33, 20480
    buffer_load_dwordx4 v2, s[8:11], s38 offen  lds
    v_mfma_f32_32x32x16_bf16 a[64:79], v[64:67], v[32:35], a[64:79]
    ds_read_b64_tr_b16 v[88:89], v16 offset:10240
    ds_read_b64_tr_b16 v[90:91], v16 offset:12800
    v_mfma_f32_32x32x16_bf16 a[80:95], v[48:51], v[36:39], a[80:95]
    ds_read_b64_tr_b16 v[92:93], v18 offset:10240
    v_mfma_f32_32x32x16_bf16 a[96:111], v[52:55], v[36:39], a[96:111]
    s_add_u32 m0, s40, 98304
    buffer_load_dwordx4 v4, s[12:15], s34 offen lds
    ds_read_b64_tr_b16 v[94:95], v18 offset:12800
    v_mfma_f32_32x32x16_bf16 a[112:127], v[56:59], v[36:39], a[112:127]
    ds_read_b64_tr_b16 v[96:97], v20 offset:10240
    v_mfma_f32_32x32x16_bf16 a[128:143], v[60:63], v[36:39], a[128:143]
    ds_read_b64_tr_b16 v[98:99], v20 offset:12800
    s_add_u32 m0, s40, 99328
    buffer_load_dwordx4 v5, s[12:15], s34 offen lds
    v_mfma_f32_32x32x16_bf16 a[144:159], v[64:67], v[36:39], a[144:159]
    ds_read_b64_tr_b16 v[100:101], v22 offset:10240
    ds_read_b64_tr_b16 v[102:103], v22 offset:12800
    s_waitcnt lgkmcnt(0)
    v_mfma_f32_32x32x16_bf16 a[0:15], v[84:87], v[68:71], a[0:15]
    v_mfma_f32_32x32x16_bf16 a[16:31], v[88:91], v[68:71], a[16:31]
    v_mfma_f32_32x32x16_bf16 a[32:47], v[92:95], v[68:71], a[32:47]
    s_waitcnt vmcnt(11)
    s_barrier
    v_mfma_f32_32x32x16_bf16 a[48:63], v[96:99], v[68:71], a[48:63]
    ds_read_b128 v[32:35], v10 offset:32768
    s_add_u32 m0, s40, 100352
    buffer_load_dwordx4 v6, s[12:15], s34 offen lds
    v_mfma_f32_32x32x16_bf16 a[64:79], v[100:103], v[68:71], a[64:79]
    ds_read_b128 v[36:39], v10 offset:34816
    ds_read_b64_tr_b16 v[48:49], v14 offset:32768
    v_mfma_f32_32x32x16_bf16 a[80:95], v[84:87], v[72:75], a[80:95]
    ds_read_b64_tr_b16 v[50:51], v14 offset:35328
    ds_read_b64_tr_b16 v[52:53], v16 offset:32768
    v_mfma_f32_32x32x16_bf16 a[96:111], v[88:91], v[72:75], a[96:111]
    s_add_u32 m0, s40, 101376
    buffer_load_dwordx4 v7, s[12:15], s34 offen lds
    ds_read_b64_tr_b16 v[54:55], v16 offset:35328
    v_mfma_f32_32x32x16_bf16 a[112:127], v[92:95], v[72:75], a[112:127]
    ds_read_b64_tr_b16 v[56:57], v18 offset:32768
    ds_read_b64_tr_b16 v[58:59], v18 offset:35328
    v_mfma_f32_32x32x16_bf16 a[128:143], v[96:99], v[72:75], a[128:143]
    ds_read_b64_tr_b16 v[60:61], v20 offset:32768
    s_add_u32 m0, s40, 102400
    buffer_load_dwordx4 v8, s[12:15], s34 offen lds
    v_mfma_f32_32x32x16_bf16 a[144:159], v[100:103], v[72:75], a[144:159]
    ds_read_b64_tr_b16 v[62:63], v20 offset:35328
    ds_read_b64_tr_b16 v[64:65], v22 offset:32768
    ds_read_b64_tr_b16 v[66:67], v22 offset:35328
    s_add_u32 s33, s33, 64
    s_add_u32 s34, s34, s41
    s_cmp_eq_u32 s42, 4
    s_cselect_b32 s10, 0, s10
    s_cselect_b32 s14, 0, s14
    s_waitcnt lgkmcnt(0)
    v_mfma_f32_32x32x16_bf16 a[0:15], v[48:51], v[32:35], a[0:15]
    ds_read_b128 v[68:71], v12 offset:32768
    v_mfma_f32_32x32x16_bf16 a[16:31], v[52:55], v[32:35], a[16:31]
    s_add_u32 m0, s39, 0
    s_add_u32 s38, s33, 0
    buffer_load_dwordx4 v2, s[8:11], s38 offen  lds
    ds_read_b128 v[72:75], v12 offset:34816
    v_mfma_f32_32x32x16_bf16 a[32:47], v[56:59], v[32:35], a[32:47]
    ds_read_b64_tr_b16 v[84:85], v14 offset:43008
    v_mfma_f32_32x32x16_bf16 a[48:63], v[60:63], v[32:35], a[48:63]
    ds_read_b64_tr_b16 v[86:87], v14 offset:45568
    s_add_u32 m0, s39, 1024
    s_add_u32 s38, s33, 20480
    buffer_load_dwordx4 v2, s[8:11], s38 offen  lds
    v_mfma_f32_32x32x16_bf16 a[64:79], v[64:67], v[32:35], a[64:79]
    ds_read_b64_tr_b16 v[88:89], v16 offset:43008
    ds_read_b64_tr_b16 v[90:91], v16 offset:45568
    v_mfma_f32_32x32x16_bf16 a[80:95], v[48:51], v[36:39], a[80:95]
    ds_read_b64_tr_b16 v[92:93], v18 offset:43008
    v_mfma_f32_32x32x16_bf16 a[96:111], v[52:55], v[36:39], a[96:111]
    s_add_u32 m0, s40, 0
    buffer_load_dwordx4 v4, s[12:15], s34 offen lds
    ds_read_b64_tr_b16 v[94:95], v18 offset:45568
    v_mfma_f32_32x32x16_bf16 a[112:127], v[56:59], v[36:39], a[112:127]
    ds_read_b64_tr_b16 v[96:97], v20 offset:43008
    v_mfma_f32_32x32x16_bf16 a[128:143], v[60:63], v[36:39], a[128:143]
    ds_read_b64_tr_b16 v[98:99], v20 offset:45568
    s_add_u32 m0, s40, 1024
    buffer_load_dwordx4 v5, s[12:15], s34 offen lds
    v_mfma_f32_32x32x16_bf16 a[144:159], v[64:67], v[36:39], a[144:159]
    ds_read_b64_tr_b16 v[100:101], v22 offset:43008
    ds_read_b64_tr_b16 v[102:103], v22 offset:45568
    s_waitcnt lgkmcnt(0)
    v_mfma_f32_32x32x16_bf16 a[0:15], v[84:87], v[68:71], a[0:15]
    v_mfma_f32_32x32x16_bf16 a[16:31], v[88:91], v[68:71], a[16:31]
    v_mfma_f32_32x32x16_bf16 a[32:47], v[92:95], v[68:71], a[32:47]
    s_waitcnt vmcnt(11)
    s_barrier
    v_mfma_f32_32x32x16_bf16 a[48:63], v[96:99], v[68:71], a[48:63]
    ds_read_b128 v[32:35], v11 offset:0
    s_add_u32 m0, s40, 2048
    buffer_load_dwordx4 v6, s[12:15], s34 offen lds
    v_mfma_f32_32x32x16_bf16 a[64:79], v[100:103], v[68:71], a[64:79]
    ds_read_b128 v[36:39], v11 offset:2048
    ds_read_b64_tr_b16 v[48:49], v15 offset:0
    v_mfma_f32_32x32x16_bf16 a[80:95], v[84:87], v[72:75], a[80:95]
    ds_read_b64_tr_b16 v[50:51], v15 offset:2560
    ds_read_b64_tr_b16 v[52:53], v17 offset:0
    v_mfma_f32_32x32x16_bf16 a[96:111], v[88:91], v[72:75], a[96:111]
    s_add_u32 m0, s40, 3072
    buffer_load_dwordx4 v7, s[12:15], s34 offen lds
    ds_read_b64_tr_b16 v[54:55], v17 offset:2560
    v_mfma_f32_32x32x16_bf16 a[112:127], v[92:95], v[72:75], a[112:127]
    ds_read_b64_tr_b16 v[56:57], v19 offset:0
    ds_read_b64_tr_b16 v[58:59], v19 offset:2560
    v_mfma_f32_32x32x16_bf16 a[128:143], v[96:99], v[72:75], a[128:143]
    ds_read_b64_tr_b16 v[60:61], v21 offset:0
    s_add_u32 m0, s40, 4096
    buffer_load_dwordx4 v8, s[12:15], s34 offen lds
    v_mfma_f32_32x32x16_bf16 a[144:159], v[100:103], v[72:75], a[144:159]
    ds_read_b64_tr_b16 v[62:63], v21 offset:2560
    ds_read_b64_tr_b16 v[64:65], v23 offset:0
    ds_read_b64_tr_b16 v[66:67], v23 offset:2560
    s_add_u32 s33, s33, 64
    s_add_u32 s34, s34, s41
    s_waitcnt lgkmcnt(0)
    v_mfma_f32_32x32x16_bf16 a[0:15], v[48:51], v[32:35], a[0:15]
    ds_read_b128 v[68:71], v13 offset:0
    v_mfma_f32_32x32x16_bf16 a[16:31], v[52:55], v[32:35], a[16:31]
    s_add_u32 m0, s39, 32768
    s_add_u32 s38, s33, 0
    buffer_load_dwordx4 v2, s[8:11], s38 offen  lds
    ds_read_b128 v[72:75], v13 offset:2048
    v_mfma_f32_32x32x16_bf16 a[32:47], v[56:59], v[32:35], a[32:47]
    ds_read_b64_tr_b16 v[84:85], v15 offset:10240
    v_mfma_f32_32x32x16_bf16 a[48:63], v[60:63], v[32:35], a[48:63]
    ds_read_b64_tr_b16 v[86:87], v15 offset:12800
    s_add_u32 m0, s39, 33792
    s_add_u32 s38, s33, 20480
    buffer_load_dwordx4 v2, s[8:11], s38 offen  lds
    v_mfma_f32_32x32x16_bf16 a[64:79], v[64:67], v[32:35], a[64:79]
    ds_read_b64_tr_b16 v[88:89], v17 offset:10240
    ds_read_b64_tr_b16 v[90:91], v17 offset:12800
    v_mfma_f32_32x32x16_bf16 a[80:95], v[48:51], v[36:39], a[80:95]
    ds_read_b64_tr_b16 v[92:93], v19 offset:10240
    v_mfma_f32_32x32x16_bf16 a[96:111], v[52:55], v[36:39], a[96:111]
    s_add_u32 m0, s40, 32768
    buffer_load_dwordx4 v4, s[12:15], s34 offen lds
    ds_read_b64_tr_b16 v[94:95], v19 offset:12800
    v_mfma_f32_32x32x16_bf16 a[112:127], v[56:59], v[36:39], a[112:127]
    ds_read_b64_tr_b16 v[96:97], v21 offset:10240
    v_mfma_f32_32x32x16_bf16 a[128:143], v[60:63], v[36:39], a[128:143]
    ds_read_b64_tr_b16 v[98:99], v21 offset:12800
    s_add_u32 m0, s40, 33792
    buffer_load_dwordx4 v5, s[12:15], s34 offen lds
    v_mfma_f32_32x32x16_bf16 a[144:159], v[64:67], v[36:39], a[144:159]
    ds_read_b64_tr_b16 v[100:101], v23 offset:10240
    ds_read_b64_tr_b16 v[102:103], v23 offset:12800
    s_waitcnt lgkmcnt(0)
    v_mfma_f32_32x32x16_bf16 a[0:15], v[84:87], v[68:71], a[0:15]
    v_mfma_f32_32x32x16_bf16 a[16:31], v[88:91], v[68:71], a[16:31]
    v_mfma_f32_32x32x16_bf16 a[32:47], v[92:95], v[68:71], a[32:47]
    s_waitcnt vmcnt(11)
    s_barrier
    v_mfma_f32_32x32x16_bf16 a[48:63], v[96:99], v[68:71], a[48:63]
    ds_read_b128 v[32:35], v11 offset:32768
    s_add_u32 m0, s40, 34816
    buffer_load_dwordx4 v6, s[12:15], s34 offen lds
    v_mfma_f32_32x32x16_bf16 a[64:79], v[100:103], v[68:71], a[64:79]
    ds_read_b128 v[36:39], v11 offset:34816
    ds_read_b64_tr_b16 v[48:49], v15 offset:32768
    v_mfma_f32_32x32x16_bf16 a[80:95], v[84:87], v[72:75], a[80:95]
    ds_read_b64_tr_b16 v[50:51], v15 offset:35328
    ds_read_b64_tr_b16 v[52:53], v17 offset:32768
    v_mfma_f32_32x32x16_bf16 a[96:111], v[88:91], v[72:75], a[96:111]
    s_add_u32 m0, s40, 35840
    buffer_load_dwordx4 v7, s[12:15], s34 offen lds
    ds_read_b64_tr_b16 v[54:55], v17 offset:35328
    v_mfma_f32_32x32x16_bf16 a[112:127], v[92:95], v[72:75], a[112:127]
    ds_read_b64_tr_b16 v[56:57], v19 offset:32768
    ds_read_b64_tr_b16 v[58:59], v19 offset:35328
    v_mfma_f32_32x32x16_bf16 a[128:143], v[96:99], v[72:75], a[128:143]
    ds_read_b64_tr_b16 v[60:61], v21 offset:32768
    s_add_u32 m0, s40, 36864
    buffer_load_dwordx4 v8, s[12:15], s34 offen lds
    v_mfma_f32_32x32x16_bf16 a[144:159], v[100:103], v[72:75], a[144:159]
    ds_read_b64_tr_b16 v[62:63], v21 offset:35328
    ds_read_b64_tr_b16 v[64:65], v23 offset:32768
    ds_read_b64_tr_b16 v[66:67], v23 offset:35328
    s_add_u32 s33, s33, 64
    s_add_u32 s34, s34, s41
    s_waitcnt lgkmcnt(0)
    v_mfma_f32_32x32x16_bf16 a[0:15], v[48:51], v[32:35], a[0:15]
    ds_read_b128 v[68:71], v13 offset:32768
    v_mfma_f32_32x32x16_bf16 a[16:31], v[52:55], v[32:35], a[16:31]
    s_add_u32 m0, s39, 65536
    s_add_u32 s38, s33, 0
    buffer_load_dwordx4 v2, s[8:11], s38 offen  lds
    ds_read_b128 v[72:75], v13 offset:34816
    v_mfma_f32_32x32x16_bf16 a[32:47], v[56:59], v[32:35], a[32:47]
    ds_read_b64_tr_b16 v[84:85], v15 offset:43008
    v_mfma_f32_32x32x16_bf16 a[48:63], v[60:63], v[32:35], a[48:63]
    ds_read_b64_tr_b16 v[86:87], v15 offset:45568
    s_add_u32 m0, s39, 66560
    s_add_u32 s38, s33, 20480
    buffer_load_dwordx4 v2, s[8:11], s38 offen  lds
    v_mfma_f32_32x32x16_bf16 a[64:79], v[64:67], v[32:35], a[64:79]
    ds_read_b64_tr_b16 v[88:89], v17 offset:43008
    ds_read_b64_tr_b16 v[90:91], v17 offset:45568
    v_mfma_f32_32x32x16_bf16 a[80:95], v[48:51], v[36:39], a[80:95]
    ds_read_b64_tr_b16 v[92:93], v19 offset:43008
    v_mfma_f32_32x32x16_bf16 a[96:111], v[52:55], v[36:39], a[96:111]
    s_add_u32 m0, s40, 65536
    buffer_load_dwordx4 v4, s[12:15], s34 offen lds
    ds_read_b64_tr_b16 v[94:95], v19 offset:45568
    v_mfma_f32_32x32x16_bf16 a[112:127], v[56:59], v[36:39], a[112:127]
    ds_read_b64_tr_b16 v[96:97], v21 offset:43008
    v_mfma_f32_32x32x16_bf16 a[128:143], v[60:63], v[36:39], a[128:143]
    ds_read_b64_tr_b16 v[98:99], v21 offset:45568
    s_add_u32 m0, s40, 66560
    buffer_load_dwordx4 v5, s[12:15], s34 offen lds
    v_mfma_f32_32x32x16_bf16 a[144:159], v[64:67], v[36:39], a[144:159]
    ds_read_b64_tr_b16 v[100:101], v23 offset:43008
    ds_read_b64_tr_b16 v[102:103], v23 offset:45568
    s_waitcnt lgkmcnt(0)
    v_mfma_f32_32x32x16_bf16 a[0:15], v[84:87], v[68:71], a[0:15]
    v_mfma_f32_32x32x16_bf16 a[16:31], v[88:91], v[68:71], a[16:31]
    v_mfma_f32_32x32x16_bf16 a[32:47], v[92:95], v[68:71], a[32:47]
    s_waitcnt vmcnt(11)
    s_barrier
    v_mfma_f32_32x32x16_bf16 a[48:63], v[96:99], v[68:71], a[48:63]
    ds_read_b128 v[32:35], v10 offset:0
    s_add_u32 m0, s40, 67584
    buffer_load_dwordx4 v6, s[12:15], s34 offen lds
    v_mfma_f32_32x32x16_bf16 a[64:79], v[100:103], v[68:71], a[64:79]
    ds_read_b128 v[36:39], v10 offset:2048
    ds_read_b64_tr_b16 v[48:49], v14 offset:0
    v_mfma_f32_32x32x16_bf16 a[80:95], v[84:87], v[72:75], a[80:95]
    ds_read_b64_tr_b16 v[50:51], v14 offset:2560
    ds_read_b64_tr_b16 v[52:53], v16 offset:0
    v_mfma_f32_32x32x16_bf16 a[96:111], v[88:91], v[72:75], a[96:111]
    s_add_u32 m0, s40, 68608
    buffer_load_dwordx4 v7, s[12:15], s34 offen lds
    ds_read_b64_tr_b16 v[54:55], v16 offset:2560
    v_mfma_f32_32x32x16_bf16 a[112:127], v[92:95], v[72:75], a[112:127]
    ds_read_b64_tr_b16 v[56:57], v18 offset:0
    ds_read_b64_tr_b16 v[58:59], v18 offset:2560
    v_mfma_f32_32x32x16_bf16 a[128:143], v[96:99], v[72:75], a[128:143]
    ds_read_b64_tr_b16 v[60:61], v20 offset:0
    s_add_u32 m0, s40, 69632
    buffer_load_dwordx4 v8, s[12:15], s34 offen lds
    v_mfma_f32_32x32x16_bf16 a[144:159], v[100:103], v[72:75], a[144:159]
    ds_read_b64_tr_b16 v[62:63], v20 offset:2560
    ds_read_b64_tr_b16 v[64:65], v22 offset:0
    ds_read_b64_tr_b16 v[66:67], v22 offset:2560
    s_add_u32 s33, s33, 64
    s_add_u32 s34, s34, s41
    s_add_u32 s42, s42, 1
    s_cmp_lt_u32 s42, 5
    s_cbranch_scc1 G_11_loop
    s_waitcnt vmcnt(0) lgkmcnt(0)
    s_nop 15
    s_nop 7
    s_barrier
    s_mul_i32 s24, s28, 1572864
    s_cmp_eq_u32 s27, 0
    s_mov_b32 s29, 79691776
    s_cselect_b32 s29, 75497472, s29
    s_mov_b32 s26, 1.0
    s_cselect_b32 s26, 0x3ea52b5c, s26
    s_add_u32 s24, s24, s29
    s_and_b32 s30, s4, 1
    s_mul_i32 s30, s30, 3072
    s_lshr_b32 s31, s4, 1
    s_mul_i32 s31, s31, 49152
    s_add_u32 s30, s30, s31
    v_and_b32 v1, 31, v0
    v_bfe_u32 v5, v0, 5, 1
    v_mul_u32_u24 v1, 48, v1
    v_add_u32 v1, s30, v1
    v_lshl_add_u32 v2, v5, 3, v1
    v_mul_u32_u24 v6, 6112, v5
    v_add_u32 v3, v1, v6
    v_mul_u32_u24 v6, 6144, v5
    v_add_u32 v4, v1, v6
    v_mov_b32 v8, 0
    v_mov_b32 v9, 0
    v_accvgpr_read_b32 v104, a0
    v_accvgpr_read_b32 v105, a1
    v_accvgpr_read_b32 v106, a2
    v_accvgpr_read_b32 v107, a3
    v_accvgpr_read_b32 v108, a4
    v_accvgpr_read_b32 v109, a5
    v_accvgpr_read_b32 v110, a6
    v_accvgpr_read_b32 v111, a7
    v_accvgpr_read_b32 v112, a8
    v_accvgpr_read_b32 v113, a9
    v_accvgpr_read_b32 v114, a10
    v_accvgpr_read_b32 v115, a11
    v_accvgpr_read_b32 v116, a12
    v_accvgpr_read_b32 v117, a13
    v_accvgpr_read_b32 v118, a14
    v_accvgpr_read_b32 v119, a15
    v_mul_f32 v104, s26, v104
    v_mul_f32 v105, s26, v105
    v_mul_f32 v106, s26, v106
    v_mul_f32 v107, s26, v107
    v_mul_f32 v108, s26, v108
    v_mul_f32 v109, s26, v109
    v_mul_f32 v110, s26, v110
    v_mul_f32 v111, s26, v111
    v_mul_f32 v112, s26, v112
    v_mul_f32 v113, s26, v113
    v_mul_f32 v114, s26, v114
    v_mul_f32 v115, s26, v115
    v_mul_f32 v116, s26, v116
    v_mul_f32 v117, s26, v117
    v_mul_f32 v118, s26, v118
    v_mul_f32 v119, s26, v119
    v_cvt_pk_bf16_f32 v128, v104, v105
    v_cvt_pk_bf16_f32 v129, v106, v107
    v_cvt_pk_bf16_f32 v130, v108, v109
    v_cvt_pk_bf16_f32 v131, v110, v111
    v_cvt_pk_bf16_f32 v132, v112, v113
    v_cvt_pk_bf16_f32 v133, v114, v115
    v_cvt_pk_bf16_f32 v134, v116, v117
    v_cvt_pk_bf16_f32 v135, v118, v119
    ds_write_b64 v2, v[128:129] offset:0
    ds_write_b64 v2, v[130:131] offset:16
    ds_write_b64 v3, v[132:133] offset:32
    ds_write_b64 v2, v[134:135] offset:6152
    v_accvgpr_read_b32 v104, a16
    v_accvgpr_read_b32 v105, a17
    v_accvgpr_read_b32 v106, a18
    v_accvgpr_read_b32 v107, a19
    v_accvgpr_read_b32 v108, a20
    v_accvgpr_read_b32 v109, a21
    v_accvgpr_read_b32 v110, a22
    v_accvgpr_read_b32 v111, a23
    v_accvgpr_read_b32 v112, a24
    v_accvgpr_read_b32 v113, a25
    v_accvgpr_read_b32 v114, a26
    v_accvgpr_read_b32 v115, a27
    v_accvgpr_read_b32 v116, a28
    v_accvgpr_read_b32 v117, a29
    v_accvgpr_read_b32 v118, a30
    v_accvgpr_read_b32 v119, a31
    v_mul_f32 v104, s26, v104
    v_mul_f32 v105, s26, v105
    v_mul_f32 v106, s26, v106
    v_mul_f32 v107, s26, v107
    v_mul_f32 v108, s26, v108
    v_mul_f32 v109, s26, v109
    v_mul_f32 v110, s26, v110
    v_mul_f32 v111, s26, v111
    v_mul_f32 v112, s26, v112
    v_mul_f32 v113, s26, v113
    v_mul_f32 v114, s26, v114
    v_mul_f32 v115, s26, v115
    v_mul_f32 v116, s26, v116
    v_mul_f32 v117, s26, v117
    v_mul_f32 v118, s26, v118
    v_mul_f32 v119, s26, v119
    v_cvt_pk_bf16_f32 v136, v104, v105
    v_cvt_pk_bf16_f32 v137, v106, v107
    v_cvt_pk_bf16_f32 v138, v108, v109
    v_cvt_pk_bf16_f32 v139, v110, v111
    v_cvt_pk_bf16_f32 v140, v112, v113
    v_cvt_pk_bf16_f32 v141, v114, v115
    v_cvt_pk_bf16_f32 v142, v116, v117
    v_cvt_pk_bf16_f32 v143, v118, v119
    ds_write_b64 v2, v[136:137] offset:6168
    ds_write_b64 v2, v[138:139] offset:12288
    ds_write_b64 v2, v[140:141] offset:12304
    ds_write_b64 v3, v[142:143] offset:12320
    v_accvgpr_read_b32 v104, a32
    v_accvgpr_read_b32 v105, a33
    v_accvgpr_read_b32 v106, a34
    v_accvgpr_read_b32 v107, a35
    v_accvgpr_read_b32 v108, a36
    v_accvgpr_read_b32 v109, a37
    v_accvgpr_read_b32 v110, a38
    v_accvgpr_read_b32 v111, a39
    v_accvgpr_read_b32 v112, a40
    v_accvgpr_read_b32 v113, a41
    v_accvgpr_read_b32 v114, a42
    v_accvgpr_read_b32 v115, a43
    v_accvgpr_read_b32 v116, a44
    v_accvgpr_read_b32 v117, a45
    v_accvgpr_read_b32 v118, a46
    v_accvgpr_read_b32 v119, a47
    v_mul_f32 v104, s26, v104
    v_mul_f32 v105, s26, v105
    v_mul_f32 v106, s26, v106
    v_mul_f32 v107, s26, v107
    v_mul_f32 v108, s26, v108
    v_mul_f32 v109, s26, v109
    v_mul_f32 v110, s26, v110
    v_mul_f32 v111, s26, v111
    v_mul_f32 v112, s26, v112
    v_mul_f32 v113, s26, v113
    v_mul_f32 v114, s26, v114
    v_mul_f32 v115, s26, v115
    v_mul_f32 v116, s26, v116
    v_mul_f32 v117, s26, v117
    v_mul_f32 v118, s26, v118
    v_mul_f32 v119, s26, v119
    v_cvt_pk_bf16_f32 v144, v104, v105
    v_cvt_pk_bf16_f32 v145, v106, v107
    v_cvt_pk_bf16_f32 v146, v108, v109
    v_cvt_pk_bf16_f32 v147, v110, v111
    v_cvt_pk_bf16_f32 v148, v112, v113
    v_cvt_pk_bf16_f32 v149, v114, v115
    v_cvt_pk_bf16_f32 v150, v116, v117
    v_cvt_pk_bf16_f32 v151, v118, v119
    ds_write_b64 v2, v[144:145] offset:18440
    ds_write_b64 v2, v[146:147] offset:18456
    ds_write_b64 v2, v[148:149] offset:24576
    ds_write_b64 v2, v[150:151] offset:24592
    v_accvgpr_read_b32 v104, a48
    v_accvgpr_read_b32 v105, a49
    v_accvgpr_read_b32 v106, a50
    v_accvgpr_read_b32 v107, a51
    v_accvgpr_read_b32 v108, a52
    v_accvgpr_read_b32 v109, a53
    v_accvgpr_read_b32 v110, a54
    v_accvgpr_read_b32 v111, a55
    v_accvgpr_read_b32 v112, a56
    v_accvgpr_read_b32 v113, a57
    v_accvgpr_read_b32 v114, a58
    v_accvgpr_read_b32 v115, a59
    v_accvgpr_read_b32 v116, a60
    v_accvgpr_read_b32 v117, a61
    v_accvgpr_read_b32 v118, a62
    v_accvgpr_read_b32 v119, a63
    v_mul_f32 v104, s26, v104
    v_mul_f32 v105, s26, v105
    v_mul_f32 v106, s26, v106
    v_mul_f32 v107, s26, v107
    v_mul_f32 v108, s26, v108
    v_mul_f32 v109, s26, v109
    v_mul_f32 v110, s26, v110
    v_mul_f32 v111, s26, v111
    v_mul_f32 v112, s26, v112
    v_mul_f32 v113, s26, v113
    v_mul_f32 v114, s26, v114
    v_mul_f32 v115, s26, v115
    v_mul_f32 v116, s26, v116
    v_mul_f32 v117, s26, v117
    v_mul_f32 v118, s26, v118
    v_mul_f32 v119, s26, v119
    v_cvt_pk_bf16_f32 v152, v104, v105
    v_cvt_pk_bf16_f32 v153, v106, v107
    v_cvt_pk_bf16_f32 v154, v108, v109
    v_cvt_pk_bf16_f32 v155, v110, v111
    v_cvt_pk_bf16_f32 v156, v112, v113
    v_cvt_pk_bf16_f32 v157, v114, v115
    v_cvt_pk_bf16_f32 v158, v116, v117
    v_cvt_pk_bf16_f32 v159, v118, v119
    ds_write_b64 v3, v[152:153] offset:24608
    ds_write_b64 v2, v[154:155] offset:30728
    ds_write_b64 v2, v[156:157] offset:30744
    ds_write_b64 v2, v[158:159] offset:36864
    v_accvgpr_read_b32 v104, a64
    v_accvgpr_read_b32 v105, a65
    v_accvgpr_read_b32 v106, a66
    v_accvgpr_read_b32 v107, a67
    v_accvgpr_read_b32 v108, a68
    v_accvgpr_read_b32 v109, a69
    v_accvgpr_read_b32 v110, a70
    v_accvgpr_read_b32 v111, a71
    v_accvgpr_read_b32 v112, a72
    v_accvgpr_read_b32 v113, a73
    v_accvgpr_read_b32 v114, a74
    v_accvgpr_read_b32 v115, a75
    v_accvgpr_read_b32 v116, a76
    v_accvgpr_read_b32 v117, a77
    v_accvgpr_read_b32 v118, a78
    v_accvgpr_read_b32 v119, a79
    v_mul_f32 v104, s26, v104
    v_mul_f32 v105, s26, v105
    v_mul_f32 v106, s26, v106
    v_mul_f32 v107, s26, v107
    v_mul_f32 v108, s26, v108
    v_mul_f32 v109, s26, v109
    v_mul_f32 v110, s26, v110
    v_mul_f32 v111, s26, v111
    v_mul_f32 v112, s26, v112
    v_mul_f32 v113, s26, v113
    v_mul_f32 v114, s26, v114
    v_mul_f32 v115, s26, v115
    v_mul_f32 v116, s26, v116
    v_mul_f32 v117, s26, v117
    v_mul_f32 v118, s26, v118
    v_mul_f32 v119, s26, v119
    v_cvt_pk_bf16_f32 v128, v104, v105
    v_cvt_pk_bf16_f32 v129, v106, v107
    v_cvt_pk_bf16_f32 v130, v108, v109
    v_cvt_pk_bf16_f32 v131, v110, v111
    v_cvt_pk_bf16_f32 v132, v112, v113
    v_cvt_pk_bf16_f32 v133, v114, v115
    v_cvt_pk_bf16_f32 v134, v116, v117
    v_cvt_pk_bf16_f32 v135, v118, v119
    ds_write_b64 v2, v[128:129] offset:36880
    ds_write_b64 v3, v[130:131] offset:36896
    ds_write_b64 v2, v[132:133] offset:43016
    ds_write_b64 v2, v[134:135] offset:43032
    ds_write_b64 v4, v[8:9] offset:40
    ds_write_b64 v4, v[8:9] offset:12328
    ds_write_b64 v4, v[8:9] offset:24616
    ds_write_b64 v4, v[8:9] offset:36904
    v_accvgpr_read_b32 v104, a80
    v_accvgpr_read_b32 v105, a81
    v_accvgpr_read_b32 v106, a82
    v_accvgpr_read_b32 v107, a83
    v_accvgpr_read_b32 v108, a84
    v_accvgpr_read_b32 v109, a85
    v_accvgpr_read_b32 v110, a86
    v_accvgpr_read_b32 v111, a87
    v_accvgpr_read_b32 v112, a88
    v_accvgpr_read_b32 v113, a89
    v_accvgpr_read_b32 v114, a90
    v_accvgpr_read_b32 v115, a91
    v_accvgpr_read_b32 v116, a92
    v_accvgpr_read_b32 v117, a93
    v_accvgpr_read_b32 v118, a94
    v_accvgpr_read_b32 v119, a95
    v_mul_f32 v104, s26, v104
    v_mul_f32 v105, s26, v105
    v_mul_f32 v106, s26, v106
    v_mul_f32 v107, s26, v107
    v_mul_f32 v108, s26, v108
    v_mul_f32 v109, s26, v109
    v_mul_f32 v110, s26, v110
    v_mul_f32 v111, s26, v111
    v_mul_f32 v112, s26, v112
    v_mul_f32 v113, s26, v113
    v_mul_f32 v114, s26, v114
    v_mul_f32 v115, s26, v115
    v_mul_f32 v116, s26, v116
    v_mul_f32 v117, s26, v117
    v_mul_f32 v118, s26, v118
    v_mul_f32 v119, s26, v119
    v_cvt_pk_bf16_f32 v136, v104, v105
    v_cvt_pk_bf16_f32 v137, v106, v107
    v_cvt_pk_bf16_f32 v138, v108, v109
    v_cvt_pk_bf16_f32 v139, v110, v111
    v_cvt_pk_bf16_f32 v140, v112, v113
    v_cvt_pk_bf16_f32 v141, v114, v115
    v_cvt_pk_bf16_f32 v142, v116, v117
    v_cvt_pk_bf16_f32 v143, v118, v119
    ds_write_b64 v2, v[136:137] offset:1536
    ds_write_b64 v2, v[138:139] offset:1552
    ds_write_b64 v3, v[140:141] offset:1568
    ds_write_b64 v2, v[142:143] offset:7688
    v_accvgpr_read_b32 v104, a96
    v_accvgpr_read_b32 v105, a97
    v_accvgpr_read_b32 v106, a98
    v_accvgpr_read_b32 v107, a99
    v_accvgpr_read_b32 v108, a100
    v_accvgpr_read_b32 v109, a101
    v_accvgpr_read_b32 v110, a102
    v_accvgpr_read_b32 v111, a103
    v_accvgpr_read_b32 v112, a104
    v_accvgpr_read_b32 v113, a105
    v_accvgpr_read_b32 v114, a106
    v_accvgpr_read_b32 v115, a107
    v_accvgpr_read_b32 v116, a108
    v_accvgpr_read_b32 v117, a109
    v_accvgpr_read_b32 v118, a110
    v_accvgpr_read_b32 v119, a111
    v_mul_f32 v104, s26, v104
    v_mul_f32 v105, s26, v105
    v_mul_f32 v106, s26, v106
    v_mul_f32 v107, s26, v107
    v_mul_f32 v108, s26, v108
    v_mul_f32 v109, s26, v109
    v_mul_f32 v110, s26, v110
    v_mul_f32 v111, s26, v111
    v_mul_f32 v112, s26, v112
    v_mul_f32 v113, s26, v113
    v_mul_f32 v114, s26, v114
    v_mul_f32 v115, s26, v115
    v_mul_f32 v116, s26, v116
    v_mul_f32 v117, s26, v117
    v_mul_f32 v118, s26, v118
    v_mul_f32 v119, s26, v119
    v_cvt_pk_bf16_f32 v144, v104, v105
    v_cvt_pk_bf16_f32 v145, v106, v107
    v_cvt_pk_bf16_f32 v146, v108, v109
    v_cvt_pk_bf16_f32 v147, v110, v111
    v_cvt_pk_bf16_f32 v148, v112, v113
    v_cvt_pk_bf16_f32 v149, v114, v115
    v_cvt_pk_bf16_f32 v150, v116, v117
    v_cvt_pk_bf16_f32 v151, v118, v119
    ds_write_b64 v2, v[144:145] offset:7704
    ds_write_b64 v2, v[146:147] offset:13824
    ds_write_b64 v2, v[148:149] offset:13840
    ds_write_b64 v3, v[150:151] offset:13856
    v_accvgpr_read_b32 v104, a112
    v_accvgpr_read_b32 v105, a113
    v_accvgpr_read_b32 v106, a114
    v_accvgpr_read_b32 v107, a115
    v_accvgpr_read_b32 v108, a116
    v_accvgpr_read_b32 v109, a117
    v_accvgpr_read_b32 v110, a118
    v_accvgpr_read_b32 v111, a119
    v_accvgpr_read_b32 v112, a120
    v_accvgpr_read_b32 v113, a121
    v_accvgpr_read_b32 v114, a122
    v_accvgpr_read_b32 v115, a123
    v_accvgpr_read_b32 v116, a124
    v_accvgpr_read_b32 v117, a125
    v_accvgpr_read_b32 v118, a126
    v_accvgpr_read_b32 v119, a127
    v_mul_f32 v104, s26, v104
    v_mul_f32 v105, s26, v105
    v_mul_f32 v106, s26, v106
    v_mul_f32 v107, s26, v107
    v_mul_f32 v108, s26, v108
    v_mul_f32 v109, s26, v109
    v_mul_f32 v110, s26, v110
    v_mul_f32 v111, s26, v111
    v_mul_f32 v112, s26, v112
    v_mul_f32 v113, s26, v113
    v_mul_f32 v114, s26, v114
    v_mul_f32 v115, s26, v115
    v_mul_f32 v116, s26, v116
    v_mul_f32 v117, s26, v117
    v_mul_f32 v118, s26, v118
    v_mul_f32 v119, s26, v119
    v_cvt_pk_bf16_f32 v152, v104, v105
    v_cvt_pk_bf16_f32 v153, v106, v107
    v_cvt_pk_bf16_f32 v154, v108, v109
    v_cvt_pk_bf16_f32 v155, v110, v111
    v_cvt_pk_bf16_f32 v156, v112, v113
    v_cvt_pk_bf16_f32 v157, v114, v115
    v_cvt_pk_bf16_f32 v158, v116, v117
    v_cvt_pk_bf16_f32 v159, v118, v119
    ds_write_b64 v2, v[152:153] offset:19976
    ds_write_b64 v2, v[154:155] offset:19992
    ds_write_b64 v2, v[156:157] offset:26112
    ds_write_b64 v2, v[158:159] offset:26128
    v_accvgpr_read_b32 v104, a128
    v_accvgpr_read_b32 v105, a129
    v_accvgpr_read_b32 v106, a130
    v_accvgpr_read_b32 v107, a131
    v_accvgpr_read_b32 v108, a132
    v_accvgpr_read_b32 v109, a133
    v_accvgpr_read_b32 v110, a134
    v_accvgpr_read_b32 v111, a135
    v_accvgpr_read_b32 v112, a136
    v_accvgpr_read_b32 v113, a137
    v_accvgpr_read_b32 v114, a138
    v_accvgpr_read_b32 v115, a139
    v_accvgpr_read_b32 v116, a140
    v_accvgpr_read_b32 v117, a141
    v_accvgpr_read_b32 v118, a142
    v_accvgpr_read_b32 v119, a143
    v_mul_f32 v104, s26, v104
    v_mul_f32 v105, s26, v105
    v_mul_f32 v106, s26, v106
    v_mul_f32 v107, s26, v107
    v_mul_f32 v108, s26, v108
    v_mul_f32 v109, s26, v109
    v_mul_f32 v110, s26, v110
    v_mul_f32 v111, s26, v111
    v_mul_f32 v112, s26, v112
    v_mul_f32 v113, s26, v113
    v_mul_f32 v114, s26, v114
    v_mul_f32 v115, s26, v115
    v_mul_f32 v116, s26, v116
    v_mul_f32 v117, s26, v117
    v_mul_f32 v118, s26, v118
    v_mul_f32 v119, s26, v119
    v_cvt_pk_bf16_f32 v128, v104, v105
    v_cvt_pk_bf16_f32 v129, v106, v107
    v_cvt_pk_bf16_f32 v130, v108, v109
    v_cvt_pk_bf16_f32 v131, v110, v111
    v_cvt_pk_bf16_f32 v132, v112, v113
    v_cvt_pk_bf16_f32 v133, v114, v115
    v_cvt_pk_bf16_f32 v134, v116, v117
    v_cvt_pk_bf16_f32 v135, v118, v119
    ds_write_b64 v3, v[128:129] offset:26144
    ds_write_b64 v2, v[130:131] offset:32264
    ds_write_b64 v2, v[132:133] offset:32280
    ds_write_b64 v2, v[134:135] offset:38400
    v_accvgpr_read_b32 v104, a144
    v_accvgpr_read_b32 v105, a145
    v_accvgpr_read_b32 v106, a146
    v_accvgpr_read_b32 v107, a147
    v_accvgpr_read_b32 v108, a148
    v_accvgpr_read_b32 v109, a149
    v_accvgpr_read_b32 v110, a150
    v_accvgpr_read_b32 v111, a151
    v_accvgpr_read_b32 v112, a152
    v_accvgpr_read_b32 v113, a153
    v_accvgpr_read_b32 v114, a154
    v_accvgpr_read_b32 v115, a155
    v_accvgpr_read_b32 v116, a156
    v_accvgpr_read_b32 v117, a157
    v_accvgpr_read_b32 v118, a158
    v_accvgpr_read_b32 v119, a159
    v_mul_f32 v104, s26, v104
    v_mul_f32 v105, s26, v105
    v_mul_f32 v106, s26, v106
    v_mul_f32 v107, s26, v107
    v_mul_f32 v108, s26, v108
    v_mul_f32 v109, s26, v109
    v_mul_f32 v110, s26, v110
    v_mul_f32 v111, s26, v111
    v_mul_f32 v112, s26, v112
    v_mul_f32 v113, s26, v113
    v_mul_f32 v114, s26, v114
    v_mul_f32 v115, s26, v115
    v_mul_f32 v116, s26, v116
    v_mul_f32 v117, s26, v117
    v_mul_f32 v118, s26, v118
    v_mul_f32 v119, s26, v119
    v_cvt_pk_bf16_f32 v136, v104, v105
    v_cvt_pk_bf16_f32 v137, v106, v107
    v_cvt_pk_bf16_f32 v138, v108, v109
    v_cvt_pk_bf16_f32 v139, v110, v111
    v_cvt_pk_bf16_f32 v140, v112, v113
    v_cvt_pk_bf16_f32 v141, v114, v115
    v_cvt_pk_bf16_f32 v142, v116, v117
    v_cvt_pk_bf16_f32 v143, v118, v119
    ds_write_b64 v2, v[136:137] offset:38416
    ds_write_b64 v3, v[138:139] offset:38432
    ds_write_b64 v2, v[140:141] offset:44552
    ds_write_b64 v2, v[142:143] offset:44568
    ds_write_b64 v4, v[8:9] offset:1576
    ds_write_b64 v4, v[8:9] offset:13864
    ds_write_b64 v4, v[8:9] offset:26152
    ds_write_b64 v4, v[8:9] offset:38440
    s_waitcnt lgkmcnt(0)
    s_barrier
    v_lshlrev_b32 v10, 4, v0
    v_add_u32 v11, 0x10000, v10
    s_mul_i32 s30, s25, 48
    s_add_u32 s30, s30, s24
    v_add_u32 v12, 0, v0
    v_cmp_le_u32 vcc, 384, v12
    v_add_u32 v13, 5760, v12
    s_nop 0
    v_cndmask_b32 v12, v12, v13, vcc
    v_lshlrev_b32 v14, 4, v12
    v_add_u32 v12, 256, v0
    v_cmp_le_u32 vcc, 384, v12
    v_add_u32 v13, 5760, v12
    s_nop 0
    v_cndmask_b32 v12, v12, v13, vcc
    v_lshlrev_b32 v15, 4, v12
    v_add_u32 v12, 512, v0
    v_cmp_le_u32 vcc, 384, v12
    v_add_u32 v13, 5760, v12
    s_nop 0
    v_cndmask_b32 v12, v12, v13, vcc
    v_lshlrev_b32 v16, 4, v12
    ds_read_b128 v[128:131], v10 offset:0
    ds_read_b128 v[132:135], v10 offset:4096
    ds_read_b128 v[136:139], v10 offset:8192
    ds_read_b128 v[140:143], v10 offset:12288
    s_waitcnt lgkmcnt(3)
    s_add_u32 s31, s30, 0
    buffer_store_dwordx4 v[128:131], v14, s[20:23], s31 offen sc1
    s_waitcnt lgkmcnt(2)
    s_add_u32 s31, s30, 0
    buffer_store_dwordx4 v[132:135], v15, s[20:23], s31 offen sc1
    s_waitcnt lgkmcnt(1)
    s_add_u32 s31, s30, 0
    buffer_store_dwordx4 v[136:139], v16, s[20:23], s31 offen sc1
    s_waitcnt lgkmcnt(0)
    s_add_u32 s31, s30, 196608
    buffer_store_dwordx4 v[140:143], v14, s[20:23], s31 offen sc1
    ds_read_b128 v[128:131], v10 offset:16384
    ds_read_b128 v[132:135], v10 offset:20480
    ds_read_b128 v[136:139], v10 offset:24576
    ds_read_b128 v[140:143], v10 offset:28672
    s_waitcnt lgkmcnt(3)
    s_add_u32 s31, s30, 196608
    buffer_store_dwordx4 v[128:131], v15, s[20:23], s31 offen sc1
    s_waitcnt lgkmcnt(2)
    s_add_u32 s31, s30, 196608
    buffer_store_dwordx4 v[132:135], v16, s[20:23], s31 offen sc1
    s_waitcnt lgkmcnt(1)
    s_add_u32 s31, s30, 393216
    buffer_store_dwordx4 v[136:139], v14, s[20:23], s31 offen sc1
    s_waitcnt lgkmcnt(0)
    s_add_u32 s31, s30, 393216
    buffer_store_dwordx4 v[140:143], v15, s[20:23], s31 offen sc1
    ds_read_b128 v[128:131], v10 offset:32768
    ds_read_b128 v[132:135], v10 offset:36864
    ds_read_b128 v[136:139], v10 offset:40960
    ds_read_b128 v[140:143], v10 offset:45056
    s_waitcnt lgkmcnt(3)
    s_add_u32 s31, s30, 393216
    buffer_store_dwordx4 v[128:131], v16, s[20:23], s31 offen sc1
    s_waitcnt lgkmcnt(2)
    s_add_u32 s31, s30, 589824
    buffer_store_dwordx4 v[132:135], v14, s[20:23], s31 offen sc1
    s_waitcnt lgkmcnt(1)
    s_add_u32 s31, s30, 589824
    buffer_store_dwordx4 v[136:139], v15, s[20:23], s31 offen sc1
    s_waitcnt lgkmcnt(0)
    s_add_u32 s31, s30, 589824
    buffer_store_dwordx4 v[140:143], v16, s[20:23], s31 offen sc1
    ds_read_b128 v[128:131], v10 offset:49152
    ds_read_b128 v[132:135], v10 offset:53248
    ds_read_b128 v[136:139], v10 offset:57344
    ds_read_b128 v[140:143], v10 offset:61440
    s_waitcnt lgkmcnt(3)
    s_add_u32 s31, s30, 786432
    buffer_store_dwordx4 v[128:131], v14, s[20:23], s31 offen sc1
    s_waitcnt lgkmcnt(2)
    s_add_u32 s31, s30, 786432
    buffer_store_dwordx4 v[132:135], v15, s[20:23], s31 offen sc1
    s_waitcnt lgkmcnt(1)
    s_add_u32 s31, s30, 786432
    buffer_store_dwordx4 v[136:139], v16, s[20:23], s31 offen sc1
    s_waitcnt lgkmcnt(0)
    s_add_u32 s31, s30, 983040
    buffer_store_dwordx4 v[140:143], v14, s[20:23], s31 offen sc1
    ds_read_b128 v[128:131], v11 offset:0
    ds_read_b128 v[132:135], v11 offset:4096
    ds_read_b128 v[136:139], v11 offset:8192
    ds_read_b128 v[140:143], v11 offset:12288
    s_waitcnt lgkmcnt(3)
    s_add_u32 s31, s30, 983040
    buffer_store_dwordx4 v[128:131], v15, s[20:23], s31 offen sc1
    s_waitcnt lgkmcnt(2)
    s_add_u32 s31, s30, 983040
    buffer_store_dwordx4 v[132:135], v16, s[20:23], s31 offen sc1
    s_waitcnt lgkmcnt(1)
    s_add_u32 s31, s30, 1179648
    buffer_store_dwordx4 v[136:139], v14, s[20:23], s31 offen sc1
    s_waitcnt lgkmcnt(0)
    s_add_u32 s31, s30, 1179648
    buffer_store_dwordx4 v[140:143], v15, s[20:23], s31 offen sc1
    ds_read_b128 v[128:131], v11 offset:16384
    ds_read_b128 v[132:135], v11 offset:20480
    ds_read_b128 v[136:139], v11 offset:24576
    ds_read_b128 v[140:143], v11 offset:28672
    s_waitcnt lgkmcnt(3)
    s_add_u32 s31, s30, 1179648
    buffer_store_dwordx4 v[128:131], v16, s[20:23], s31 offen sc1
    s_waitcnt lgkmcnt(2)
    s_add_u32 s31, s30, 1376256
    buffer_store_dwordx4 v[132:135], v14, s[20:23], s31 offen sc1
    s_waitcnt lgkmcnt(1)
    s_add_u32 s31, s30, 1376256
    buffer_store_dwordx4 v[136:139], v15, s[20:23], s31 offen sc1
    s_waitcnt lgkmcnt(0)
    s_add_u32 s31, s30, 1376256
    buffer_store_dwordx4 v[140:143], v16, s[20:23], s31 offen sc1
    s_branch M_fin
BQ_10_v:
    s_mul_i32 s33, s4, 40960
    s_add_u32 s33, s33, s16
    s_lshl_b32 s37, s18, 3
    s_mul_i32 s34, s4, s37
    s_add_u32 s34, s34, s17
    s_mul_i32 s39, s4, 2048
    s_mul_i32 s40, s4, 5120
    s_add_u32 s40, s40, 8192
    s_lshl_b32 s41, s18, 5
    s_add_u32 m0, s39, 0
    s_add_u32 s38, s33, 0
    buffer_load_dwordx4 v2, s[8:11], s38 offen  lds
    s_add_u32 m0, s39, 1024
    s_add_u32 s38, s33, 20480
    buffer_load_dwordx4 v2, s[8:11], s38 offen  lds
    s_add_u32 m0, s40, 0
    buffer_load_dwordx4 v4, s[12:15], s34 offen lds
    s_add_u32 m0, s40, 1024
    buffer_load_dwordx4 v5, s[12:15], s34 offen lds
    s_add_u32 m0, s40, 2048
    buffer_load_dwordx4 v6, s[12:15], s34 offen lds
    s_add_u32 m0, s40, 3072
    buffer_load_dwordx4 v7, s[12:15], s34 offen lds
    s_add_u32 m0, s40, 4096
    buffer_load_dwordx4 v8, s[12:15], s34 offen lds
    s_add_u32 s33, s33, 64
    s_add_u32 s34, s34, s41
    s_add_u32 m0, s39, 32768
    s_add_u32 s38, s33, 0
    buffer_load_dwordx4 v2, s[8:11], s38 offen  lds
    s_add_u32 m0, s39, 33792
    s_add_u32 s38, s33, 20480
    buffer_load_dwordx4 v2, s[8:11], s38 offen  lds
    s_add_u32 m0, s40, 32768
    buffer_load_dwordx4 v4, s[12:15], s34 offen lds
    s_add_u32 m0, s40, 33792
    buffer_load_dwordx4 v5, s[12:15], s34 offen lds
    s_add_u32 m0, s40, 34816
    buffer_load_dwordx4 v6, s[12:15], s34 offen lds
    s_add_u32 m0, s40, 35840
    buffer_load_dwordx4 v7, s[12:15], s34 offen lds
    s_add_u32 m0, s40, 36864
    buffer_load_dwordx4 v8, s[12:15], s34 offen lds
    s_add_u32 s33, s33, 64
    s_add_u32 s34, s34, s41
    s_add_u32 m0, s39, 65536
    s_add_u32 s38, s33, 0
    buffer_load_dwordx4 v2, s[8:11], s38 offen  lds
    s_add_u32 m0, s39, 66560
    s_add_u32 s38, s33, 20480
    buffer_load_dwordx4 v2, s[8:11], s38 offen  lds
    s_add_u32 m0, s40, 65536
    buffer_load_dwordx4 v4, s[12:15], s34 offen lds
    s_add_u32 m0, s40, 66560
    buffer_load_dwordx4 v5, s[12:15], s34 offen lds
    s_add_u32 m0, s40, 67584
    buffer_load_dwordx4 v6, s[12:15], s34 offen lds
    s_add_u32 m0, s40, 68608
    buffer_load_dwordx4 v7, s[12:15], s34 offen lds
    s_add_u32 m0, s40, 69632
    buffer_load_dwordx4 v8, s[12:15], s34 offen lds
    s_add_u32 s33, s33, 64
    s_add_u32 s34, s34, s41
    v_accvgpr_write_b32 a0, 0
    v_accvgpr_write_b32 a1, 0
    v_accvgpr_write_b32 a2, 0
    v_accvgpr_write_b32 a3, 0
    v_accvgpr_write_b32 a4, 0
    v_accvgpr_write_b32 a5, 0
    v_accvgpr_write_b32 a6, 0
    v_accvgpr_write_b32 a7, 0
    v_accvgpr_write_b32 a8, 0
    v_accvgpr_write_b32 a9, 0
    v_accvgpr_write_b32 a10, 0
    v_accvgpr_write_b32 a11, 0
    v_accvgpr_write_b32 a12, 0
    v_accvgpr_write_b32 a13, 0
    v_accvgpr_write_b32 a14, 0
    v_accvgpr_write_b32 a15, 0
    v_accvgpr_write_b32 a16, 0
    v_accvgpr_write_b32 a17, 0
    v_accvgpr_write_b32 a18, 0
    v_accvgpr_write_b32 a19, 0
    v_accvgpr_write_b32 a20, 0
    v_accvgpr_write_b32 a21, 0
    v_accvgpr_write_b32 a22, 0
    v_accvgpr_write_b32 a23, 0
    v_accvgpr_write_b32 a24, 0
    v_accvgpr_write_b32 a25, 0
    v_accvgpr_write_b32 a26, 0
    v_accvgpr_write_b32 a27, 0
    v_accvgpr_write_b32 a28, 0
    v_accvgpr_write_b32 a29, 0
    v_accvgpr_write_b32 a30, 0
    v_accvgpr_write_b32 a31, 0
    v_accvgpr_write_b32 a32, 0
    v_accvgpr_write_b32 a33, 0
    v_accvgpr_write_b32 a34, 0
    v_accvgpr_write_b32 a35, 0
    v_accvgpr_write_b32 a36, 0
    v_accvgpr_write_b32 a37, 0
    v_accvgpr_write_b32 a38, 0
    v_accvgpr_write_b32 a39, 0
    v_accvgpr_write_b32 a40, 0
    v_accvgpr_write_b32 a41, 0
    v_accvgpr_write_b32 a42, 0
    v_accvgpr_write_b32 a43, 0
    v_accvgpr_write_b32 a44, 0
    v_accvgpr_write_b32 a45, 0
    v_accvgpr_write_b32 a46, 0
    v_accvgpr_write_b32 a47, 0
    v_accvgpr_write_b32 a48, 0
    v_accvgpr_write_b32 a49, 0
    v_accvgpr_write_b32 a50, 0
    v_accvgpr_write_b32 a51, 0
    v_accvgpr_write_b32 a52, 0
    v_accvgpr_write_b32 a53, 0
    v_accvgpr_write_b32 a54, 0
    v_accvgpr_write_b32 a55, 0
    v_accvgpr_write_b32 a56, 0
    v_accvgpr_write_b32 a57, 0
    v_accvgpr_write_b32 a58, 0
    v_accvgpr_write_b32 a59, 0
    v_accvgpr_write_b32 a60, 0
    v_accvgpr_write_b32 a61, 0
    v_accvgpr_write_b32 a62, 0
    v_accvgpr_write_b32 a63, 0
    v_accvgpr_write_b32 a64, 0
    v_accvgpr_write_b32 a65, 0
    v_accvgpr_write_b32 a66, 0
    v_accvgpr_write_b32 a67, 0
    v_accvgpr_write_b32 a68, 0
    v_accvgpr_write_b32 a69, 0
    v_accvgpr_write_b32 a70, 0
    v_accvgpr_write_b32 a71, 0
    v_accvgpr_write_b32 a72, 0
    v_accvgpr_write_b32 a73, 0
    v_accvgpr_write_b32 a74, 0
    v_accvgpr_write_b32 a75, 0
    v_accvgpr_write_b32 a76, 0
    v_accvgpr_write_b32 a77, 0
    v_accvgpr_write_b32 a78, 0
    v_accvgpr_write_b32 a79, 0
    v_accvgpr_write_b32 a80, 0
    v_accvgpr_write_b32 a81, 0
    v_accvgpr_write_b32 a82, 0
    v_accvgpr_write_b32 a83, 0
    v_accvgpr_write_b32 a84, 0
    v_accvgpr_write_b32 a85, 0
    v_accvgpr_write_b32 a86, 0
    v_accvgpr_write_b32 a87, 0
    v_accvgpr_write_b32 a88, 0
    v_accvgpr_write_b32 a89, 0
    v_accvgpr_write_b32 a90, 0
    v_accvgpr_write_b32 a91, 0
    v_accvgpr_write_b32 a92, 0
    v_accvgpr_write_b32 a93, 0
    v_accvgpr_write_b32 a94, 0
    v_accvgpr_write_b32 a95, 0
    v_accvgpr_write_b32 a96, 0
    v_accvgpr_write_b32 a97, 0
    v_accvgpr_write_b32 a98, 0
    v_accvgpr_write_b32 a99, 0
    v_accvgpr_write_b32 a100, 0
    v_accvgpr_write_b32 a101, 0
    v_accvgpr_write_b32 a102, 0
    v_accvgpr_write_b32 a103, 0
    v_accvgpr_write_b32 a104, 0
    v_accvgpr_write_b32 a105, 0
    v_accvgpr_write_b32 a106, 0
    v_accvgpr_write_b32 a107, 0
    v_accvgpr_write_b32 a108, 0
    v_accvgpr_write_b32 a109, 0
    v_accvgpr_write_b32 a110, 0
    v_accvgpr_write_b32 a111, 0
    v_accvgpr_write_b32 a112, 0
    v_accvgpr_write_b32 a113, 0
    v_accvgpr_write_b32 a114, 0
    v_accvgpr_write_b32 a115, 0
    v_accvgpr_write_b32 a116, 0
    v_accvgpr_write_b32 a117, 0
    v_accvgpr_write_b32 a118, 0
    v_accvgpr_write_b32 a119, 0
    v_accvgpr_write_b32 a120, 0
    v_accvgpr_write_b32 a121, 0
    v_accvgpr_write_b32 a122, 0
    v_accvgpr_write_b32 a123, 0
    v_accvgpr_write_b32 a124, 0
    v_accvgpr_write_b32 a125, 0
    v_accvgpr_write_b32 a126, 0
    v_accvgpr_write_b32 a127, 0
    v_accvgpr_write_b32 a128, 0
    v_accvgpr_write_b32 a129, 0
    v_accvgpr_write_b32 a130, 0
    v_accvgpr_write_b32 a131, 0
    v_accvgpr_write_b32 a132, 0
    v_accvgpr_write_b32 a133, 0
    v_accvgpr_write_b32 a134, 0
    v_accvgpr_write_b32 a135, 0
    v_accvgpr_write_b32 a136, 0
    v_accvgpr_write_b32 a137, 0
    v_accvgpr_write_b32 a138, 0
    v_accvgpr_write_b32 a139, 0
    v_accvgpr_write_b32 a140, 0
    v_accvgpr_write_b32 a141, 0
    v_accvgpr_write_b32 a142, 0
    v_accvgpr_write_b32 a143, 0
    v_accvgpr_write_b32 a144, 0
    v_accvgpr_write_b32 a145, 0
    v_accvgpr_write_b32 a146, 0
    v_accvgpr_write_b32 a147, 0
    v_accvgpr_write_b32 a148, 0
    v_accvgpr_write_b32 a149, 0
    v_accvgpr_write_b32 a150, 0
    v_accvgpr_write_b32 a151, 0
    v_accvgpr_write_b32 a152, 0
    v_accvgpr_write_b32 a153, 0
    v_accvgpr_write_b32 a154, 0
    v_accvgpr_write_b32 a155, 0
    v_accvgpr_write_b32 a156, 0
    v_accvgpr_write_b32 a157, 0
    v_accvgpr_write_b32 a158, 0
    v_accvgpr_write_b32 a159, 0
    s_waitcnt vmcnt(14)
    s_barrier
    ds_read_b128 v[32:35], v10 offset:0
    ds_read_b128 v[36:39], v10 offset:2048
    ds_read_b64_tr_b16 v[48:49], v14 offset:0
    ds_read_b64_tr_b16 v[50:51], v14 offset:2560
    ds_read_b64_tr_b16 v[52:53], v16 offset:0
    ds_read_b64_tr_b16 v[54:55], v16 offset:2560
    ds_read_b64_tr_b16 v[56:57], v18 offset:0
    ds_read_b64_tr_b16 v[58:59], v18 offset:2560
    ds_read_b64_tr_b16 v[60:61], v20 offset:0
    ds_read_b64_tr_b16 v[62:63], v20 offset:2560
    ds_read_b64_tr_b16 v[64:65], v22 offset:0
    ds_read_b64_tr_b16 v[66:67], v22 offset:2560
    s_mov_b32 s42, 0
G_12_loop:
    s_waitcnt lgkmcnt(0)
    v_mfma_f32_32x32x16_bf16 a[0:15], v[32:35], v[48:51], a[0:15]
    ds_read_b128 v[68:71], v12 offset:0
    v_mfma_f32_32x32x16_bf16 a[16:31], v[32:35], v[52:55], a[16:31]
    s_add_u32 m0, s39, 98304
    s_add_u32 s38, s33, 0
    buffer_load_dwordx4 v2, s[8:11], s38 offen  lds
    ds_read_b128 v[72:75], v12 offset:2048
    v_mfma_f32_32x32x16_bf16 a[32:47], v[32:35], v[56:59], a[32:47]
    ds_read_b64_tr_b16 v[84:85], v14 offset:10240
    v_mfma_f32_32x32x16_bf16 a[48:63], v[32:35], v[60:63], a[48:63]
    ds_read_b64_tr_b16 v[86:87], v14 offset:12800
    s_add_u32 m0, s39, 99328
    s_add_u32 s38, s33, 20480
    buffer_load_dwordx4 v2, s[8:11], s38 offen  lds
    v_mfma_f32_32x32x16_bf16 a[64:79], v[32:35], v[64:67], a[64:79]
    ds_read_b64_tr_b16 v[88:89], v16 offset:10240
    ds_read_b64_tr_b16 v[90:91], v16 offset:12800
    v_mfma_f32_32x32x16_bf16 a[80:95], v[36:39], v[48:51], a[80:95]
    ds_read_b64_tr_b16 v[92:93], v18 offset:10240
    v_mfma_f32_32x32x16_bf16 a[96:111], v[36:39], v[52:55], a[96:111]
    s_add_u32 m0, s40, 98304
    buffer_load_dwordx4 v4, s[12:15], s34 offen lds
    ds_read_b64_tr_b16 v[94:95], v18 offset:12800
    v_mfma_f32_32x32x16_bf16 a[112:127], v[36:39], v[56:59], a[112:127]
    ds_read_b64_tr_b16 v[96:97], v20 offset:10240
    v_mfma_f32_32x32x16_bf16 a[128:143], v[36:39], v[60:63], a[128:143]
    ds_read_b64_tr_b16 v[98:99], v20 offset:12800
    s_add_u32 m0, s40, 99328
    buffer_load_dwordx4 v5, s[12:15], s34 offen lds
    v_mfma_f32_32x32x16_bf16 a[144:159], v[36:39], v[64:67], a[144:159]
    ds_read_b64_tr_b16 v[100:101], v22 offset:10240
    ds_read_b64_tr_b16 v[102:103], v22 offset:12800
    s_waitcnt lgkmcnt(0)
    v_mfma_f32_32x32x16_bf16 a[0:15], v[68:71], v[84:87], a[0:15]
    v_mfma_f32_32x32x16_bf16 a[16:31], v[68:71], v[88:91], a[16:31]
    v_mfma_f32_32x32x16_bf16 a[32:47], v[68:71], v[92:95], a[32:47]
    s_waitcnt vmcnt(11)
    s_barrier
    v_mfma_f32_32x32x16_bf16 a[48:63], v[68:71], v[96:99], a[48:63]
    ds_read_b128 v[32:35], v10 offset:32768
    s_add_u32 m0, s40, 100352
    buffer_load_dwordx4 v6, s[12:15], s34 offen lds
    v_mfma_f32_32x32x16_bf16 a[64:79], v[68:71], v[100:103], a[64:79]
    ds_read_b128 v[36:39], v10 offset:34816
    ds_read_b64_tr_b16 v[48:49], v14 offset:32768
    v_mfma_f32_32x32x16_bf16 a[80:95], v[72:75], v[84:87], a[80:95]
    ds_read_b64_tr_b16 v[50:51], v14 offset:35328
    ds_read_b64_tr_b16 v[52:53], v16 offset:32768
    v_mfma_f32_32x32x16_bf16 a[96:111], v[72:75], v[88:91], a[96:111]
    s_add_u32 m0, s40, 101376
    buffer_load_dwordx4 v7, s[12:15], s34 offen lds
    ds_read_b64_tr_b16 v[54:55], v16 offset:35328
    v_mfma_f32_32x32x16_bf16 a[112:127], v[72:75], v[92:95], a[112:127]
    ds_read_b64_tr_b16 v[56:57], v18 offset:32768
    ds_read_b64_tr_b16 v[58:59], v18 offset:35328
    v_mfma_f32_32x32x16_bf16 a[128:143], v[72:75], v[96:99], a[128:143]
    ds_read_b64_tr_b16 v[60:61], v20 offset:32768
    s_add_u32 m0, s40, 102400
    buffer_load_dwordx4 v8, s[12:15], s34 offen lds
    v_mfma_f32_32x32x16_bf16 a[144:159], v[72:75], v[100:103], a[144:159]
    ds_read_b64_tr_b16 v[62:63], v20 offset:35328
    ds_read_b64_tr_b16 v[64:65], v22 offset:32768
    ds_read_b64_tr_b16 v[66:67], v22 offset:35328
    s_add_u32 s33, s33, 64
    s_add_u32 s34, s34, s41
    s_cmp_eq_u32 s42, 4
    s_cselect_b32 s10, 0, s10
    s_cselect_b32 s14, 0, s14
    s_waitcnt lgkmcnt(0)
    v_mfma_f32_32x32x16_bf16 a[0:15], v[32:35], v[48:51], a[0:15]
    ds_read_b128 v[68:71], v12 offset:32768
    v_mfma_f32_32x32x16_bf16 a[16:31], v[32:35], v[52:55], a[16:31]
    s_add_u32 m0, s39, 0
    s_add_u32 s38, s33, 0
    buffer_load_dwordx4 v2, s[8:11], s38 offen  lds
    ds_read_b128 v[72:75], v12 offset:34816
    v_mfma_f32_32x32x16_bf16 a[32:47], v[32:35], v[56:59], a[32:47]
    ds_read_b64_tr_b16 v[84:85], v14 offset:43008
    v_mfma_f32_32x32x16_bf16 a[48:63], v[32:35], v[60:63], a[48:63]
    ds_read_b64_tr_b16 v[86:87], v14 offset:45568
    s_add_u32 m0, s39, 1024
    s_add_u32 s38, s33, 20480
    buffer_load_dwordx4 v2, s[8:11], s38 offen  lds
    v_mfma_f32_32x32x16_bf16 a[64:79], v[32:35], v[64:67], a[64:79]
    ds_read_b64_tr_b16 v[88:89], v16 offset:43008
    ds_read_b64_tr_b16 v[90:91], v16 offset:45568
    v_mfma_f32_32x32x16_bf16 a[80:95], v[36:39], v[48:51], a[80:95]
    ds_read_b64_tr_b16 v[92:93], v18 offset:43008
    v_mfma_f32_32x32x16_bf16 a[96:111], v[36:39], v[52:55], a[96:111]
    s_add_u32 m0, s40, 0
    buffer_load_dwordx4 v4, s[12:15], s34 offen lds
    ds_read_b64_tr_b16 v[94:95], v18 offset:45568
    v_mfma_f32_32x32x16_bf16 a[112:127], v[36:39], v[56:59], a[112:127]
    ds_read_b64_tr_b16 v[96:97], v20 offset:43008
    v_mfma_f32_32x32x16_bf16 a[128:143], v[36:39], v[60:63], a[128:143]
    ds_read_b64_tr_b16 v[98:99], v20 offset:45568
    s_add_u32 m0, s40, 1024
    buffer_load_dwordx4 v5, s[12:15], s34 offen lds
    v_mfma_f32_32x32x16_bf16 a[144:159], v[36:39], v[64:67], a[144:159]
    ds_read_b64_tr_b16 v[100:101], v22 offset:43008
    ds_read_b64_tr_b16 v[102:103], v22 offset:45568
    s_waitcnt lgkmcnt(0)
    v_mfma_f32_32x32x16_bf16 a[0:15], v[68:71], v[84:87], a[0:15]
    v_mfma_f32_32x32x16_bf16 a[16:31], v[68:71], v[88:91], a[16:31]
    v_mfma_f32_32x32x16_bf16 a[32:47], v[68:71], v[92:95], a[32:47]
    s_waitcnt vmcnt(11)
    s_barrier
    v_mfma_f32_32x32x16_bf16 a[48:63], v[68:71], v[96:99], a[48:63]
    ds_read_b128 v[32:35], v11 offset:0
    s_add_u32 m0, s40, 2048
    buffer_load_dwordx4 v6, s[12:15], s34 offen lds
    v_mfma_f32_32x32x16_bf16 a[64:79], v[68:71], v[100:103], a[64:79]
    ds_read_b128 v[36:39], v11 offset:2048
    ds_read_b64_tr_b16 v[48:49], v15 offset:0
    v_mfma_f32_32x32x16_bf16 a[80:95], v[72:75], v[84:87], a[80:95]
    ds_read_b64_tr_b16 v[50:51], v15 offset:2560
    ds_read_b64_tr_b16 v[52:53], v17 offset:0
    v_mfma_f32_32x32x16_bf16 a[96:111], v[72:75], v[88:91], a[96:111]
    s_add_u32 m0, s40, 3072
    buffer_load_dwordx4 v7, s[12:15], s34 offen lds
    ds_read_b64_tr_b16 v[54:55], v17 offset:2560
    v_mfma_f32_32x32x16_bf16 a[112:127], v[72:75], v[92:95], a[112:127]
    ds_read_b64_tr_b16 v[56:57], v19 offset:0
    ds_read_b64_tr_b16 v[58:59], v19 offset:2560
    v_mfma_f32_32x32x16_bf16 a[128:143], v[72:75], v[96:99], a[128:143]
    ds_read_b64_tr_b16 v[60:61], v21 offset:0
    s_add_u32 m0, s40, 4096
    buffer_load_dwordx4 v8, s[12:15], s34 offen lds
    v_mfma_f32_32x32x16_bf16 a[144:159], v[72:75], v[100:103], a[144:159]
    ds_read_b64_tr_b16 v[62:63], v21 offset:2560
    ds_read_b64_tr_b16 v[64:65], v23 offset:0
    ds_read_b64_tr_b16 v[66:67], v23 offset:2560
    s_add_u32 s33, s33, 64
    s_add_u32 s34, s34, s41
    s_waitcnt lgkmcnt(0)
    v_mfma_f32_32x32x16_bf16 a[0:15], v[32:35], v[48:51], a[0:15]
    ds_read_b128 v[68:71], v13 offset:0
    v_mfma_f32_32x32x16_bf16 a[16:31], v[32:35], v[52:55], a[16:31]
    s_add_u32 m0, s39, 32768
    s_add_u32 s38, s33, 0
    buffer_load_dwordx4 v2, s[8:11], s38 offen  lds
    ds_read_b128 v[72:75], v13 offset:2048
    v_mfma_f32_32x32x16_bf16 a[32:47], v[32:35], v[56:59], a[32:47]
    ds_read_b64_tr_b16 v[84:85], v15 offset:10240
    v_mfma_f32_32x32x16_bf16 a[48:63], v[32:35], v[60:63], a[48:63]
    ds_read_b64_tr_b16 v[86:87], v15 offset:12800
    s_add_u32 m0, s39, 33792
    s_add_u32 s38, s33, 20480
    buffer_load_dwordx4 v2, s[8:11], s38 offen  lds
    v_mfma_f32_32x32x16_bf16 a[64:79], v[32:35], v[64:67], a[64:79]
    ds_read_b64_tr_b16 v[88:89], v17 offset:10240
    ds_read_b64_tr_b16 v[90:91], v17 offset:12800
    v_mfma_f32_32x32x16_bf16 a[80:95], v[36:39], v[48:51], a[80:95]
    ds_read_b64_tr_b16 v[92:93], v19 offset:10240
    v_mfma_f32_32x32x16_bf16 a[96:111], v[36:39], v[52:55], a[96:111]
    s_add_u32 m0, s40, 32768
    buffer_load_dwordx4 v4, s[12:15], s34 offen lds
    ds_read_b64_tr_b16 v[94:95], v19 offset:12800
    v_mfma_f32_32x32x16_bf16 a[112:127], v[36:39], v[56:59], a[112:127]
    ds_read_b64_tr_b16 v[96:97], v21 offset:10240
    v_mfma_f32_32x32x16_bf16 a[128:143], v[36:39], v[60:63], a[128:143]
    ds_read_b64_tr_b16 v[98:99], v21 offset:12800
    s_add_u32 m0, s40, 33792
    buffer_load_dwordx4 v5, s[12:15], s34 offen lds
    v_mfma_f32_32x32x16_bf16 a[144:159], v[36:39], v[64:67], a[144:159]
    ds_read_b64_tr_b16 v[100:101], v23 offset:10240
    ds_read_b64_tr_b16 v[102:103], v23 offset:12800
    s_waitcnt lgkmcnt(0)
    v_mfma_f32_32x32x16_bf16 a[0:15], v[68:71], v[84:87], a[0:15]
    v_mfma_f32_32x32x16_bf16 a[16:31], v[68:71], v[88:91], a[16:31]
    v_mfma_f32_32x32x16_bf16 a[32:47], v[68:71], v[92:95], a[32:47]
    s_waitcnt vmcnt(11)
    s_barrier
    v_mfma_f32_32x32x16_bf16 a[48:63], v[68:71], v[96:99], a[48:63]
    ds_read_b128 v[32:35], v11 offset:32768
    s_add_u32 m0, s40, 34816
    buffer_load_dwordx4 v6, s[12:15], s34 offen lds
    v_mfma_f32_32x32x16_bf16 a[64:79], v[68:71], v[100:103], a[64:79]
    ds_read_b128 v[36:39], v11 offset:34816
    ds_read_b64_tr_b16 v[48:49], v15 offset:32768
    v_mfma_f32_32x32x16_bf16 a[80:95], v[72:75], v[84:87], a[80:95]
    ds_read_b64_tr_b16 v[50:51], v15 offset:35328
    ds_read_b64_tr_b16 v[52:53], v17 offset:32768
    v_mfma_f32_32x32x16_bf16 a[96:111], v[72:75], v[88:91], a[96:111]
    s_add_u32 m0, s40, 35840
    buffer_load_dwordx4 v7, s[12:15], s34 offen lds
    ds_read_b64_tr_b16 v[54:55], v17 offset:35328
    v_mfma_f32_32x32x16_bf16 a[112:127], v[72:75], v[92:95], a[112:127]
    ds_read_b64_tr_b16 v[56:57], v19 offset:32768
    ds_read_b64_tr_b16 v[58:59], v19 offset:35328
    v_mfma_f32_32x32x16_bf16 a[128:143], v[72:75], v[96:99], a[128:143]
    ds_read_b64_tr_b16 v[60:61], v21 offset:32768
    s_add_u32 m0, s40, 36864
    buffer_load_dwordx4 v8, s[12:15], s34 offen lds
    v_mfma_f32_32x32x16_bf16 a[144:159], v[72:75], v[100:103], a[144:159]
    ds_read_b64_tr_b16 v[62:63], v21 offset:35328
    ds_read_b64_tr_b16 v[64:65], v23 offset:32768
    ds_read_b64_tr_b16 v[66:67], v23 offset:35328
    s_add_u32 s33, s33, 64
    s_add_u32 s34, s34, s41
    s_waitcnt lgkmcnt(0)
    v_mfma_f32_32x32x16_bf16 a[0:15], v[32:35], v[48:51], a[0:15]
    ds_read_b128 v[68:71], v13 offset:32768
    v_mfma_f32_32x32x16_bf16 a[16:31], v[32:35], v[52:55], a[16:31]
    s_add_u32 m0, s39, 65536
    s_add_u32 s38, s33, 0
    buffer_load_dwordx4 v2, s[8:11], s38 offen  lds
    ds_read_b128 v[72:75], v13 offset:34816
    v_mfma_f32_32x32x16_bf16 a[32:47], v[32:35], v[56:59], a[32:47]
    ds_read_b64_tr_b16 v[84:85], v15 offset:43008
    v_mfma_f32_32x32x16_bf16 a[48:63], v[32:35], v[60:63], a[48:63]
    ds_read_b64_tr_b16 v[86:87], v15 offset:45568
    s_add_u32 m0, s39, 66560
    s_add_u32 s38, s33, 20480
    buffer_load_dwordx4 v2, s[8:11], s38 offen  lds
    v_mfma_f32_32x32x16_bf16 a[64:79], v[32:35], v[64:67], a[64:79]
    ds_read_b64_tr_b16 v[88:89], v17 offset:43008
    ds_read_b64_tr_b16 v[90:91], v17 offset:45568
    v_mfma_f32_32x32x16_bf16 a[80:95], v[36:39], v[48:51], a[80:95]
    ds_read_b64_tr_b16 v[92:93], v19 offset:43008
    v_mfma_f32_32x32x16_bf16 a[96:111], v[36:39], v[52:55], a[96:111]
    s_add_u32 m0, s40, 65536
    buffer_load_dwordx4 v4, s[12:15], s34 offen lds
    ds_read_b64_tr_b16 v[94:95], v19 offset:45568
    v_mfma_f32_32x32x16_bf16 a[112:127], v[36:39], v[56:59], a[112:127]
    ds_read_b64_tr_b16 v[96:97], v21 offset:43008
    v_mfma_f32_32x32x16_bf16 a[128:143], v[36:39], v[60:63], a[128:143]
    ds_read_b64_tr_b16 v[98:99], v21 offset:45568
    s_add_u32 m0, s40, 66560
    buffer_load_dwordx4 v5, s[12:15], s34 offen lds
    v_mfma_f32_32x32x16_bf16 a[144:159], v[36:39], v[64:67], a[144:159]
    ds_read_b64_tr_b16 v[100:101], v23 offset:43008
    ds_read_b64_tr_b16 v[102:103], v23 offset:45568
    s_waitcnt lgkmcnt(0)
    v_mfma_f32_32x32x16_bf16 a[0:15], v[68:71], v[84:87], a[0:15]
    v_mfma_f32_32x32x16_bf16 a[16:31], v[68:71], v[88:91], a[16:31]
    v_mfma_f32_32x32x16_bf16 a[32:47], v[68:71], v[92:95], a[32:47]
    s_waitcnt vmcnt(11)
    s_barrier
    v_mfma_f32_32x32x16_bf16 a[48:63], v[68:71], v[96:99], a[48:63]
    ds_read_b128 v[32:35], v10 offset:0
    s_add_u32 m0, s40, 67584
    buffer_load_dwordx4 v6, s[12:15], s34 offen lds
    v_mfma_f32_32x32x16_bf16 a[64:79], v[68:71], v[100:103], a[64:79]
    ds_read_b128 v[36:39], v10 offset:2048
    ds_read_b64_tr_b16 v[48:49], v14 offset:0
    v_mfma_f32_32x32x16_bf16 a[80:95], v[72:75], v[84:87], a[80:95]
    ds_read_b64_tr_b16 v[50:51], v14 offset:2560
    ds_read_b64_tr_b16 v[52:53], v16 offset:0
    v_mfma_f32_32x32x16_bf16 a[96:111], v[72:75], v[88:91], a[96:111]
    s_add_u32 m0, s40, 68608
    buffer_load_dwordx4 v7, s[12:15], s34 offen lds
    ds_read_b64_tr_b16 v[54:55], v16 offset:2560
    v_mfma_f32_32x32x16_bf16 a[112:127], v[72:75], v[92:95], a[112:127]
    ds_read_b64_tr_b16 v[56:57], v18 offset:0
    ds_read_b64_tr_b16 v[58:59], v18 offset:2560
    v_mfma_f32_32x32x16_bf16 a[128:143], v[72:75], v[96:99], a[128:143]
    ds_read_b64_tr_b16 v[60:61], v20 offset:0
    s_add_u32 m0, s40, 69632
    buffer_load_dwordx4 v8, s[12:15], s34 offen lds
    v_mfma_f32_32x32x16_bf16 a[144:159], v[72:75], v[100:103], a[144:159]
    ds_read_b64_tr_b16 v[62:63], v20 offset:2560
    ds_read_b64_tr_b16 v[64:65], v22 offset:0
    ds_read_b64_tr_b16 v[66:67], v22 offset:2560
    s_add_u32 s33, s33, 64
    s_add_u32 s34, s34, s41
    s_add_u32 s42, s42, 1
    s_cmp_lt_u32 s42, 5
    s_cbranch_scc1 G_12_loop
    s_waitcnt vmcnt(0) lgkmcnt(0)
    s_nop 15
    s_nop 7
    s_barrier
    s_mul_i32 s24, s28, 1310720
    s_add_u32 s24, s24, 83886080
    s_and_b32 s30, s4, 1
    s_mul_i32 s30, s30, 128
    s_lshr_b32 s31, s4, 1
    s_mul_i32 s31, s31, 43520
    s_add_u32 s30, s30, s31
    v_and_b32 v1, 31, v0
    v_bfe_u32 v5, v0, 5, 1
    v_mul_u32_u24 v1, 272, v1
    v_add_u32 v1, s30, v1
    v_lshl_add_u32 v2, v5, 3, v1
    v_accvgpr_read_b32 v104, a0
    v_accvgpr_read_b32 v105, a1
    v_accvgpr_read_b32 v106, a2
    v_accvgpr_read_b32 v107, a3
    v_accvgpr_read_b32 v108, a4
    v_accvgpr_read_b32 v109, a5
    v_accvgpr_read_b32 v110, a6
    v_accvgpr_read_b32 v111, a7
    v_accvgpr_read_b32 v112, a8
    v_accvgpr_read_b32 v113, a9
    v_accvgpr_read_b32 v114, a10
    v_accvgpr_read_b32 v115, a11
    v_accvgpr_read_b32 v116, a12
    v_accvgpr_read_b32 v117, a13
    v_accvgpr_read_b32 v118, a14
    v_accvgpr_read_b32 v119, a15
    v_cvt_pk_bf16_f32 v128, v104, v105
    v_cvt_pk_bf16_f32 v129, v106, v107
    v_cvt_pk_bf16_f32 v130, v108, v109
    v_cvt_pk_bf16_f32 v131, v110, v111
    v_cvt_pk_bf16_f32 v132, v112, v113
    v_cvt_pk_bf16_f32 v133, v114, v115
    v_cvt_pk_bf16_f32 v134, v116, v117
    v_cvt_pk_bf16_f32 v135, v118, v119
    ds_write_b64 v2, v[128:129] offset:0
    ds_write_b64 v2, v[130:131] offset:16
    ds_write_b64 v2, v[132:133] offset:32
    ds_write_b64 v2, v[134:135] offset:48
    v_accvgpr_read_b32 v104, a16
    v_accvgpr_read_b32 v105, a17
    v_accvgpr_read_b32 v106, a18
    v_accvgpr_read_b32 v107, a19
    v_accvgpr_read_b32 v108, a20
    v_accvgpr_read_b32 v109, a21
    v_accvgpr_read_b32 v110, a22
    v_accvgpr_read_b32 v111, a23
    v_accvgpr_read_b32 v112, a24
    v_accvgpr_read_b32 v113, a25
    v_accvgpr_read_b32 v114, a26
    v_accvgpr_read_b32 v115, a27
    v_accvgpr_read_b32 v116, a28
    v_accvgpr_read_b32 v117, a29
    v_accvgpr_read_b32 v118, a30
    v_accvgpr_read_b32 v119, a31
    v_cvt_pk_bf16_f32 v136, v104, v105
    v_cvt_pk_bf16_f32 v137, v106, v107
    v_cvt_pk_bf16_f32 v138, v108, v109
    v_cvt_pk_bf16_f32 v139, v110, v111
    v_cvt_pk_bf16_f32 v140, v112, v113
    v_cvt_pk_bf16_f32 v141, v114, v115
    v_cvt_pk_bf16_f32 v142, v116, v117
    v_cvt_pk_bf16_f32 v143, v118, v119
    ds_write_b64 v2, v[136:137] offset:8704
    ds_write_b64 v2, v[138:139] offset:8720
    ds_write_b64 v2, v[140:141] offset:8736
    ds_write_b64 v2, v[142:143] offset:8752
    v_accvgpr_read_b32 v104, a32
    v_accvgpr_read_b32 v105, a33
    v_accvgpr_read_b32 v106, a34
    v_accvgpr_read_b32 v107, a35
    v_accvgpr_read_b32 v108, a36
    v_accvgpr_read_b32 v109, a37
    v_accvgpr_read_b32 v110, a38
    v_accvgpr_read_b32 v111, a39
    v_accvgpr_read_b32 v112, a40
    v_accvgpr_read_b32 v113, a41
    v_accvgpr_read_b32 v114, a42
    v_accvgpr_read_b32 v115, a43
    v_accvgpr_read_b32 v116, a44
    v_accvgpr_read_b32 v117, a45
    v_accvgpr_read_b32 v118, a46
    v_accvgpr_read_b32 v119, a47
    v_cvt_pk_bf16_f32 v144, v104, v105
    v_cvt_pk_bf16_f32 v145, v106, v107
    v_cvt_pk_bf16_f32 v146, v108, v109
    v_cvt_pk_bf16_f32 v147, v110, v111
    v_cvt_pk_bf16_f32 v148, v112, v113
    v_cvt_pk_bf16_f32 v149, v114, v115
    v_cvt_pk_bf16_f32 v150, v116, v117
    v_cvt_pk_bf16_f32 v151, v118, v119
    ds_write_b64 v2, v[144:145] offset:17408
    ds_write_b64 v2, v[146:147] offset:17424
    ds_write_b64 v2, v[148:149] offset:17440
    ds_write_b64 v2, v[150:151] offset:17456
    v_accvgpr_read_b32 v104, a48
    v_accvgpr_read_b32 v105, a49
    v_accvgpr_read_b32 v106, a50
    v_accvgpr_read_b32 v107, a51
    v_accvgpr_read_b32 v108, a52
    v_accvgpr_read_b32 v109, a53
    v_accvgpr_read_b32 v110, a54
    v_accvgpr_read_b32 v111, a55
    v_accvgpr_read_b32 v112, a56
    v_accvgpr_read_b32 v113, a57
    v_accvgpr_read_b32 v114, a58
    v_accvgpr_read_b32 v115, a59
    v_accvgpr_read_b32 v116, a60
    v_accvgpr_read_b32 v117, a61
    v_accvgpr_read_b32 v118, a62
    v_accvgpr_read_b32 v119, a63
    v_cvt_pk_bf16_f32 v152, v104, v105
    v_cvt_pk_bf16_f32 v153, v106, v107
    v_cvt_pk_bf16_f32 v154, v108, v109
    v_cvt_pk_bf16_f32 v155, v110, v111
    v_cvt_pk_bf16_f32 v156, v112, v113
    v_cvt_pk_bf16_f32 v157, v114, v115
    v_cvt_pk_bf16_f32 v158, v116, v117
    v_cvt_pk_bf16_f32 v159, v118, v119
    ds_write_b64 v2, v[152:153] offset:26112
    ds_write_b64 v2, v[154:155] offset:26128
    ds_write_b64 v2, v[156:157] offset:26144
    ds_write_b64 v2, v[158:159] offset:26160
    v_accvgpr_read_b32 v104, a64
    v_accvgpr_read_b32 v105, a65
    v_accvgpr_read_b32 v106, a66
    v_accvgpr_read_b32 v107, a67
    v_accvgpr_read_b32 v108, a68
    v_accvgpr_read_b32 v109, a69
    v_accvgpr_read_b32 v110, a70
    v_accvgpr_read_b32 v111, a71
    v_accvgpr_read_b32 v112, a72
    v_accvgpr_read_b32 v113, a73
    v_accvgpr_read_b32 v114, a74
    v_accvgpr_read_b32 v115, a75
    v_accvgpr_read_b32 v116, a76
    v_accvgpr_read_b32 v117, a77
    v_accvgpr_read_b32 v118, a78
    v_accvgpr_read_b32 v119, a79
    v_cvt_pk_bf16_f32 v128, v104, v105
    v_cvt_pk_bf16_f32 v129, v106, v107
    v_cvt_pk_bf16_f32 v130, v108, v109
    v_cvt_pk_bf16_f32 v131, v110, v111
    v_cvt_pk_bf16_f32 v132, v112, v113
    v_cvt_pk_bf16_f32 v133, v114, v115
    v_cvt_pk_bf16_f32 v134, v116, v117
    v_cvt_pk_bf16_f32 v135, v118, v119
    ds_write_b64 v2, v[128:129] offset:34816
    ds_write_b64 v2, v[130:131] offset:34832
    ds_write_b64 v2, v[132:133] offset:34848
    ds_write_b64 v2, v[134:135] offset:34864
    v_accvgpr_read_b32 v104, a80
    v_accvgpr_read_b32 v105, a81
    v_accvgpr_read_b32 v106, a82
    v_accvgpr_read_b32 v107, a83
    v_accvgpr_read_b32 v108, a84
    v_accvgpr_read_b32 v109, a85
    v_accvgpr_read_b32 v110, a86
    v_accvgpr_read_b32 v111, a87
    v_accvgpr_read_b32 v112, a88
    v_accvgpr_read_b32 v113, a89
    v_accvgpr_read_b32 v114, a90
    v_accvgpr_read_b32 v115, a91
    v_accvgpr_read_b32 v116, a92
    v_accvgpr_read_b32 v117, a93
    v_accvgpr_read_b32 v118, a94
    v_accvgpr_read_b32 v119, a95
    v_cvt_pk_bf16_f32 v136, v104, v105
    v_cvt_pk_bf16_f32 v137, v106, v107
    v_cvt_pk_bf16_f32 v138, v108, v109
    v_cvt_pk_bf16_f32 v139, v110, v111
    v_cvt_pk_bf16_f32 v140, v112, v113
    v_cvt_pk_bf16_f32 v141, v114, v115
    v_cvt_pk_bf16_f32 v142, v116, v117
    v_cvt_pk_bf16_f32 v143, v118, v119
    ds_write_b64 v2, v[136:137] offset:64
    ds_write_b64 v2, v[138:139] offset:80
    ds_write_b64 v2, v[140:141] offset:96
    ds_write_b64 v2, v[142:143] offset:112
    v_accvgpr_read_b32 v104, a96
    v_accvgpr_read_b32 v105, a97
    v_accvgpr_read_b32 v106, a98
    v_accvgpr_read_b32 v107, a99
    v_accvgpr_read_b32 v108, a100
    v_accvgpr_read_b32 v109, a101
    v_accvgpr_read_b32 v110, a102
    v_accvgpr_read_b32 v111, a103
    v_accvgpr_read_b32 v112, a104
    v_accvgpr_read_b32 v113, a105
    v_accvgpr_read_b32 v114, a106
    v_accvgpr_read_b32 v115, a107
    v_accvgpr_read_b32 v116, a108
    v_accvgpr_read_b32 v117, a109
    v_accvgpr_read_b32 v118, a110
    v_accvgpr_read_b32 v119, a111
    v_cvt_pk_bf16_f32 v144, v104, v105
    v_cvt_pk_bf16_f32 v145, v106, v107
    v_cvt_pk_bf16_f32 v146, v108, v109
    v_cvt_pk_bf16_f32 v147, v110, v111
    v_cvt_pk_bf16_f32 v148, v112, v113
    v_cvt_pk_bf16_f32 v149, v114, v115
    v_cvt_pk_bf16_f32 v150, v116, v117
    v_cvt_pk_bf16_f32 v151, v118, v119
    ds_write_b64 v2, v[144:145] offset:8768
    ds_write_b64 v2, v[146:147] offset:8784
    ds_write_b64 v2, v[148:149] offset:8800
    ds_write_b64 v2, v[150:151] offset:8816
    v_accvgpr_read_b32 v104, a112
    v_accvgpr_read_b32 v105, a113
    v_accvgpr_read_b32 v106, a114
    v_accvgpr_read_b32 v107, a115
    v_accvgpr_read_b32 v108, a116
    v_accvgpr_read_b32 v109, a117
    v_accvgpr_read_b32 v110, a118
    v_accvgpr_read_b32 v111, a119
    v_accvgpr_read_b32 v112, a120
    v_accvgpr_read_b32 v113, a121
    v_accvgpr_read_b32 v114, a122
    v_accvgpr_read_b32 v115, a123
    v_accvgpr_read_b32 v116, a124
    v_accvgpr_read_b32 v117, a125
    v_accvgpr_read_b32 v118, a126
    v_accvgpr_read_b32 v119, a127
    v_cvt_pk_bf16_f32 v152, v104, v105
    v_cvt_pk_bf16_f32 v153, v106, v107
    v_cvt_pk_bf16_f32 v154, v108, v109
    v_cvt_pk_bf16_f32 v155, v110, v111
    v_cvt_pk_bf16_f32 v156, v112, v113
    v_cvt_pk_bf16_f32 v157, v114, v115
    v_cvt_pk_bf16_f32 v158, v116, v117
    v_cvt_pk_bf16_f32 v159, v118, v119
    ds_write_b64 v2, v[152:153] offset:17472
    ds_write_b64 v2, v[154:155] offset:17488
    ds_write_b64 v2, v[156:157] offset:17504
    ds_write_b64 v2, v[158:159] offset:17520
    v_accvgpr_read_b32 v104, a128
    v_accvgpr_read_b32 v105, a129
    v_accvgpr_read_b32 v106, a130
    v_accvgpr_read_b32 v107, a131
    v_accvgpr_read_b32 v108, a132
    v_accvgpr_read_b32 v109, a133
    v_accvgpr_read_b32 v110, a134
    v_accvgpr_read_b32 v111, a135
    v_accvgpr_read_b32 v112, a136
    v_accvgpr_read_b32 v113, a137
    v_accvgpr_read_b32 v114, a138
    v_accvgpr_read_b32 v115, a139
    v_accvgpr_read_b32 v116, a140
    v_accvgpr_read_b32 v117, a141
    v_accvgpr_read_b32 v118, a142
    v_accvgpr_read_b32 v119, a143
    v_cvt_pk_bf16_f32 v128, v104, v105
    v_cvt_pk_bf16_f32 v129, v106, v107
    v_cvt_pk_bf16_f32 v130, v108, v109
    v_cvt_pk_bf16_f32 v131, v110, v111
    v_cvt_pk_bf16_f32 v132, v112, v113
    v_cvt_pk_bf16_f32 v133, v114, v115
    v_cvt_pk_bf16_f32 v134, v116, v117
    v_cvt_pk_bf16_f32 v135, v118, v119
    ds_write_b64 v2, v[128:129] offset:26176
    ds_write_b64 v2, v[130:131] offset:26192
    ds_write_b64 v2, v[132:133] offset:26208
    ds_write_b64 v2, v[134:135] offset:26224
    v_accvgpr_read_b32 v104, a144
    v_accvgpr_read_b32 v105, a145
    v_accvgpr_read_b32 v106, a146
    v_accvgpr_read_b32 v107, a147
    v_accvgpr_read_b32 v108, a148
    v_accvgpr_read_b32 v109, a149
    v_accvgpr_read_b32 v110, a150
    v_accvgpr_read_b32 v111, a151
    v_accvgpr_read_b32 v112, a152
    v_accvgpr_read_b32 v113, a153
    v_accvgpr_read_b32 v114, a154
    v_accvgpr_read_b32 v115, a155
    v_accvgpr_read_b32 v116, a156
    v_accvgpr_read_b32 v117, a157
    v_accvgpr_read_b32 v118, a158
    v_accvgpr_read_b32 v119, a159
    v_cvt_pk_bf16_f32 v136, v104, v105
    v_cvt_pk_bf16_f32 v137, v106, v107
    v_cvt_pk_bf16_f32 v138, v108, v109
    v_cvt_pk_bf16_f32 v139, v110, v111
    v_cvt_pk_bf16_f32 v140, v112, v113
    v_cvt_pk_bf16_f32 v141, v114, v115
    v_cvt_pk_bf16_f32 v142, v116, v117
    v_cvt_pk_bf16_f32 v143, v118, v119
    ds_write_b64 v2, v[136:137] offset:34880
    ds_write_b64 v2, v[138:139] offset:34896
    ds_write_b64 v2, v[140:141] offset:34912
    ds_write_b64 v2, v[142:143] offset:34928
    s_waitcnt lgkmcnt(0)
    s_barrier
    v_lshrrev_b32 v12, 4, v0
    v_and_b32 v13, 15, v0
    v_mul_u32_u24 v10, 272, v12
    v_lshl_add_u32 v10, v13, 4, v10
    v_lshlrev_b32 v14, 12, v12
    v_lshl_add_u32 v14, v13, 4, v14
    s_lshl_b32 s30, s25, 1
    s_add_u32 s30, s30, s24
    v_add_u32 v11, 43520, v10
    ds_read_b128 v[128:131], v10 offset:0
    ds_read_b128 v[132:135], v10 offset:4352
    ds_read_b128 v[136:139], v10 offset:8704
    ds_read_b128 v[140:143], v10 offset:13056
    s_waitcnt lgkmcnt(3)
    s_add_u32 s31, s30, 0
    buffer_store_dwordx4 v[128:131], v14, s[20:23], s31 offen sc1
    s_waitcnt lgkmcnt(2)
    s_add_u32 s31, s30, 65536
    buffer_store_dwordx4 v[132:135], v14, s[20:23], s31 offen sc1
    s_waitcnt lgkmcnt(1)
    s_add_u32 s31, s30, 131072
    buffer_store_dwordx4 v[136:139], v14, s[20:23], s31 offen sc1
    s_waitcnt lgkmcnt(0)
    s_add_u32 s31, s30, 196608
    buffer_store_dwordx4 v[140:143], v14, s[20:23], s31 offen sc1
    ds_read_b128 v[128:131], v10 offset:17408
    ds_read_b128 v[132:135], v10 offset:21760
    ds_read_b128 v[136:139], v10 offset:26112
    ds_read_b128 v[140:143], v10 offset:30464
    s_waitcnt lgkmcnt(3)
    s_add_u32 s31, s30, 262144
    buffer_store_dwordx4 v[128:131], v14, s[20:23], s31 offen sc1
    s_waitcnt lgkmcnt(2)
    s_add_u32 s31, s30, 327680
    buffer_store_dwordx4 v[132:135], v14, s[20:23], s31 offen sc1
    s_waitcnt lgkmcnt(1)
    s_add_u32 s31, s30, 393216
    buffer_store_dwordx4 v[136:139], v14, s[20:23], s31 offen sc1
    s_waitcnt lgkmcnt(0)
    s_add_u32 s31, s30, 458752
    buffer_store_dwordx4 v[140:143], v14, s[20:23], s31 offen sc1
    ds_read_b128 v[128:131], v10 offset:34816
    ds_read_b128 v[132:135], v10 offset:39168
    ds_read_b128 v[136:139], v11 offset:0
    ds_read_b128 v[140:143], v11 offset:4352
    s_waitcnt lgkmcnt(3)
    s_add_u32 s31, s30, 524288
    buffer_store_dwordx4 v[128:131], v14, s[20:23], s31 offen sc1
    s_waitcnt lgkmcnt(2)
    s_add_u32 s31, s30, 589824
    buffer_store_dwordx4 v[132:135], v14, s[20:23], s31 offen sc1
    s_waitcnt lgkmcnt(1)
    s_add_u32 s31, s30, 655360
    buffer_store_dwordx4 v[136:139], v14, s[20:23], s31 offen sc1
    s_waitcnt lgkmcnt(0)
    s_add_u32 s31, s30, 720896
    buffer_store_dwordx4 v[140:143], v14, s[20:23], s31 offen sc1
    ds_read_b128 v[128:131], v11 offset:8704
    ds_read_b128 v[132:135], v11 offset:13056
    ds_read_b128 v[136:139], v11 offset:17408
    ds_read_b128 v[140:143], v11 offset:21760
    s_waitcnt lgkmcnt(3)
    s_add_u32 s31, s30, 786432
    buffer_store_dwordx4 v[128:131], v14, s[20:23], s31 offen sc1
    s_waitcnt lgkmcnt(2)
    s_add_u32 s31, s30, 851968
    buffer_store_dwordx4 v[132:135], v14, s[20:23], s31 offen sc1
    s_waitcnt lgkmcnt(1)
    s_add_u32 s31, s30, 917504
    buffer_store_dwordx4 v[136:139], v14, s[20:23], s31 offen sc1
    s_waitcnt lgkmcnt(0)
    s_add_u32 s31, s30, 983040
    buffer_store_dwordx4 v[140:143], v14, s[20:23], s31 offen sc1
    ds_read_b128 v[128:131], v11 offset:26112
    ds_read_b128 v[132:135], v11 offset:30464
    ds_read_b128 v[136:139], v11 offset:34816
    ds_read_b128 v[140:143], v11 offset:39168
    s_waitcnt lgkmcnt(3)
    s_add_u32 s31, s30, 1048576
    buffer_store_dwordx4 v[128:131], v14, s[20:23], s31 offen sc1
    s_waitcnt lgkmcnt(2)
    s_add_u32 s31, s30, 1114112
    buffer_store_dwordx4 v[132:135], v14, s[20:23], s31 offen sc1
    s_waitcnt lgkmcnt(1)
    s_add_u32 s31, s30, 1179648
    buffer_store_dwordx4 v[136:139], v14, s[20:23], s31 offen sc1
    s_waitcnt lgkmcnt(0)
    s_add_u32 s31, s30, 1245184
    buffer_store_dwordx4 v[140:143], v14, s[20:23], s31 offen sc1
    s_branch M_fin
M_ba:
    s_sub_u32 s5, s5, 320
    s_lshr_b32 s16, s5, 3
    s_and_b32 s17, s5, 7
    s_lshl_b32 s44, s17, 5
    s_add_u32 s44, s44, s16
    s_lshl_b32 s44, s44, 2
    s_add_u32 s99, s44, 100671488
    s_load_dwordx2 s[8:9], s[0:1], 96
    s_waitcnt lgkmcnt(0)
    s_mov_b32 s10, 0x10000000
    s_mov_b32 s11, 0x20000
    s_and_b32 s44, s97, 1
    s_cmp_lg_u32 s44, 0
    s_cbranch_scc1 WI_13_d
    s_load_dwordx2 s[46:47], s[0:1], 88
    v_mov_b32 v250, 76
    s_mov_b32 s45, 0
    s_waitcnt lgkmcnt(0)
WI_13_l:
    global_load_dword v251, v250, s[46:47] sc1
    s_add_u32 s45, s45, 1
    s_cmp_gt_u32 s45, 200000
    s_cbranch_scc1 WI_13_e
    s_waitcnt vmcnt(0)
    s_movk_i32 s44, 8
    v_cmp_gt_u32 vcc, s44, v251
    s_cbranch_vccz WI_13_e
    s_sleep 4
    s_branch WI_13_l
WI_13_e:
    s_or_b32 s97, s97, 1
WI_13_d:
    s_lshr_b32 s18, s16, 4
    s_add_u32 s44, s18, 0
    s_lshl_b32 s44, s44, 6
    s_add_u32 s44, s44, 100667392
    v_and_b32 v250, 63, v0
    v_min_u32 v250, 15, v250
    v_lshlrev_b32 v250, 2, v250
    s_mov_b32 s45, 0
WF_14_l:
    buffer_load_dword v251, v250, s[8:11], s44 offen sc1
    s_add_u32 s45, s45, 1
    s_cmp_gt_u32 s45, 200000
    s_cbranch_scc1 WF_14_e
    s_waitcnt vmcnt(0)
    v_cmp_ne_u32 vcc, 1, v251
    s_cbranch_vccz WF_14_e
    s_sleep 32
    s_branch WF_14_l
WF_14_e:
    s_add_u32 s44, s18, 2
    s_lshl_b32 s44, s44, 6
    s_add_u32 s44, s44, 100667392
    v_and_b32 v250, 63, v0
    v_min_u32 v250, 15, v250
    v_lshlrev_b32 v250, 2, v250
    s_mov_b32 s45, 0
WF_15_l:
    buffer_load_dword v251, v250, s[8:11], s44 offen sc1
    s_add_u32 s45, s45, 1
    s_cmp_gt_u32 s45, 200000
    s_cbranch_scc1 WF_15_e
    s_waitcnt vmcnt(0)
    v_cmp_ne_u32 vcc, 1, v251
    s_cbranch_vccz WF_15_e
    s_sleep 32
    s_branch WF_15_l
WF_15_e:
    s_add_u32 s44, s18, 4
    s_lshl_b32 s44, s44, 6
    s_add_u32 s44, s44, 100667392
    v_and_b32 v250, 63, v0
    v_min_u32 v250, 15, v250
    v_lshlrev_b32 v250, 2, v250
    s_mov_b32 s45, 0
WF_16_l:
    buffer_load_dword v251, v250, s[8:11], s44 offen sc1
    s_add_u32 s45, s45, 1
    s_cmp_gt_u32 s45, 200000
    s_cbranch_scc1 WF_16_e
    s_waitcnt vmcnt(0)
    v_cmp_ne_u32 vcc, 1, v251
    s_cbranch_vccz WF_16_e
    s_sleep 32
    s_branch WF_16_l
WF_16_e:
    s_mov_b32 s37, 49152
    v_and_b32 v1, 63, v0
    v_lshlrev_b32 v4, 4, v1
    v_and_b32 v6, 31, v1
    v_lshrrev_b32 v7, 5, v1
    v_mov_b32 v10, 0x3f803f80
    v_mov_b32 v11, v10
    v_mov_b32 v12, v10
    v_mov_b32 v13, v10
    v_mov_b64 v[14:15], 0
    v_mov_b64 v[16:17], 0
    v_add_u32 v9, 45376, v4
    ds_write_b128 v9, v[10:13]
    ds_write_b128 v9, v[14:17] offset:1040
    v_add_u32 v9, 94528, v4
    ds_write_b128 v9, v[10:13]
    ds_write_b128 v9, v[14:17] offset:1040
    s_lshl_b32 s31, s17, 8
    s_lshl_b32 s32, s4, 6
    s_add_u32 s31, s31, s32
    s_mul_i32 s31, s31, 48
    s_mul_i32 s32, s16, 98304
    s_add_u32 s31, s31, s32
    s_add_u32 s31, s31, 75497472
    v_mul_u32_u24 v9, 48, v6
    v_lshl_add_u32 v10, v7, 4, v9
    buffer_load_dwordx4 v[32:35], v10, s[8:11], s31 offen offset:0 sc1
    buffer_load_dwordx4 v[36:39], v9, s[8:11], s31 offen offset:32 sc1
    buffer_load_dwordx4 v[40:43], v10, s[8:11], s31 offen offset:1536 sc1
    buffer_load_dwordx4 v[44:47], v9, s[8:11], s31 offen offset:1568 sc1
    s_mov_b32 s30, 0
    s_mov_b32 s34, 0
    s_mul_i32 s31, s16, 98304
    s_mul_i32 s32, s30, 24576
    s_add_u32 s31, s31, s32
    s_mul_i32 s32, s4, 6144
    s_add_u32 s31, s31, s32
    s_add_u32 s31, s31, 79691776
    s_add_u32 s33, s34, s32
    s_mov_b32 m0, s33
    s_nop 0
    buffer_load_dwordx4 v4, s[8:11], s31 offen offset:0 sc1 lds
    buffer_load_dwordx4 v4, s[8:11], s31 offen offset:1024 sc1 lds
    buffer_load_dwordx4 v4, s[8:11], s31 offen offset:2048 sc1 lds
    buffer_load_dwordx4 v4, s[8:11], s31 offen offset:3072 sc1 lds
    s_add_u32 s31, s31, 4096
    s_add_u32 s33, s33, 4096
    s_mov_b32 m0, s33
    s_nop 0
    buffer_load_dwordx4 v4, s[8:11], s31 offen offset:0 sc1 lds
    buffer_load_dwordx4 v4, s[8:11], s31 offen offset:1024 sc1 lds
    s_mul_i32 s31, s16, 20
    s_mul_i32 s32, s4, 5
    s_add_u32 s31, s31, s32
    s_lshl_b32 s31, s31, 12
    s_lshl_b32 s33, s30, 10
    s_add_u32 s31, s31, s33
    s_add_u32 s31, s31, 83886080
    s_mul_i32 s33, s32, 1040
    s_add_u32 s33, s33, s34
    s_add_u32 s33, s33, 24576
    s_mov_b32 m0, s33
    s_add_u32 s33, s33, 1040
    buffer_load_dwordx4 v4, s[8:11], s31 offen sc1 lds
    s_add_u32 s31, s31, 4096
    s_mov_b32 m0, s33
    s_add_u32 s33, s33, 1040
    buffer_load_dwordx4 v4, s[8:11], s31 offen sc1 lds
    s_add_u32 s31, s31, 4096
    s_mov_b32 m0, s33
    s_add_u32 s33, s33, 1040
    buffer_load_dwordx4 v4, s[8:11], s31 offen sc1 lds
    s_add_u32 s31, s31, 4096
    s_mov_b32 m0, s33
    s_add_u32 s33, s33, 1040
    buffer_load_dwordx4 v4, s[8:11], s31 offen sc1 lds
    s_add_u32 s31, s31, 4096
    s_mov_b32 m0, s33
    s_add_u32 s33, s33, 1040
    buffer_load_dwordx4 v4, s[8:11], s31 offen sc1 lds
    s_add_u32 s31, s31, 4096
    s_waitcnt vmcnt(11)
    v_cmp_eq_u32 vcc, 1, v7
    s_nop 1
    v_cndmask_b32_e64 v36, v36, 0, vcc
    v_cndmask_b32_e64 v37, v37, 0, vcc
    v_cndmask_b32_e64 v38, v38, 0, vcc
    v_cndmask_b32_e64 v39, v39, 0, vcc
    v_cndmask_b32_e64 v44, v44, 0, vcc
    v_cndmask_b32_e64 v45, v45, 0, vcc
    v_cndmask_b32_e64 v46, v46, 0, vcc
    v_cndmask_b32_e64 v47, v47, 0, vcc
    v_mov_b64 v[128:129], 0
    v_mov_b64 v[130:131], 0
    v_mov_b64 v[132:133], 0
    v_mov_b64 v[134:135], 0
    v_mov_b64 v[136:137], 0
    v_mov_b64 v[138:139], 0
    v_mov_b64 v[140:141], 0
    v_mov_b64 v[142:143], 0
    v_mov_b64 v[144:145], 0
    v_mov_b64 v[146:147], 0
    v_mov_b64 v[148:149], 0
    v_mov_b64 v[150:151], 0
    v_mov_b64 v[152:153], 0
    v_mov_b64 v[154:155], 0
    v_mov_b64 v[156:157], 0
    v_mov_b64 v[158:159], 0
    s_mov_b32 s35, 0
    s_waitcnt vmcnt(0) lgkmcnt(0)
    s_barrier
BA_18_chunk:
    s_cmp_ge_u32 s35, 3
    s_cbranch_scc1 BA_18_nopf
    s_add_u32 s30, s35, 1
    s_xor_b32 s36, s34, s37
    s_mul_i32 s31, s16, 98304
    s_mul_i32 s32, s30, 24576
    s_add_u32 s31, s31, s32
    s_mul_i32 s32, s4, 6144
    s_add_u32 s31, s31, s32
    s_add_u32 s31, s31, 79691776
    s_add_u32 s33, s36, s32
    s_mov_b32 m0, s33
    s_nop 0
    buffer_load_dwordx4 v4, s[8:11], s31 offen offset:0 sc1 lds
    buffer_load_dwordx4 v4, s[8:11], s31 offen offset:1024 sc1 lds
    buffer_load_dwordx4 v4, s[8:11], s31 offen offset:2048 sc1 lds
    buffer_load_dwordx4 v4, s[8:11], s31 offen offset:3072 sc1 lds
    s_add_u32 s31, s31, 4096
    s_add_u32 s33, s33, 4096
    s_mov_b32 m0, s33
    s_nop 0
    buffer_load_dwordx4 v4, s[8:11], s31 offen offset:0 sc1 lds
    buffer_load_dwordx4 v4, s[8:11], s31 offen offset:1024 sc1 lds
    s_mul_i32 s31, s16, 20
    s_mul_i32 s32, s4, 5
    s_add_u32 s31, s31, s32
    s_lshl_b32 s31, s31, 12
    s_lshl_b32 s33, s30, 10
    s_add_u32 s31, s31, s33
    s_add_u32 s31, s31, 83886080
    s_mul_i32 s33, s32, 1040
    s_add_u32 s33, s33, s36
    s_add_u32 s33, s33, 24576
    s_mov_b32 m0, s33
    s_add_u32 s33, s33, 1040
    buffer_load_dwordx4 v4, s[8:11], s31 offen sc1 lds
    s_add_u32 s31, s31, 4096
    s_mov_b32 m0, s33
    s_add_u32 s33, s33, 1040
    buffer_load_dwordx4 v4, s[8:11], s31 offen sc1 lds
    s_add_u32 s31, s31, 4096
    s_mov_b32 m0, s33
    s_add_u32 s33, s33, 1040
    buffer_load_dwordx4 v4, s[8:11], s31 offen sc1 lds
    s_add_u32 s31, s31, 4096
    s_mov_b32 m0, s33
    s_add_u32 s33, s33, 1040
    buffer_load_dwordx4 v4, s[8:11], s31 offen sc1 lds
    s_add_u32 s31, s31, 4096
    s_mov_b32 m0, s33
    s_add_u32 s33, s33, 1040
    buffer_load_dwordx4 v4, s[8:11], s31 offen sc1 lds
    s_add_u32 s31, s31, 4096
BA_18_nopf:
    v_and_b32 v6, 31, v1
    v_lshrrev_b32 v7, 5, v1
    v_mul_u32_u24 v9, 48, v6
    v_add_u32 v9, s34, v9
    v_lshl_add_u32 v2, v7, 4, v9
    v_add_u32 v8, 32, v9
    v_min_u32 v6, 21, v6
    v_mul_u32_u24 v6, 1040, v6
    v_lshl_add_u32 v6, v7, 3, v6
    v_add_u32 v6, s34, v6
    v_add_u32 v3, 24576, v6
    ds_read_b128 v[160:163], v2
    ds_read_b128 v[164:167], v8
    v_add_u32 v2, 1536, v2
    v_add_u32 v8, 1536, v8
    s_cmp_lg_u32 s35, 0
    s_cbranch_scc1 FM_19
    s_waitcnt lgkmcnt(0)
    v_mfma_f32_32x32x16_bf16 v[80:95], v[160:163], v[32:35], 0
    v_mfma_f32_32x32x16_bf16 v[80:95], v[164:167], v[36:39], v[80:95]
    v_mfma_f32_32x32x16_bf16 v[96:111], v[160:163], v[40:43], 0
    v_mfma_f32_32x32x16_bf16 v[96:111], v[164:167], v[44:47], v[96:111]
    s_nop 7
    s_nop 3
    v_max3_f32 v10, v80, v81, v82
    v_max3_f32 v10, v10, v83, v84
    v_max3_f32 v10, v10, v85, v86
    v_max3_f32 v10, v10, v87, v88
    v_max3_f32 v10, v10, v89, v90
    v_max3_f32 v10, v10, v91, v92
    v_max3_f32 v10, v10, v93, v94
    v_max_f32 v10, v10, v95
    v_mov_b32 v11, v10
    s_nop 1
    v_permlane32_swap_b32 v10, v11
    v_max_f32 v10, v10, v11
    v_sub_f32 v10, 0, v10
    v_mov_b32 v48, v10
    v_mov_b32 v49, v10
    v_mov_b32 v50, v10
    v_mov_b32 v51, v10
    v_mov_b32 v52, v10
    v_mov_b32 v53, v10
    v_mov_b32 v54, v10
    v_mov_b32 v55, v10
    v_mov_b32 v56, v10
    v_mov_b32 v57, v10
    v_mov_b32 v58, v10
    v_mov_b32 v59, v10
    v_mov_b32 v60, v10
    v_mov_b32 v61, v10
    v_mov_b32 v62, v10
    v_mov_b32 v63, v10
    v_max3_f32 v10, v96, v97, v98
    v_max3_f32 v10, v10, v99, v100
    v_max3_f32 v10, v10, v101, v102
    v_max3_f32 v10, v10, v103, v104
    v_max3_f32 v10, v10, v105, v106
    v_max3_f32 v10, v10, v107, v108
    v_max3_f32 v10, v10, v109, v110
    v_max_f32 v10, v10, v111
    v_mov_b32 v11, v10
    s_nop 1
    v_permlane32_swap_b32 v10, v11
    v_max_f32 v10, v10, v11
    v_sub_f32 v10, 0, v10
    v_mov_b32 v64, v10
    v_mov_b32 v65, v10
    v_mov_b32 v66, v10
    v_mov_b32 v67, v10
    v_mov_b32 v68, v10
    v_mov_b32 v69, v10
    v_mov_b32 v70, v10
    v_mov_b32 v71, v10
    v_mov_b32 v72, v10
    v_mov_b32 v73, v10
    v_mov_b32 v74, v10
    v_mov_b32 v75, v10
    v_mov_b32 v76, v10
    v_mov_b32 v77, v10
    v_mov_b32 v78, v10
    v_mov_b32 v79, v10
FM_19:
    s_waitcnt lgkmcnt(0)
    v_mfma_f32_32x32x16_bf16 v[80:95], v[160:163], v[32:35], v[48:63]
    v_mfma_f32_32x32x16_bf16 v[80:95], v[164:167], v[36:39], v[80:95]
    s_nop 7
    s_nop 3
    s_mov_b32 s38, 0
BA_18_t:
    ds_read_b128 v[168:171], v2
    ds_read_b128 v[172:175], v8
    ds_read2_b64 v[176:179], v3 offset0:0 offset1:2
    ds_read2_b64 v[180:183], v3 offset0:4 offset1:6
    v_add_u32 v2, 1536, v2
    v_add_u32 v8, 1536, v8
    v_mfma_f32_32x32x16_bf16 v[96:111], v[160:163], v[40:43], v[64:79]
    v_exp_f32 v80, v80
    v_exp_f32 v81, v81
    v_exp_f32 v82, v82
    v_mfma_f32_32x32x16_bf16 v[96:111], v[164:167], v[44:47], v[96:111]
    v_exp_f32 v83, v83
    v_exp_f32 v84, v84
    v_exp_f32 v85, v85
    v_exp_f32 v86, v86
    v_exp_f32 v87, v87
    v_exp_f32 v88, v88
    v_exp_f32 v89, v89
    v_cvt_pk_bf16_f32 v112, v80, v81
    v_exp_f32 v90, v90
    v_cvt_pk_bf16_f32 v113, v82, v83
    v_exp_f32 v91, v91
    v_cvt_pk_bf16_f32 v114, v84, v85
    v_exp_f32 v92, v92
    v_cvt_pk_bf16_f32 v115, v86, v87
    v_exp_f32 v93, v93
    v_exp_f32 v94, v94
    v_exp_f32 v95, v95
    v_cvt_pk_bf16_f32 v116, v88, v89
    v_cvt_pk_bf16_f32 v117, v90, v91
    v_cvt_pk_bf16_f32 v118, v92, v93
    v_cvt_pk_bf16_f32 v119, v94, v95
    s_waitcnt lgkmcnt(0)
    v_mfma_f32_32x32x16_bf16 v[128:143], v[176:179], v[112:115], v[128:143]
    v_mfma_f32_32x32x16_bf16 v[128:143], v[180:183], v[116:119], v[128:143]
    v_exp_f32 v96, v96
    v_exp_f32 v97, v97
    v_mfma_f32_32x32x16_bf16 v[80:95], v[168:171], v[32:35], v[48:63]
    v_exp_f32 v98, v98
    v_exp_f32 v99, v99
    v_exp_f32 v100, v100
    v_mfma_f32_32x32x16_bf16 v[80:95], v[172:175], v[36:39], v[80:95]
    v_exp_f32 v101, v101
    v_exp_f32 v102, v102
    v_exp_f32 v103, v103
    v_exp_f32 v104, v104
    v_exp_f32 v105, v105
    v_cvt_pk_bf16_f32 v120, v96, v97
    v_exp_f32 v106, v106
    v_cvt_pk_bf16_f32 v121, v98, v99
    v_exp_f32 v107, v107
    v_cvt_pk_bf16_f32 v122, v100, v101
    v_exp_f32 v108, v108
    v_cvt_pk_bf16_f32 v123, v102, v103
    v_exp_f32 v109, v109
    v_exp_f32 v110, v110
    v_exp_f32 v111, v111
    v_cvt_pk_bf16_f32 v124, v104, v105
    v_cvt_pk_bf16_f32 v125, v106, v107
    v_cvt_pk_bf16_f32 v126, v108, v109
    v_cvt_pk_bf16_f32 v127, v110, v111
    v_add_u32 v3, 64, v3
    s_nop 0
    v_mfma_f32_32x32x16_bf16 v[144:159], v[176:179], v[120:123], v[144:159]
    v_mfma_f32_32x32x16_bf16 v[144:159], v[180:183], v[124:127], v[144:159]
    ds_read_b128 v[160:163], v2
    ds_read_b128 v[164:167], v8
    ds_read2_b64 v[184:187], v3 offset0:0 offset1:2
    ds_read2_b64 v[188:191], v3 offset0:4 offset1:6
    v_add_u32 v2, 1536, v2
    v_add_u32 v8, 1536, v8
    v_mfma_f32_32x32x16_bf16 v[96:111], v[168:171], v[40:43], v[64:79]
    v_exp_f32 v80, v80
    v_exp_f32 v81, v81
    v_exp_f32 v82, v82
    v_mfma_f32_32x32x16_bf16 v[96:111], v[172:175], v[44:47], v[96:111]
    v_exp_f32 v83, v83
    v_exp_f32 v84, v84
    v_exp_f32 v85, v85
    v_exp_f32 v86, v86
    v_exp_f32 v87, v87
    v_exp_f32 v88, v88
    v_exp_f32 v89, v89
    v_cvt_pk_bf16_f32 v112, v80, v81
    v_exp_f32 v90, v90
    v_cvt_pk_bf16_f32 v113, v82, v83
    v_exp_f32 v91, v91
    v_cvt_pk_bf16_f32 v114, v84, v85
    v_exp_f32 v92, v92
    v_cvt_pk_bf16_f32 v115, v86, v87
    v_exp_f32 v93, v93
    v_exp_f32 v94, v94
    v_exp_f32 v95, v95
    v_cvt_pk_bf16_f32 v116, v88, v89
    v_cvt_pk_bf16_f32 v117, v90, v91
    v_cvt_pk_bf16_f32 v118, v92, v93
    v_cvt_pk_bf16_f32 v119, v94, v95
    s_waitcnt lgkmcnt(0)
    v_mfma_f32_32x32x16_bf16 v[128:143], v[184:187], v[112:115], v[128:143]
    v_mfma_f32_32x32x16_bf16 v[128:143], v[188:191], v[116:119], v[128:143]
    v_exp_f32 v96, v96
    v_exp_f32 v97, v97
    v_mfma_f32_32x32x16_bf16 v[80:95], v[160:163], v[32:35], v[48:63]
    v_exp_f32 v98, v98
    v_exp_f32 v99, v99
    v_exp_f32 v100, v100
    v_mfma_f32_32x32x16_bf16 v[80:95], v[164:167], v[36:39], v[80:95]
    v_exp_f32 v101, v101
    v_exp_f32 v102, v102
    v_exp_f32 v103, v103
    v_exp_f32 v104, v104
    v_exp_f32 v105, v105
    v_cvt_pk_bf16_f32 v120, v96, v97
    v_exp_f32 v106, v106
    v_cvt_pk_bf16_f32 v121, v98, v99
    v_exp_f32 v107, v107
    v_cvt_pk_bf16_f32 v122, v100, v101
    v_exp_f32 v108, v108
    v_cvt_pk_bf16_f32 v123, v102, v103
    v_exp_f32 v109, v109
    v_exp_f32 v110, v110
    v_exp_f32 v111, v111
    v_cvt_pk_bf16_f32 v124, v104, v105
    v_cvt_pk_bf16_f32 v125, v106, v107
    v_cvt_pk_bf16_f32 v126, v108, v109
    v_cvt_pk_bf16_f32 v127, v110, v111
    v_add_u32 v3, 64, v3
    s_nop 0
    v_mfma_f32_32x32x16_bf16 v[144:159], v[184:187], v[120:123], v[144:159]
    v_mfma_f32_32x32x16_bf16 v[144:159], v[188:191], v[124:127], v[144:159]
    s_add_u32 s38, s38, 1
    s_cmp_lt_u32 s38, 8
    s_cbranch_scc1 BA_18_t
    s_waitcnt vmcnt(0) lgkmcnt(0)
    s_barrier
    s_xor_b32 s34, s34, s37
    s_add_u32 s35, s35, 1
    s_cmp_lt_u32 s35, 4
    s_cbranch_scc1 BA_18_chunk
    s_nop 7
    s_nop 3
    v_mov_b32 v10, 0
    v_add_f32_e64 v10, v10, abs(v128)
    v_add_f32_e64 v10, v10, abs(v129)
    v_add_f32_e64 v10, v10, abs(v130)
    v_add_f32_e64 v10, v10, abs(v131)
    v_add_f32_e64 v10, v10, abs(v132)
    v_add_f32_e64 v10, v10, abs(v133)
    v_add_f32_e64 v10, v10, abs(v134)
    v_add_f32_e64 v10, v10, abs(v135)
    v_add_f32_e64 v10, v10, abs(v136)
    v_add_f32_e64 v10, v10, abs(v137)
    v_add_f32_e64 v10, v10, abs(v138)
    v_add_f32_e64 v10, v10, abs(v139)
    v_add_f32_e64 v10, v10, abs(v144)
    v_add_f32_e64 v10, v10, abs(v145)
    v_add_f32_e64 v10, v10, abs(v146)
    v_add_f32_e64 v10, v10, abs(v147)
    v_add_f32_e64 v10, v10, abs(v148)
    v_add_f32_e64 v10, v10, abs(v149)
    v_add_f32_e64 v10, v10, abs(v150)
    v_add_f32_e64 v10, v10, abs(v151)
    v_add_f32_e64 v10, v10, abs(v152)
    v_add_f32_e64 v10, v10, abs(v153)
    v_add_f32_e64 v10, v10, abs(v154)
    v_add_f32_e64 v10, v10, abs(v155)
    s_mov_b32 s31, 0x207
    v_cmp_class_f32 vcc, v10, s31
    v_mov_b32 v11, 98304
    v_mov_b32 v12, 0
    s_cmp_eq_u32 s4, 0
    s_cbranch_scc0 BT_17_nz
    ds_write_b32 v11, v12
BT_17_nz:
    s_waitcnt lgkmcnt(0)
    s_barrier
    s_cbranch_vccz BT_17_ok
    v_mov_b32 v12, 1
    ds_write_b32 v11, v12
    s_waitcnt lgkmcnt(0)
BT_17_ok:
    s_barrier
    ds_read_b32 v12, v11
    s_waitcnt lgkmcnt(0)
    v_readfirstlane_b32 s31, v12
    s_nop 3
    s_cmp_eq_u32 s31, 0
    s_cbranch_scc1 BT_17_out
    s_mov_b32 s30, 0
    s_mov_b32 s34, 0
    s_mul_i32 s31, s16, 98304
    s_mul_i32 s32, s30, 24576
    s_add_u32 s31, s31, s32
    s_mul_i32 s32, s4, 6144
    s_add_u32 s31, s31, s32
    s_add_u32 s31, s31, 79691776
    s_add_u32 s33, s34, s32
    s_mov_b32 m0, s33
    s_nop 0
    buffer_load_dwordx4 v4, s[8:11], s31 offen offset:0 sc1 lds
    buffer_load_dwordx4 v4, s[8:11], s31 offen offset:1024 sc1 lds
    buffer_load_dwordx4 v4, s[8:11], s31 offen offset:2048 sc1 lds
    buffer_load_dwordx4 v4, s[8:11], s31 offen offset:3072 sc1 lds
    s_add_u32 s31, s31, 4096
    s_add_u32 s33, s33, 4096
    s_mov_b32 m0, s33
    s_nop 0
    buffer_load_dwordx4 v4, s[8:11], s31 offen offset:0 sc1 lds
    buffer_load_dwordx4 v4, s[8:11], s31 offen offset:1024 sc1 lds
    s_mul_i32 s31, s16, 20
    s_mul_i32 s32, s4, 5
    s_add_u32 s31, s31, s32
    s_lshl_b32 s31, s31, 12
    s_lshl_b32 s33, s30, 10
    s_add_u32 s31, s31, s33
    s_add_u32 s31, s31, 83886080
    s_mul_i32 s33, s32, 1040
    s_add_u32 s33, s33, s34
    s_add_u32 s33, s33, 24576
    s_mov_b32 m0, s33
    s_add_u32 s33, s33, 1040
    buffer_load_dwordx4 v4, s[8:11], s31 offen sc1 lds
    s_add_u32 s31, s31, 4096
    s_mov_b32 m0, s33
    s_add_u32 s33, s33, 1040
    buffer_load_dwordx4 v4, s[8:11], s31 offen sc1 lds
    s_add_u32 s31, s31, 4096
    s_mov_b32 m0, s33
    s_add_u32 s33, s33, 1040
    buffer_load_dwordx4 v4, s[8:11], s31 offen sc1 lds
    s_add_u32 s31, s31, 4096
    s_mov_b32 m0, s33
    s_add_u32 s33, s33, 1040
    buffer_load_dwordx4 v4, s[8:11], s31 offen sc1 lds
    s_add_u32 s31, s31, 4096
    s_mov_b32 m0, s33
    s_add_u32 s33, s33, 1040
    buffer_load_dwordx4 v4, s[8:11], s31 offen sc1 lds
    s_add_u32 s31, s31, 4096
    v_mov_b64 v[128:129], 0
    v_mov_b64 v[130:131], 0
    v_mov_b64 v[132:133], 0
    v_mov_b64 v[134:135], 0
    v_mov_b64 v[136:137], 0
    v_mov_b64 v[138:139], 0
    v_mov_b64 v[140:141], 0
    v_mov_b64 v[142:143], 0
    v_mov_b64 v[144:145], 0
    v_mov_b64 v[146:147], 0
    v_mov_b64 v[148:149], 0
    v_mov_b64 v[150:151], 0
    v_mov_b64 v[152:153], 0
    v_mov_b64 v[154:155], 0
    v_mov_b64 v[156:157], 0
    v_mov_b64 v[158:159], 0
    s_mov_b32 s35, 0
    s_waitcnt vmcnt(0) lgkmcnt(0)
    s_barrier
BA_20_chunk:
    s_cmp_ge_u32 s35, 3
    s_cbranch_scc1 BA_20_nopf
    s_add_u32 s30, s35, 1
    s_xor_b32 s36, s34, s37
    s_mul_i32 s31, s16, 98304
    s_mul_i32 s32, s30, 24576
    s_add_u32 s31, s31, s32
    s_mul_i32 s32, s4, 6144
    s_add_u32 s31, s31, s32
    s_add_u32 s31, s31, 79691776
    s_add_u32 s33, s36, s32
    s_mov_b32 m0, s33
    s_nop 0
    buffer_load_dwordx4 v4, s[8:11], s31 offen offset:0 sc1 lds
    buffer_load_dwordx4 v4, s[8:11], s31 offen offset:1024 sc1 lds
    buffer_load_dwordx4 v4, s[8:11], s31 offen offset:2048 sc1 lds
    buffer_load_dwordx4 v4, s[8:11], s31 offen offset:3072 sc1 lds
    s_add_u32 s31, s31, 4096
    s_add_u32 s33, s33, 4096
    s_mov_b32 m0, s33
    s_nop 0
    buffer_load_dwordx4 v4, s[8:11], s31 offen offset:0 sc1 lds
    buffer_load_dwordx4 v4, s[8:11], s31 offen offset:1024 sc1 lds
    s_mul_i32 s31, s16, 20
    s_mul_i32 s32, s4, 5
    s_add_u32 s31, s31, s32
    s_lshl_b32 s31, s31, 12
    s_lshl_b32 s33, s30, 10
    s_add_u32 s31, s31, s33
    s_add_u32 s31, s31, 83886080
    s_mul_i32 s33, s32, 1040
    s_add_u32 s33, s33, s36
    s_add_u32 s33, s33, 24576
    s_mov_b32 m0, s33
    s_add_u32 s33, s33, 1040
    buffer_load_dwordx4 v4, s[8:11], s31 offen sc1 lds
    s_add_u32 s31, s31, 4096
    s_mov_b32 m0, s33
    s_add_u32 s33, s33, 1040
    buffer_load_dwordx4 v4, s[8:11], s31 offen sc1 lds
    s_add_u32 s31, s31, 4096
    s_mov_b32 m0, s33
    s_add_u32 s33, s33, 1040
    buffer_load_dwordx4 v4, s[8:11], s31 offen sc1 lds
    s_add_u32 s31, s31, 4096
    s_mov_b32 m0, s33
    s_add_u32 s33, s33, 1040
    buffer_load_dwordx4 v4, s[8:11], s31 offen sc1 lds
    s_add_u32 s31, s31, 4096
    s_mov_b32 m0, s33
    s_add_u32 s33, s33, 1040
    buffer_load_dwordx4 v4, s[8:11], s31 offen sc1 lds
    s_add_u32 s31, s31, 4096
BA_20_nopf:
    v_and_b32 v6, 31, v1
    v_lshrrev_b32 v7, 5, v1
    v_mul_u32_u24 v9, 48, v6
    v_add_u32 v9, s34, v9
    v_lshl_add_u32 v2, v7, 4, v9
    v_add_u32 v8, 32, v9
    v_min_u32 v6, 21, v6
    v_mul_u32_u24 v6, 1040, v6
    v_lshl_add_u32 v6, v7, 3, v6
    v_add_u32 v6, s34, v6
    v_add_u32 v3, 24576, v6
    s_cmp_lg_u32 s35, 0
    s_cbranch_scc1 SF_21
    v_mov_b32 v48, 0xff800000
    v_mov_b32 v64, 0xff800000
SF_21:
    s_mov_b32 s38, 0
BA_20_t:
    ds_read_b128 v[160:163], v2
    ds_read_b128 v[164:167], v8
    ds_read2_b64 v[176:179], v3 offset0:0 offset1:2
    ds_read2_b64 v[180:183], v3 offset0:4 offset1:6
    v_add_u32 v2, 1536, v2
    v_add_u32 v8, 1536, v8
    v_add_u32 v3, 64, v3
    s_waitcnt lgkmcnt(0)
    v_mfma_f32_32x32x16_bf16 v[80:95], v[160:163], v[32:35], 0
    v_mfma_f32_32x32x16_bf16 v[80:95], v[164:167], v[36:39], v[80:95]
    s_nop 7
    s_nop 3
    v_max3_f32 v10, v80, v81, v82
    v_max3_f32 v10, v10, v83, v84
    v_max3_f32 v10, v10, v85, v86
    v_max3_f32 v10, v10, v87, v88
    v_max3_f32 v10, v10, v89, v90
    v_max3_f32 v10, v10, v91, v92
    v_max3_f32 v10, v10, v93, v94
    v_max_f32 v10, v10, v95
    v_mov_b32 v11, v10
    s_nop 1
    v_permlane32_swap_b32 v10, v11
    v_max3_f32 v10, v10, v11, v48
    v_sub_f32 v11, v48, v10
    v_exp_f32 v11, v11
    v_mov_b32 v48, v10
    v_sub_f32 v80, v80, v10
    v_sub_f32 v81, v81, v10
    v_sub_f32 v82, v82, v10
    v_sub_f32 v83, v83, v10
    v_sub_f32 v84, v84, v10
    v_sub_f32 v85, v85, v10
    v_sub_f32 v86, v86, v10
    v_sub_f32 v87, v87, v10
    v_sub_f32 v88, v88, v10
    v_sub_f32 v89, v89, v10
    v_sub_f32 v90, v90, v10
    v_sub_f32 v91, v91, v10
    v_sub_f32 v92, v92, v10
    v_sub_f32 v93, v93, v10
    v_sub_f32 v94, v94, v10
    v_sub_f32 v95, v95, v10
    v_exp_f32 v80, v80
    v_exp_f32 v81, v81
    v_exp_f32 v82, v82
    v_exp_f32 v83, v83
    v_exp_f32 v84, v84
    v_exp_f32 v85, v85
    v_exp_f32 v86, v86
    v_exp_f32 v87, v87
    v_exp_f32 v88, v88
    v_exp_f32 v89, v89
    v_exp_f32 v90, v90
    v_exp_f32 v91, v91
    v_exp_f32 v92, v92
    v_exp_f32 v93, v93
    v_exp_f32 v94, v94
    v_exp_f32 v95, v95
    v_mul_f32 v128, v11, v128
    v_mul_f32 v129, v11, v129
    v_mul_f32 v130, v11, v130
    v_mul_f32 v131, v11, v131
    v_mul_f32 v132, v11, v132
    v_mul_f32 v133, v11, v133
    v_mul_f32 v134, v11, v134
    v_mul_f32 v135, v11, v135
    v_mul_f32 v136, v11, v136
    v_mul_f32 v137, v11, v137
    v_mul_f32 v138, v11, v138
    v_mul_f32 v139, v11, v139
    v_mul_f32 v140, v11, v140
    v_mul_f32 v141, v11, v141
    v_mul_f32 v142, v11, v142
    v_mul_f32 v143, v11, v143
    v_cvt_pk_bf16_f32 v112, v80, v81
    v_cvt_pk_bf16_f32 v113, v82, v83
    v_cvt_pk_bf16_f32 v114, v84, v85
    v_cvt_pk_bf16_f32 v115, v86, v87
    v_cvt_pk_bf16_f32 v116, v88, v89
    v_cvt_pk_bf16_f32 v117, v90, v91
    v_cvt_pk_bf16_f32 v118, v92, v93
    v_cvt_pk_bf16_f32 v119, v94, v95
    s_nop 1
    v_mfma_f32_32x32x16_bf16 v[128:143], v[176:179], v[112:115], v[128:143]
    v_mfma_f32_32x32x16_bf16 v[128:143], v[180:183], v[116:119], v[128:143]
    s_nop 7
    s_nop 3
    v_mfma_f32_32x32x16_bf16 v[96:111], v[160:163], v[40:43], 0
    v_mfma_f32_32x32x16_bf16 v[96:111], v[164:167], v[44:47], v[96:111]
    s_nop 7
    s_nop 3
    v_max3_f32 v10, v96, v97, v98
    v_max3_f32 v10, v10, v99, v100
    v_max3_f32 v10, v10, v101, v102
    v_max3_f32 v10, v10, v103, v104
    v_max3_f32 v10, v10, v105, v106
    v_max3_f32 v10, v10, v107, v108
    v_max3_f32 v10, v10, v109, v110
    v_max_f32 v10, v10, v111
    v_mov_b32 v11, v10
    s_nop 1
    v_permlane32_swap_b32 v10, v11
    v_max3_f32 v10, v10, v11, v64
    v_sub_f32 v11, v64, v10
    v_exp_f32 v11, v11
    v_mov_b32 v64, v10
    v_sub_f32 v96, v96, v10
    v_sub_f32 v97, v97, v10
    v_sub_f32 v98, v98, v10
    v_sub_f32 v99, v99, v10
    v_sub_f32 v100, v100, v10
    v_sub_f32 v101, v101, v10
    v_sub_f32 v102, v102, v10
    v_sub_f32 v103, v103, v10
    v_sub_f32 v104, v104, v10
    v_sub_f32 v105, v105, v10
    v_sub_f32 v106, v106, v10
    v_sub_f32 v107, v107, v10
    v_sub_f32 v108, v108, v10
    v_sub_f32 v109, v109, v10
    v_sub_f32 v110, v110, v10
    v_sub_f32 v111, v111, v10
    v_exp_f32 v96, v96
    v_exp_f32 v97, v97
    v_exp_f32 v98, v98
    v_exp_f32 v99, v99
    v_exp_f32 v100, v100
    v_exp_f32 v101, v101
    v_exp_f32 v102, v102
    v_exp_f32 v103, v103
    v_exp_f32 v104, v104
    v_exp_f32 v105, v105
    v_exp_f32 v106, v106
    v_exp_f32 v107, v107
    v_exp_f32 v108, v108
    v_exp_f32 v109, v109
    v_exp_f32 v110, v110
    v_exp_f32 v111, v111
    v_mul_f32 v144, v11, v144
    v_mul_f32 v145, v11, v145
    v_mul_f32 v146, v11, v146
    v_mul_f32 v147, v11, v147
    v_mul_f32 v148, v11, v148
    v_mul_f32 v149, v11, v149
    v_mul_f32 v150, v11, v150
    v_mul_f32 v151, v11, v151
    v_mul_f32 v152, v11, v152
    v_mul_f32 v153, v11, v153
    v_mul_f32 v154, v11, v154
    v_mul_f32 v155, v11, v155
    v_mul_f32 v156, v11, v156
    v_mul_f32 v157, v11, v157
    v_mul_f32 v158, v11, v158
    v_mul_f32 v159, v11, v159
    v_cvt_pk_bf16_f32 v120, v96, v97
    v_cvt_pk_bf16_f32 v121, v98, v99
    v_cvt_pk_bf16_f32 v122, v100, v101
    v_cvt_pk_bf16_f32 v123, v102, v103
    v_cvt_pk_bf16_f32 v124, v104, v105
    v_cvt_pk_bf16_f32 v125, v106, v107
    v_cvt_pk_bf16_f32 v126, v108, v109
    v_cvt_pk_bf16_f32 v127, v110, v111
    s_nop 1
    v_mfma_f32_32x32x16_bf16 v[144:159], v[176:179], v[120:123], v[144:159]
    v_mfma_f32_32x32x16_bf16 v[144:159], v[180:183], v[124:127], v[144:159]
    s_nop 7
    s_nop 3
    s_add_u32 s38, s38, 1
    s_cmp_lt_u32 s38, 16
    s_cbranch_scc1 BA_20_t
    s_waitcnt vmcnt(0) lgkmcnt(0)
    s_barrier
    s_xor_b32 s34, s34, s37
    s_add_u32 s35, s35, 1
    s_cmp_lt_u32 s35, 4
    s_cbranch_scc1 BA_20_chunk
    s_nop 7
    s_nop 3
BT_17_out:
    v_and_b32 v6, 31, v1
    v_lshrrev_b32 v7, 5, v1
    v_mul_u32_u24 v9, 1280, v6
    v_lshl_add_u32 v9, v7, 3, v9
    s_lshl_b32 s31, s17, 8
    s_lshl_b32 s32, s4, 6
    s_add_u32 s31, s31, s32
    s_mul_i32 s31, s31, 1280
    s_mul_i32 s32, s16, 40
    s_add_u32 s31, s31, s32
    s_add_u32 s31, s31, 88080384
    s_mov_b32 s40, -1
    s_mov_b32 s41, 0
    v_mov_b32 v10, v136
    v_mov_b32 v11, v136
    s_nop 1
    v_permlane32_swap_b32 v10, v11
    v_rcp_f32 v11, v11
    s_nop 0
    v_mul_f32 v128, v11, v128
    v_mul_f32 v129, v11, v129
    v_mul_f32 v130, v11, v130
    v_mul_f32 v131, v11, v131
    v_mul_f32 v132, v11, v132
    v_mul_f32 v133, v11, v133
    v_mul_f32 v134, v11, v134
    v_mul_f32 v135, v11, v135
    v_mul_f32 v136, v11, v136
    v_mul_f32 v137, v11, v137
    v_mul_f32 v138, v11, v138
    v_mul_f32 v139, v11, v139
    v_cvt_pk_bf16_f32 v128, v128, v129
    v_cvt_pk_bf16_f32 v129, v130, v131
    v_cvt_pk_bf16_f32 v130, v132, v133
    v_cvt_pk_bf16_f32 v131, v134, v135
    v_cvt_pk_bf16_f32 v132, v136, v137
    v_cvt_pk_bf16_f32 v133, v138, v139
    s_add_u32 s32, s31, 0
    buffer_store_dwordx2 v[128:129], v9, s[8:11], s32 offen sc1
    buffer_store_dwordx2 v[130:131], v9, s[8:11], s32 offen offset:16 sc1
    s_mov_b64 exec, s[40:41]
    buffer_store_dwordx2 v[132:133], v9, s[8:11], s32 offen offset:32 sc1
    s_mov_b64 exec, -1
    v_mov_b32 v10, v152
    v_mov_b32 v11, v152
    s_nop 1
    v_permlane32_swap_b32 v10, v11
    v_rcp_f32 v11, v11
    s_nop 0
    v_mul_f32 v144, v11, v144
    v_mul_f32 v145, v11, v145
    v_mul_f32 v146, v11, v146
    v_mul_f32 v147, v11, v147
    v_mul_f32 v148, v11, v148
    v_mul_f32 v149, v11, v149
    v_mul_f32 v150, v11, v150
    v_mul_f32 v151, v11, v151
    v_mul_f32 v152, v11, v152
    v_mul_f32 v153, v11, v153
    v_mul_f32 v154, v11, v154
    v_mul_f32 v155, v11, v155
    v_cvt_pk_bf16_f32 v144, v144, v145
    v_cvt_pk_bf16_f32 v145, v146, v147
    v_cvt_pk_bf16_f32 v146, v148, v149
    v_cvt_pk_bf16_f32 v147, v150, v151
    v_cvt_pk_bf16_f32 v148, v152, v153
    v_cvt_pk_bf16_f32 v149, v154, v155
    s_add_u32 s32, s31, 40960
    buffer_store_dwordx2 v[144:145], v9, s[8:11], s32 offen sc1
    buffer_store_dwordx2 v[146:147], v9, s[8:11], s32 offen offset:16 sc1
    s_mov_b64 exec, s[40:41]
    buffer_store_dwordx2 v[148:149], v9, s[8:11], s32 offen offset:32 sc1
    s_mov_b64 exec, -1
    s_branch M_fin
M_bo:
    s_sub_u32 s5, s5, 576
    s_load_dwordx2 s[8:9], s[0:1], 96
    s_waitcnt lgkmcnt(0)
    s_mov_b32 s10, 0x10000000
    s_mov_b32 s11, 0x20000
    s_and_b32 s44, s97, 1
    s_cmp_lg_u32 s44, 0
    s_cbranch_scc1 WI_22_d
    s_load_dwordx2 s[46:47], s[0:1], 88
    v_mov_b32 v250, 76
    s_mov_b32 s45, 0
    s_waitcnt lgkmcnt(0)
WI_22_l:
    global_load_dword v251, v250, s[46:47] sc1
    s_add_u32 s45, s45, 1
    s_cmp_gt_u32 s45, 200000
    s_cbranch_scc1 WI_22_e
    s_waitcnt vmcnt(0)
    s_movk_i32 s44, 8
    v_cmp_gt_u32 vcc, s44, v251
    s_cbranch_vccz WI_22_e
    s_sleep 4
    s_branch WI_22_l
WI_22_e:
    s_or_b32 s97, s97, 1
WI_22_d:
    s_lshr_b32 s44, s5, 2
    s_lshl_b32 s44, s44, 7
    s_add_u32 s44, s44, 100671488
    v_and_b32 v250, 63, v0
    v_min_u32 v250, 31, v250
    v_lshlrev_b32 v250, 2, v250
    s_mov_b32 s45, 0
WF_23_l:
    buffer_load_dword v251, v250, s[8:11], s44 offen sc1
    s_add_u32 s45, s45, 1
    s_cmp_gt_u32 s45, 200000
    s_cbranch_scc1 WF_23_e
    s_waitcnt vmcnt(0)
    v_cmp_ne_u32 vcc, 1, v251
    s_cbranch_vccz WF_23_e
    s_sleep 32
    s_branch WF_23_l
WF_23_e:
    s_mov_b32 s99, 100696064
    s_lshr_b32 s6, s5, 1
    s_and_b32 s7, s5, 1
    s_load_dwordx2 s[8:9], s[0:1], 96
    s_load_dwordx2 s[12:13], s[0:1], 72
    s_load_dwordx2 s[20:21], s[0:1], 80
    s_mul_i32 s16, s6, 163840
    s_add_u32 s16, s16, 88080384
    s_mul_i32 s17, s7, 640
    s_mov_b32 s18, 1280
    s_lshl_b32 s25, s6, 7
    s_waitcnt lgkmcnt(0)
    s_mov_b32 s10, 0x10000000
    s_mov_b32 s11, 0x20000
    s_mov_b32 s14, 819200
    s_mov_b32 s15, 0x20000
    s_mov_b32 s22, 5242880
    s_mov_b32 s23, 0x20000
    v_and_b32 v1, 63, v0
    v_lshrrev_b32 v20, 2, v1
    v_and_b32 v21, 3, v1
    v_lshrrev_b32 v22, 4, v1
    v_xor_b32 v23, v21, v22
    v_mul_u32_u24 v24, 1280, v20
    v_lshl_add_u32 v2, v23, 4, v24
    v_add_u32 v20, 0, v1
    s_mov_b32 s30, 0xCCCCCCCD
    v_mul_hi_u32 v21, v20, s30
    v_lshrrev_b32 v21, 5, v21
    v_mul_u32_u24 v22, 40, v21
    v_sub_u32 v22, v20, v22
    v_and_b32 v23, 2, v21
    v_lshlrev_b32 v23, 1, v23
    v_xor_b32 v22, v22, v23
    v_mul_lo_u32 v21, v21, s18
    v_lshl_add_u32 v4, v22, 4, v21
    v_add_u32 v20, 64, v1
    s_mov_b32 s30, 0xCCCCCCCD
    v_mul_hi_u32 v21, v20, s30
    v_lshrrev_b32 v21, 5, v21
    v_mul_u32_u24 v22, 40, v21
    v_sub_u32 v22, v20, v22
    v_and_b32 v23, 2, v21
    v_lshlrev_b32 v23, 1, v23
    v_xor_b32 v22, v22, v23
    v_mul_lo_u32 v21, v21, s18
    v_lshl_add_u32 v5, v22, 4, v21
    v_add_u32 v20, 128, v1
    s_mov_b32 s30, 0xCCCCCCCD
    v_mul_hi_u32 v21, v20, s30
    v_lshrrev_b32 v21, 5, v21
    v_mul_u32_u24 v22, 40, v21
    v_sub_u32 v22, v20, v22
    v_and_b32 v23, 2, v21
    v_lshlrev_b32 v23, 1, v23
    v_xor_b32 v22, v22, v23
    v_mul_lo_u32 v21, v21, s18
    v_lshl_add_u32 v6, v22, 4, v21
    v_add_u32 v20, 192, v1
    s_mov_b32 s30, 0xCCCCCCCD
    v_mul_hi_u32 v21, v20, s30
    v_lshrrev_b32 v21, 5, v21
    v_mul_u32_u24 v22, 40, v21
    v_sub_u32 v22, v20, v22
    v_and_b32 v23, 2, v21
    v_lshlrev_b32 v23, 1, v23
    v_xor_b32 v22, v22, v23
    v_mul_lo_u32 v21, v21, s18
    v_lshl_add_u32 v7, v22, 4, v21
    v_add_u32 v20, 256, v1
    s_mov_b32 s30, 0xCCCCCCCD
    v_mul_hi_u32 v21, v20, s30
    v_lshrrev_b32 v21, 5, v21
    v_mul_u32_u24 v22, 40, v21
    v_sub_u32 v22, v20, v22
    v_and_b32 v23, 2, v21
    v_lshlrev_b32 v23, 1, v23
    v_xor_b32 v22, v22, v23
    v_mul_lo_u32 v21, v21, s18
    v_lshl_add_u32 v8, v22, 4, v21
    s_and_b32 s30, s4, 1
    s_mul_i32 s30, s30, 4096
    v_and_b32 v20, 31, v1
    v_lshrrev_b32 v21, 5, v1
    v_bfe_u32 v22, v20, 2, 2
    v_lshlrev_b32 v20, 6, v20
    v_add_u32 v20, s30, v20
    v_add_u32 v23, 0, v21
    v_xor_b32 v23, v23, v22
    v_lshl_add_u32 v10, v23, 4, v20
    v_add_u32 v11, 0x10000, v10
    v_add_u32 v23, 2, v21
    v_xor_b32 v23, v23, v22
    v_lshl_add_u32 v12, v23, 4, v20
    v_add_u32 v13, 0x10000, v12
    s_lshr_b32 s31, s4, 1
    s_mul_i32 s31, s31, 20
    v_bfe_u32 v20, v1, 2, 2
    v_and_b32 v21, 3, v1
    v_bfe_u32 v22, v1, 4, 1
    v_lshrrev_b32 v23, 5, v1
    v_lshl_add_u32 v24, v23, 3, v20
    v_mul_u32_u24 v24, 640, v24
    v_add_u32 v24, 8192, v24
    v_and_b32 v25, 1, v21
    v_lshl_add_u32 v24, v25, 3, v24
    v_lshrrev_b32 v25, 1, v21
    v_lshl_add_u32 v25, v22, 1, v25
    v_add_u32 v25, s31, v25
    v_and_b32 v26, 2, v20
    v_lshlrev_b32 v26, 1, v26
    v_add_u32 v27, 0, v25
    v_xor_b32 v27, v27, v26
    v_lshl_add_u32 v14, v27, 4, v24
    v_add_u32 v15, 0x10000, v14
    v_add_u32 v27, 4, v25
    v_xor_b32 v27, v27, v26
    v_lshl_add_u32 v16, v27, 4, v24
    v_add_u32 v17, 0x10000, v16
    v_add_u32 v27, 8, v25
    v_xor_b32 v27, v27, v26
    v_lshl_add_u32 v18, v27, 4, v24
    v_add_u32 v19, 0x10000, v18
    v_add_u32 v27, 12, v25
    v_xor_b32 v27, v27, v26
    v_lshl_add_u32 v20, v27, 4, v24
    v_add_u32 v21, 0x10000, v20
    v_add_u32 v27, 16, v25
    v_xor_b32 v27, v27, v26
    v_lshl_add_u32 v22, v27, 4, v24
    v_add_u32 v23, 0x10000, v22
    s_mul_i32 s33, s4, 40960
    s_add_u32 s33, s33, s16
    s_lshl_b32 s37, s18, 3
    s_mul_i32 s34, s4, s37
    s_add_u32 s34, s34, s17
    s_mul_i32 s39, s4, 2048
    s_mul_i32 s40, s4, 5120
    s_add_u32 s40, s40, 8192
    s_lshl_b32 s41, s18, 5
    s_add_u32 m0, s39, 0
    s_add_u32 s38, s33, 0
    buffer_load_dwordx4 v2, s[8:11], s38 offen sc1 lds
    s_add_u32 m0, s39, 1024
    s_add_u32 s38, s33, 20480
    buffer_load_dwordx4 v2, s[8:11], s38 offen sc1 lds
    s_add_u32 m0, s40, 0
    buffer_load_dwordx4 v4, s[12:15], s34 offen lds
    s_add_u32 m0, s40, 1024
    buffer_load_dwordx4 v5, s[12:15], s34 offen lds
    s_add_u32 m0, s40, 2048
    buffer_load_dwordx4 v6, s[12:15], s34 offen lds
    s_add_u32 m0, s40, 3072
    buffer_load_dwordx4 v7, s[12:15], s34 offen lds
    s_add_u32 m0, s40, 4096
    buffer_load_dwordx4 v8, s[12:15], s34 offen lds
    s_add_u32 s33, s33, 64
    s_add_u32 s34, s34, s41
    s_add_u32 m0, s39, 32768
    s_add_u32 s38, s33, 0
    buffer_load_dwordx4 v2, s[8:11], s38 offen sc1 lds
    s_add_u32 m0, s39, 33792
    s_add_u32 s38, s33, 20480
    buffer_load_dwordx4 v2, s[8:11], s38 offen sc1 lds
    s_add_u32 m0, s40, 32768
    buffer_load_dwordx4 v4, s[12:15], s34 offen lds
    s_add_u32 m0, s40, 33792
    buffer_load_dwordx4 v5, s[12:15], s34 offen lds
    s_add_u32 m0, s40, 34816
    buffer_load_dwordx4 v6, s[12:15], s34 offen lds
    s_add_u32 m0, s40, 35840
    buffer_load_dwordx4 v7, s[12:15], s34 offen lds
    s_add_u32 m0, s40, 36864
    buffer_load_dwordx4 v8, s[12:15], s34 offen lds
    s_add_u32 s33, s33, 64
    s_add_u32 s34, s34, s41
    s_add_u32 m0, s39, 65536
    s_add_u32 s38, s33, 0
    buffer_load_dwordx4 v2, s[8:11], s38 offen sc1 lds
    s_add_u32 m0, s39, 66560
    s_add_u32 s38, s33, 20480
    buffer_load_dwordx4 v2, s[8:11], s38 offen sc1 lds
    s_add_u32 m0, s40, 65536
    buffer_load_dwordx4 v4, s[12:15], s34 offen lds
    s_add_u32 m0, s40, 66560
    buffer_load_dwordx4 v5, s[12:15], s34 offen lds
    s_add_u32 m0, s40, 67584
    buffer_load_dwordx4 v6, s[12:15], s34 offen lds
    s_add_u32 m0, s40, 68608
    buffer_load_dwordx4 v7, s[12:15], s34 offen lds
    s_add_u32 m0, s40, 69632
    buffer_load_dwordx4 v8, s[12:15], s34 offen lds
    s_add_u32 s33, s33, 64
    s_add_u32 s34, s34, s41
    v_accvgpr_write_b32 a0, 0
    v_accvgpr_write_b32 a1, 0
    v_accvgpr_write_b32 a2, 0
    v_accvgpr_write_b32 a3, 0
    v_accvgpr_write_b32 a4, 0
    v_accvgpr_write_b32 a5, 0
    v_accvgpr_write_b32 a6, 0
    v_accvgpr_write_b32 a7, 0
    v_accvgpr_write_b32 a8, 0
    v_accvgpr_write_b32 a9, 0
    v_accvgpr_write_b32 a10, 0
    v_accvgpr_write_b32 a11, 0
    v_accvgpr_write_b32 a12, 0
    v_accvgpr_write_b32 a13, 0
    v_accvgpr_write_b32 a14, 0
    v_accvgpr_write_b32 a15, 0
    v_accvgpr_write_b32 a16, 0
    v_accvgpr_write_b32 a17, 0
    v_accvgpr_write_b32 a18, 0
    v_accvgpr_write_b32 a19, 0
    v_accvgpr_write_b32 a20, 0
    v_accvgpr_write_b32 a21, 0
    v_accvgpr_write_b32 a22, 0
    v_accvgpr_write_b32 a23, 0
    v_accvgpr_write_b32 a24, 0
    v_accvgpr_write_b32 a25, 0
    v_accvgpr_write_b32 a26, 0
    v_accvgpr_write_b32 a27, 0
    v_accvgpr_write_b32 a28, 0
    v_accvgpr_write_b32 a29, 0
    v_accvgpr_write_b32 a30, 0
    v_accvgpr_write_b32 a31, 0
    v_accvgpr_write_b32 a32, 0
    v_accvgpr_write_b32 a33, 0
    v_accvgpr_write_b32 a34, 0
    v_accvgpr_write_b32 a35, 0
    v_accvgpr_write_b32 a36, 0
    v_accvgpr_write_b32 a37, 0
    v_accvgpr_write_b32 a38, 0
    v_accvgpr_write_b32 a39, 0
    v_accvgpr_write_b32 a40, 0
    v_accvgpr_write_b32 a41, 0
    v_accvgpr_write_b32 a42, 0
    v_accvgpr_write_b32 a43, 0
    v_accvgpr_write_b32 a44, 0
    v_accvgpr_write_b32 a45, 0
    v_accvgpr_write_b32 a46, 0
    v_accvgpr_write_b32 a47, 0
    v_accvgpr_write_b32 a48, 0
    v_accvgpr_write_b32 a49, 0
    v_accvgpr_write_b32 a50, 0
    v_accvgpr_write_b32 a51, 0
    v_accvgpr_write_b32 a52, 0
    v_accvgpr_write_b32 a53, 0
    v_accvgpr_write_b32 a54, 0
    v_accvgpr_write_b32 a55, 0
    v_accvgpr_write_b32 a56, 0
    v_accvgpr_write_b32 a57, 0
    v_accvgpr_write_b32 a58, 0
    v_accvgpr_write_b32 a59, 0
    v_accvgpr_write_b32 a60, 0
    v_accvgpr_write_b32 a61, 0
    v_accvgpr_write_b32 a62, 0
    v_accvgpr_write_b32 a63, 0
    v_accvgpr_write_b32 a64, 0
    v_accvgpr_write_b32 a65, 0
    v_accvgpr_write_b32 a66, 0
    v_accvgpr_write_b32 a67, 0
    v_accvgpr_write_b32 a68, 0
    v_accvgpr_write_b32 a69, 0
    v_accvgpr_write_b32 a70, 0
    v_accvgpr_write_b32 a71, 0
    v_accvgpr_write_b32 a72, 0
    v_accvgpr_write_b32 a73, 0
    v_accvgpr_write_b32 a74, 0
    v_accvgpr_write_b32 a75, 0
    v_accvgpr_write_b32 a76, 0
    v_accvgpr_write_b32 a77, 0
    v_accvgpr_write_b32 a78, 0
    v_accvgpr_write_b32 a79, 0
    v_accvgpr_write_b32 a80, 0
    v_accvgpr_write_b32 a81, 0
    v_accvgpr_write_b32 a82, 0
    v_accvgpr_write_b32 a83, 0
    v_accvgpr_write_b32 a84, 0
    v_accvgpr_write_b32 a85, 0
    v_accvgpr_write_b32 a86, 0
    v_accvgpr_write_b32 a87, 0
    v_accvgpr_write_b32 a88, 0
    v_accvgpr_write_b32 a89, 0
    v_accvgpr_write_b32 a90, 0
    v_accvgpr_write_b32 a91, 0
    v_accvgpr_write_b32 a92, 0
    v_accvgpr_write_b32 a93, 0
    v_accvgpr_write_b32 a94, 0
    v_accvgpr_write_b32 a95, 0
    v_accvgpr_write_b32 a96, 0
    v_accvgpr_write_b32 a97, 0
    v_accvgpr_write_b32 a98, 0
    v_accvgpr_write_b32 a99, 0
    v_accvgpr_write_b32 a100, 0
    v_accvgpr_write_b32 a101, 0
    v_accvgpr_write_b32 a102, 0
    v_accvgpr_write_b32 a103, 0
    v_accvgpr_write_b32 a104, 0
    v_accvgpr_write_b32 a105, 0
    v_accvgpr_write_b32 a106, 0
    v_accvgpr_write_b32 a107, 0
    v_accvgpr_write_b32 a108, 0
    v_accvgpr_write_b32 a109, 0
    v_accvgpr_write_b32 a110, 0
    v_accvgpr_write_b32 a111, 0
    v_accvgpr_write_b32 a112, 0
    v_accvgpr_write_b32 a113, 0
    v_accvgpr_write_b32 a114, 0
    v_accvgpr_write_b32 a115, 0
    v_accvgpr_write_b32 a116, 0
    v_accvgpr_write_b32 a117, 0
    v_accvgpr_write_b32 a118, 0
    v_accvgpr_write_b32 a119, 0
    v_accvgpr_write_b32 a120, 0
    v_accvgpr_write_b32 a121, 0
    v_accvgpr_write_b32 a122, 0
    v_accvgpr_write_b32 a123, 0
    v_accvgpr_write_b32 a124, 0
    v_accvgpr_write_b32 a125, 0
    v_accvgpr_write_b32 a126, 0
    v_accvgpr_write_b32 a127, 0
    v_accvgpr_write_b32 a128, 0
    v_accvgpr_write_b32 a129, 0
    v_accvgpr_write_b32 a130, 0
    v_accvgpr_write_b32 a131, 0
    v_accvgpr_write_b32 a132, 0
    v_accvgpr_write_b32 a133, 0
    v_accvgpr_write_b32 a134, 0
    v_accvgpr_write_b32 a135, 0
    v_accvgpr_write_b32 a136, 0
    v_accvgpr_write_b32 a137, 0
    v_accvgpr_write_b32 a138, 0
    v_accvgpr_write_b32 a139, 0
    v_accvgpr_write_b32 a140, 0
    v_accvgpr_write_b32 a141, 0
    v_accvgpr_write_b32 a142, 0
    v_accvgpr_write_b32 a143, 0
    v_accvgpr_write_b32 a144, 0
    v_accvgpr_write_b32 a145, 0
    v_accvgpr_write_b32 a146, 0
    v_accvgpr_write_b32 a147, 0
    v_accvgpr_write_b32 a148, 0
    v_accvgpr_write_b32 a149, 0
    v_accvgpr_write_b32 a150, 0
    v_accvgpr_write_b32 a151, 0
    v_accvgpr_write_b32 a152, 0
    v_accvgpr_write_b32 a153, 0
    v_accvgpr_write_b32 a154, 0
    v_accvgpr_write_b32 a155, 0
    v_accvgpr_write_b32 a156, 0
    v_accvgpr_write_b32 a157, 0
    v_accvgpr_write_b32 a158, 0
    v_accvgpr_write_b32 a159, 0
    s_waitcnt vmcnt(14)
    s_barrier
    ds_read_b128 v[32:35], v10 offset:0
    ds_read_b128 v[36:39], v10 offset:2048
    ds_read_b64_tr_b16 v[48:49], v14 offset:0
    ds_read_b64_tr_b16 v[50:51], v14 offset:2560
    ds_read_b64_tr_b16 v[52:53], v16 offset:0
    ds_read_b64_tr_b16 v[54:55], v16 offset:2560
    ds_read_b64_tr_b16 v[56:57], v18 offset:0
    ds_read_b64_tr_b16 v[58:59], v18 offset:2560
    ds_read_b64_tr_b16 v[60:61], v20 offset:0
    ds_read_b64_tr_b16 v[62:63], v20 offset:2560
    ds_read_b64_tr_b16 v[64:65], v22 offset:0
    ds_read_b64_tr_b16 v[66:67], v22 offset:2560
    s_mov_b32 s42, 0
G_24_loop:
    s_waitcnt lgkmcnt(0)
    v_mfma_f32_32x32x16_bf16 a[0:15], v[48:51], v[32:35], a[0:15]
    ds_read_b128 v[68:71], v12 offset:0
    v_mfma_f32_32x32x16_bf16 a[16:31], v[52:55], v[32:35], a[16:31]
    s_add_u32 m0, s39, 98304
    s_add_u32 s38, s33, 0
    buffer_load_dwordx4 v2, s[8:11], s38 offen sc1 lds
    ds_read_b128 v[72:75], v12 offset:2048
    v_mfma_f32_32x32x16_bf16 a[32:47], v[56:59], v[32:35], a[32:47]
    ds_read_b64_tr_b16 v[84:85], v14 offset:10240
    v_mfma_f32_32x32x16_bf16 a[48:63], v[60:63], v[32:35], a[48:63]
    ds_read_b64_tr_b16 v[86:87], v14 offset:12800
    s_add_u32 m0, s39, 99328
    s_add_u32 s38, s33, 20480
    buffer_load_dwordx4 v2, s[8:11], s38 offen sc1 lds
    v_mfma_f32_32x32x16_bf16 a[64:79], v[64:67], v[32:35], a[64:79]
    ds_read_b64_tr_b16 v[88:89], v16 offset:10240
    ds_read_b64_tr_b16 v[90:91], v16 offset:12800
    v_mfma_f32_32x32x16_bf16 a[80:95], v[48:51], v[36:39], a[80:95]
    ds_read_b64_tr_b16 v[92:93], v18 offset:10240
    v_mfma_f32_32x32x16_bf16 a[96:111], v[52:55], v[36:39], a[96:111]
    s_add_u32 m0, s40, 98304
    buffer_load_dwordx4 v4, s[12:15], s34 offen lds
    ds_read_b64_tr_b16 v[94:95], v18 offset:12800
    v_mfma_f32_32x32x16_bf16 a[112:127], v[56:59], v[36:39], a[112:127]
    ds_read_b64_tr_b16 v[96:97], v20 offset:10240
    v_mfma_f32_32x32x16_bf16 a[128:143], v[60:63], v[36:39], a[128:143]
    ds_read_b64_tr_b16 v[98:99], v20 offset:12800
    s_add_u32 m0, s40, 99328
    buffer_load_dwordx4 v5, s[12:15], s34 offen lds
    v_mfma_f32_32x32x16_bf16 a[144:159], v[64:67], v[36:39], a[144:159]
    ds_read_b64_tr_b16 v[100:101], v22 offset:10240
    ds_read_b64_tr_b16 v[102:103], v22 offset:12800
    s_waitcnt lgkmcnt(0)
    v_mfma_f32_32x32x16_bf16 a[0:15], v[84:87], v[68:71], a[0:15]
    v_mfma_f32_32x32x16_bf16 a[16:31], v[88:91], v[68:71], a[16:31]
    v_mfma_f32_32x32x16_bf16 a[32:47], v[92:95], v[68:71], a[32:47]
    s_waitcnt vmcnt(11)
    s_barrier
    v_mfma_f32_32x32x16_bf16 a[48:63], v[96:99], v[68:71], a[48:63]
    ds_read_b128 v[32:35], v10 offset:32768
    s_add_u32 m0, s40, 100352
    buffer_load_dwordx4 v6, s[12:15], s34 offen lds
    v_mfma_f32_32x32x16_bf16 a[64:79], v[100:103], v[68:71], a[64:79]
    ds_read_b128 v[36:39], v10 offset:34816
    ds_read_b64_tr_b16 v[48:49], v14 offset:32768
    v_mfma_f32_32x32x16_bf16 a[80:95], v[84:87], v[72:75], a[80:95]
    ds_read_b64_tr_b16 v[50:51], v14 offset:35328
    ds_read_b64_tr_b16 v[52:53], v16 offset:32768
    v_mfma_f32_32x32x16_bf16 a[96:111], v[88:91], v[72:75], a[96:111]
    s_add_u32 m0, s40, 101376
    buffer_load_dwordx4 v7, s[12:15], s34 offen lds
    ds_read_b64_tr_b16 v[54:55], v16 offset:35328
    v_mfma_f32_32x32x16_bf16 a[112:127], v[92:95], v[72:75], a[112:127]
    ds_read_b64_tr_b16 v[56:57], v18 offset:32768
    ds_read_b64_tr_b16 v[58:59], v18 offset:35328
    v_mfma_f32_32x32x16_bf16 a[128:143], v[96:99], v[72:75], a[128:143]
    ds_read_b64_tr_b16 v[60:61], v20 offset:32768
    s_add_u32 m0, s40, 102400
    buffer_load_dwordx4 v8, s[12:15], s34 offen lds
    v_mfma_f32_32x32x16_bf16 a[144:159], v[100:103], v[72:75], a[144:159]
    ds_read_b64_tr_b16 v[62:63], v20 offset:35328
    ds_read_b64_tr_b16 v[64:65], v22 offset:32768
    ds_read_b64_tr_b16 v[66:67], v22 offset:35328
    s_add_u32 s33, s33, 64
    s_add_u32 s34, s34, s41
    s_cmp_eq_u32 s42, 4
    s_cselect_b32 s10, 0, s10
    s_cselect_b32 s14, 0, s14
    s_waitcnt lgkmcnt(0)
    v_mfma_f32_32x32x16_bf16 a[0:15], v[48:51], v[32:35], a[0:15]
    ds_read_b128 v[68:71], v12 offset:32768
    v_mfma_f32_32x32x16_bf16 a[16:31], v[52:55], v[32:35], a[16:31]
    s_add_u32 m0, s39, 0
    s_add_u32 s38, s33, 0
    buffer_load_dwordx4 v2, s[8:11], s38 offen sc1 lds
    ds_read_b128 v[72:75], v12 offset:34816
    v_mfma_f32_32x32x16_bf16 a[32:47], v[56:59], v[32:35], a[32:47]
    ds_read_b64_tr_b16 v[84:85], v14 offset:43008
    v_mfma_f32_32x32x16_bf16 a[48:63], v[60:63], v[32:35], a[48:63]
    ds_read_b64_tr_b16 v[86:87], v14 offset:45568
    s_add_u32 m0, s39, 1024
    s_add_u32 s38, s33, 20480
    buffer_load_dwordx4 v2, s[8:11], s38 offen sc1 lds
    v_mfma_f32_32x32x16_bf16 a[64:79], v[64:67], v[32:35], a[64:79]
    ds_read_b64_tr_b16 v[88:89], v16 offset:43008
    ds_read_b64_tr_b16 v[90:91], v16 offset:45568
    v_mfma_f32_32x32x16_bf16 a[80:95], v[48:51], v[36:39], a[80:95]
    ds_read_b64_tr_b16 v[92:93], v18 offset:43008
    v_mfma_f32_32x32x16_bf16 a[96:111], v[52:55], v[36:39], a[96:111]
    s_add_u32 m0, s40, 0
    buffer_load_dwordx4 v4, s[12:15], s34 offen lds
    ds_read_b64_tr_b16 v[94:95], v18 offset:45568
    v_mfma_f32_32x32x16_bf16 a[112:127], v[56:59], v[36:39], a[112:127]
    ds_read_b64_tr_b16 v[96:97], v20 offset:43008
    v_mfma_f32_32x32x16_bf16 a[128:143], v[60:63], v[36:39], a[128:143]
    ds_read_b64_tr_b16 v[98:99], v20 offset:45568
    s_add_u32 m0, s40, 1024
    buffer_load_dwordx4 v5, s[12:15], s34 offen lds
    v_mfma_f32_32x32x16_bf16 a[144:159], v[64:67], v[36:39], a[144:159]
    ds_read_b64_tr_b16 v[100:101], v22 offset:43008
    ds_read_b64_tr_b16 v[102:103], v22 offset:45568
    s_waitcnt lgkmcnt(0)
    v_mfma_f32_32x32x16_bf16 a[0:15], v[84:87], v[68:71], a[0:15]
    v_mfma_f32_32x32x16_bf16 a[16:31], v[88:91], v[68:71], a[16:31]
    v_mfma_f32_32x32x16_bf16 a[32:47], v[92:95], v[68:71], a[32:47]
    s_waitcnt vmcnt(11)
    s_barrier
    v_mfma_f32_32x32x16_bf16 a[48:63], v[96:99], v[68:71], a[48:63]
    ds_read_b128 v[32:35], v11 offset:0
    s_add_u32 m0, s40, 2048
    buffer_load_dwordx4 v6, s[12:15], s34 offen lds
    v_mfma_f32_32x32x16_bf16 a[64:79], v[100:103], v[68:71], a[64:79]
    ds_read_b128 v[36:39], v11 offset:2048
    ds_read_b64_tr_b16 v[48:49], v15 offset:0
    v_mfma_f32_32x32x16_bf16 a[80:95], v[84:87], v[72:75], a[80:95]
    ds_read_b64_tr_b16 v[50:51], v15 offset:2560
    ds_read_b64_tr_b16 v[52:53], v17 offset:0
    v_mfma_f32_32x32x16_bf16 a[96:111], v[88:91], v[72:75], a[96:111]
    s_add_u32 m0, s40, 3072
    buffer_load_dwordx4 v7, s[12:15], s34 offen lds
    ds_read_b64_tr_b16 v[54:55], v17 offset:2560
    v_mfma_f32_32x32x16_bf16 a[112:127], v[92:95], v[72:75], a[112:127]
    ds_read_b64_tr_b16 v[56:57], v19 offset:0
    ds_read_b64_tr_b16 v[58:59], v19 offset:2560
    v_mfma_f32_32x32x16_bf16 a[128:143], v[96:99], v[72:75], a[128:143]
    ds_read_b64_tr_b16 v[60:61], v21 offset:0
    s_add_u32 m0, s40, 4096
    buffer_load_dwordx4 v8, s[12:15], s34 offen lds
    v_mfma_f32_32x32x16_bf16 a[144:159], v[100:103], v[72:75], a[144:159]
    ds_read_b64_tr_b16 v[62:63], v21 offset:2560
    ds_read_b64_tr_b16 v[64:65], v23 offset:0
    ds_read_b64_tr_b16 v[66:67], v23 offset:2560
    s_add_u32 s33, s33, 64
    s_add_u32 s34, s34, s41
    s_waitcnt lgkmcnt(0)
    v_mfma_f32_32x32x16_bf16 a[0:15], v[48:51], v[32:35], a[0:15]
    ds_read_b128 v[68:71], v13 offset:0
    v_mfma_f32_32x32x16_bf16 a[16:31], v[52:55], v[32:35], a[16:31]
    s_add_u32 m0, s39, 32768
    s_add_u32 s38, s33, 0
    buffer_load_dwordx4 v2, s[8:11], s38 offen sc1 lds
    ds_read_b128 v[72:75], v13 offset:2048
    v_mfma_f32_32x32x16_bf16 a[32:47], v[56:59], v[32:35], a[32:47]
    ds_read_b64_tr_b16 v[84:85], v15 offset:10240
    v_mfma_f32_32x32x16_bf16 a[48:63], v[60:63], v[32:35], a[48:63]
    ds_read_b64_tr_b16 v[86:87], v15 offset:12800
    s_add_u32 m0, s39, 33792
    s_add_u32 s38, s33, 20480
    buffer_load_dwordx4 v2, s[8:11], s38 offen sc1 lds
    v_mfma_f32_32x32x16_bf16 a[64:79], v[64:67], v[32:35], a[64:79]
    ds_read_b64_tr_b16 v[88:89], v17 offset:10240
    ds_read_b64_tr_b16 v[90:91], v17 offset:12800
    v_mfma_f32_32x32x16_bf16 a[80:95], v[48:51], v[36:39], a[80:95]
    ds_read_b64_tr_b16 v[92:93], v19 offset:10240
    v_mfma_f32_32x32x16_bf16 a[96:111], v[52:55], v[36:39], a[96:111]
    s_add_u32 m0, s40, 32768
    buffer_load_dwordx4 v4, s[12:15], s34 offen lds
    ds_read_b64_tr_b16 v[94:95], v19 offset:12800
    v_mfma_f32_32x32x16_bf16 a[112:127], v[56:59], v[36:39], a[112:127]
    ds_read_b64_tr_b16 v[96:97], v21 offset:10240
    v_mfma_f32_32x32x16_bf16 a[128:143], v[60:63], v[36:39], a[128:143]
    ds_read_b64_tr_b16 v[98:99], v21 offset:12800
    s_add_u32 m0, s40, 33792
    buffer_load_dwordx4 v5, s[12:15], s34 offen lds
    v_mfma_f32_32x32x16_bf16 a[144:159], v[64:67], v[36:39], a[144:159]
    ds_read_b64_tr_b16 v[100:101], v23 offset:10240
    ds_read_b64_tr_b16 v[102:103], v23 offset:12800
    s_waitcnt lgkmcnt(0)
    v_mfma_f32_32x32x16_bf16 a[0:15], v[84:87], v[68:71], a[0:15]
    v_mfma_f32_32x32x16_bf16 a[16:31], v[88:91], v[68:71], a[16:31]
    v_mfma_f32_32x32x16_bf16 a[32:47], v[92:95], v[68:71], a[32:47]
    s_waitcnt vmcnt(11)
    s_barrier
    v_mfma_f32_32x32x16_bf16 a[48:63], v[96:99], v[68:71], a[48:63]
    ds_read_b128 v[32:35], v11 offset:32768
    s_add_u32 m0, s40, 34816
    buffer_load_dwordx4 v6, s[12:15], s34 offen lds
    v_mfma_f32_32x32x16_bf16 a[64:79], v[100:103], v[68:71], a[64:79]
    ds_read_b128 v[36:39], v11 offset:34816
    ds_read_b64_tr_b16 v[48:49], v15 offset:32768
    v_mfma_f32_32x32x16_bf16 a[80:95], v[84:87], v[72:75], a[80:95]
    ds_read_b64_tr_b16 v[50:51], v15 offset:35328
    ds_read_b64_tr_b16 v[52:53], v17 offset:32768
    v_mfma_f32_32x32x16_bf16 a[96:111], v[88:91], v[72:75], a[96:111]
    s_add_u32 m0, s40, 35840
    buffer_load_dwordx4 v7, s[12:15], s34 offen lds
    ds_read_b64_tr_b16 v[54:55], v17 offset:35328
    v_mfma_f32_32x32x16_bf16 a[112:127], v[92:95], v[72:75], a[112:127]
    ds_read_b64_tr_b16 v[56:57], v19 offset:32768
    ds_read_b64_tr_b16 v[58:59], v19 offset:35328
    v_mfma_f32_32x32x16_bf16 a[128:143], v[96:99], v[72:75], a[128:143]
    ds_read_b64_tr_b16 v[60:61], v21 offset:32768
    s_add_u32 m0, s40, 36864
    buffer_load_dwordx4 v8, s[12:15], s34 offen lds
    v_mfma_f32_32x32x16_bf16 a[144:159], v[100:103], v[72:75], a[144:159]
    ds_read_b64_tr_b16 v[62:63], v21 offset:35328
    ds_read_b64_tr_b16 v[64:65], v23 offset:32768
    ds_read_b64_tr_b16 v[66:67], v23 offset:35328
    s_add_u32 s33, s33, 64
    s_add_u32 s34, s34, s41
    s_waitcnt lgkmcnt(0)
    v_mfma_f32_32x32x16_bf16 a[0:15], v[48:51], v[32:35], a[0:15]
    ds_read_b128 v[68:71], v13 offset:32768
    v_mfma_f32_32x32x16_bf16 a[16:31], v[52:55], v[32:35], a[16:31]
    s_add_u32 m0, s39, 65536
    s_add_u32 s38, s33, 0
    buffer_load_dwordx4 v2, s[8:11], s38 offen sc1 lds
    ds_read_b128 v[72:75], v13 offset:34816
    v_mfma_f32_32x32x16_bf16 a[32:47], v[56:59], v[32:35], a[32:47]
    ds_read_b64_tr_b16 v[84:85], v15 offset:43008
    v_mfma_f32_32x32x16_bf16 a[48:63], v[60:63], v[32:35], a[48:63]
    ds_read_b64_tr_b16 v[86:87], v15 offset:45568
    s_add_u32 m0, s39, 66560
    s_add_u32 s38, s33, 20480
    buffer_load_dwordx4 v2, s[8:11], s38 offen sc1 lds
    v_mfma_f32_32x32x16_bf16 a[64:79], v[64:67], v[32:35], a[64:79]
    ds_read_b64_tr_b16 v[88:89], v17 offset:43008
    ds_read_b64_tr_b16 v[90:91], v17 offset:45568
    v_mfma_f32_32x32x16_bf16 a[80:95], v[48:51], v[36:39], a[80:95]
    ds_read_b64_tr_b16 v[92:93], v19 offset:43008
    v_mfma_f32_32x32x16_bf16 a[96:111], v[52:55], v[36:39], a[96:111]
    s_add_u32 m0, s40, 65536
    buffer_load_dwordx4 v4, s[12:15], s34 offen lds
    ds_read_b64_tr_b16 v[94:95], v19 offset:45568
    v_mfma_f32_32x32x16_bf16 a[112:127], v[56:59], v[36:39], a[112:127]
    ds_read_b64_tr_b16 v[96:97], v21 offset:43008
    v_mfma_f32_32x32x16_bf16 a[128:143], v[60:63], v[36:39], a[128:143]
    ds_read_b64_tr_b16 v[98:99], v21 offset:45568
    s_add_u32 m0, s40, 66560
    buffer_load_dwordx4 v5, s[12:15], s34 offen lds
    v_mfma_f32_32x32x16_bf16 a[144:159], v[64:67], v[36:39], a[144:159]
    ds_read_b64_tr_b16 v[100:101], v23 offset:43008
    ds_read_b64_tr_b16 v[102:103], v23 offset:45568
    s_waitcnt lgkmcnt(0)
    v_mfma_f32_32x32x16_bf16 a[0:15], v[84:87], v[68:71], a[0:15]
    v_mfma_f32_32x32x16_bf16 a[16:31], v[88:91], v[68:71], a[16:31]
    v_mfma_f32_32x32x16_bf16 a[32:47], v[92:95], v[68:71], a[32:47]
    s_waitcnt vmcnt(11)
    s_barrier
    v_mfma_f32_32x32x16_bf16 a[48:63], v[96:99], v[68:71], a[48:63]
    ds_read_b128 v[32:35], v10 offset:0
    s_add_u32 m0, s40, 67584
    buffer_load_dwordx4 v6, s[12:15], s34 offen lds
    v_mfma_f32_32x32x16_bf16 a[64:79], v[100:103], v[68:71], a[64:79]
    ds_read_b128 v[36:39], v10 offset:2048
    ds_read_b64_tr_b16 v[48:49], v14 offset:0
    v_mfma_f32_32x32x16_bf16 a[80:95], v[84:87], v[72:75], a[80:95]
    ds_read_b64_tr_b16 v[50:51], v14 offset:2560
    ds_read_b64_tr_b16 v[52:53], v16 offset:0
    v_mfma_f32_32x32x16_bf16 a[96:111], v[88:91], v[72:75], a[96:111]
    s_add_u32 m0, s40, 68608
    buffer_load_dwordx4 v7, s[12:15], s34 offen lds
    ds_read_b64_tr_b16 v[54:55], v16 offset:2560
    v_mfma_f32_32x32x16_bf16 a[112:127], v[92:95], v[72:75], a[112:127]
    ds_read_b64_tr_b16 v[56:57], v18 offset:0
    ds_read_b64_tr_b16 v[58:59], v18 offset:2560
    v_mfma_f32_32x32x16_bf16 a[128:143], v[96:99], v[72:75], a[128:143]
    ds_read_b64_tr_b16 v[60:61], v20 offset:0
    s_add_u32 m0, s40, 69632
    buffer_load_dwordx4 v8, s[12:15], s34 offen lds
    v_mfma_f32_32x32x16_bf16 a[144:159], v[100:103], v[72:75], a[144:159]
    ds_read_b64_tr_b16 v[62:63], v20 offset:2560
    ds_read_b64_tr_b16 v[64:65], v22 offset:0
    ds_read_b64_tr_b16 v[66:67], v22 offset:2560
    s_add_u32 s33, s33, 64
    s_add_u32 s34, s34, s41
    s_add_u32 s42, s42, 1
    s_cmp_lt_u32 s42, 5
    s_cbranch_scc1 G_24_loop
    s_waitcnt vmcnt(0) lgkmcnt(0)
    s_nop 15
    s_nop 7
    s_barrier
    s_mul_i32 s24, s7, 640
    s_add_u32 s24, s24, 1280
    s_and_b32 s30, s4, 1
    s_mul_i32 s30, s30, 64
    s_add_u32 s30, s30, s25
    s_mul_i32 s30, s30, 2560
    s_lshr_b32 s31, s4, 1
    s_mul_i32 s31, s31, 320
    s_add_u32 s30, s30, s31
    s_add_u32 s30, s30, s24
    v_and_b32 v1, 31, v0
    v_bfe_u32 v5, v0, 5, 1
    v_mul_u32_u24 v1, 2560, v1
    v_lshl_add_u32 v2, v5, 4, v1
    v_accvgpr_read_b32 v104, a0
    v_accvgpr_read_b32 v105, a1
    v_accvgpr_read_b32 v106, a2
    v_accvgpr_read_b32 v107, a3
    v_accvgpr_read_b32 v108, a4
    v_accvgpr_read_b32 v109, a5
    v_accvgpr_read_b32 v110, a6
    v_accvgpr_read_b32 v111, a7
    v_accvgpr_read_b32 v112, a8
    v_accvgpr_read_b32 v113, a9
    v_accvgpr_read_b32 v114, a10
    v_accvgpr_read_b32 v115, a11
    v_accvgpr_read_b32 v116, a12
    v_accvgpr_read_b32 v117, a13
    v_accvgpr_read_b32 v118, a14
    v_accvgpr_read_b32 v119, a15
    v_cvt_pk_bf16_f32 v128, v104, v105
    v_cvt_pk_bf16_f32 v129, v106, v107
    v_cvt_pk_bf16_f32 v130, v108, v109
    v_cvt_pk_bf16_f32 v131, v110, v111
    v_cvt_pk_bf16_f32 v132, v112, v113
    v_cvt_pk_bf16_f32 v133, v114, v115
    v_cvt_pk_bf16_f32 v134, v116, v117
    v_cvt_pk_bf16_f32 v135, v118, v119
    s_nop 1
    v_permlane32_swap_b32 v128, v130
    v_permlane32_swap_b32 v129, v131
    v_permlane32_swap_b32 v132, v134
    v_permlane32_swap_b32 v133, v135
    s_add_u32 s31, s30, 0
    buffer_store_dwordx4 v[128:131], v2, s[20:23], s31 offen offset:0
    buffer_store_dwordx4 v[132:135], v2, s[20:23], s31 offen offset:32
    v_accvgpr_read_b32 v104, a16
    v_accvgpr_read_b32 v105, a17
    v_accvgpr_read_b32 v106, a18
    v_accvgpr_read_b32 v107, a19
    v_accvgpr_read_b32 v108, a20
    v_accvgpr_read_b32 v109, a21
    v_accvgpr_read_b32 v110, a22
    v_accvgpr_read_b32 v111, a23
    v_accvgpr_read_b32 v112, a24
    v_accvgpr_read_b32 v113, a25
    v_accvgpr_read_b32 v114, a26
    v_accvgpr_read_b32 v115, a27
    v_accvgpr_read_b32 v116, a28
    v_accvgpr_read_b32 v117, a29
    v_accvgpr_read_b32 v118, a30
    v_accvgpr_read_b32 v119, a31
    v_cvt_pk_bf16_f32 v136, v104, v105
    v_cvt_pk_bf16_f32 v137, v106, v107
    v_cvt_pk_bf16_f32 v138, v108, v109
    v_cvt_pk_bf16_f32 v139, v110, v111
    v_cvt_pk_bf16_f32 v140, v112, v113
    v_cvt_pk_bf16_f32 v141, v114, v115
    v_cvt_pk_bf16_f32 v142, v116, v117
    v_cvt_pk_bf16_f32 v143, v118, v119
    s_nop 1
    v_permlane32_swap_b32 v136, v138
    v_permlane32_swap_b32 v137, v139
    v_permlane32_swap_b32 v140, v142
    v_permlane32_swap_b32 v141, v143
    s_add_u32 s31, s30, 0
    buffer_store_dwordx4 v[136:139], v2, s[20:23], s31 offen offset:64
    buffer_store_dwordx4 v[140:143], v2, s[20:23], s31 offen offset:96
    v_accvgpr_read_b32 v104, a32
    v_accvgpr_read_b32 v105, a33
    v_accvgpr_read_b32 v106, a34
    v_accvgpr_read_b32 v107, a35
    v_accvgpr_read_b32 v108, a36
    v_accvgpr_read_b32 v109, a37
    v_accvgpr_read_b32 v110, a38
    v_accvgpr_read_b32 v111, a39
    v_accvgpr_read_b32 v112, a40
    v_accvgpr_read_b32 v113, a41
    v_accvgpr_read_b32 v114, a42
    v_accvgpr_read_b32 v115, a43
    v_accvgpr_read_b32 v116, a44
    v_accvgpr_read_b32 v117, a45
    v_accvgpr_read_b32 v118, a46
    v_accvgpr_read_b32 v119, a47
    v_cvt_pk_bf16_f32 v144, v104, v105
    v_cvt_pk_bf16_f32 v145, v106, v107
    v_cvt_pk_bf16_f32 v146, v108, v109
    v_cvt_pk_bf16_f32 v147, v110, v111
    v_cvt_pk_bf16_f32 v148, v112, v113
    v_cvt_pk_bf16_f32 v149, v114, v115
    v_cvt_pk_bf16_f32 v150, v116, v117
    v_cvt_pk_bf16_f32 v151, v118, v119
    s_nop 1
    v_permlane32_swap_b32 v144, v146
    v_permlane32_swap_b32 v145, v147
    v_permlane32_swap_b32 v148, v150
    v_permlane32_swap_b32 v149, v151
    s_add_u32 s31, s30, 0
    buffer_store_dwordx4 v[144:147], v2, s[20:23], s31 offen offset:128
    buffer_store_dwordx4 v[148:151], v2, s[20:23], s31 offen offset:160
    v_accvgpr_read_b32 v104, a48
    v_accvgpr_read_b32 v105, a49
    v_accvgpr_read_b32 v106, a50
    v_accvgpr_read_b32 v107, a51
    v_accvgpr_read_b32 v108, a52
    v_accvgpr_read_b32 v109, a53
    v_accvgpr_read_b32 v110, a54
    v_accvgpr_read_b32 v111, a55
    v_accvgpr_read_b32 v112, a56
    v_accvgpr_read_b32 v113, a57
    v_accvgpr_read_b32 v114, a58
    v_accvgpr_read_b32 v115, a59
    v_accvgpr_read_b32 v116, a60
    v_accvgpr_read_b32 v117, a61
    v_accvgpr_read_b32 v118, a62
    v_accvgpr_read_b32 v119, a63
    v_cvt_pk_bf16_f32 v152, v104, v105
    v_cvt_pk_bf16_f32 v153, v106, v107
    v_cvt_pk_bf16_f32 v154, v108, v109
    v_cvt_pk_bf16_f32 v155, v110, v111
    v_cvt_pk_bf16_f32 v156, v112, v113
    v_cvt_pk_bf16_f32 v157, v114, v115
    v_cvt_pk_bf16_f32 v158, v116, v117
    v_cvt_pk_bf16_f32 v159, v118, v119
    s_nop 1
    v_permlane32_swap_b32 v152, v154
    v_permlane32_swap_b32 v153, v155
    v_permlane32_swap_b32 v156, v158
    v_permlane32_swap_b32 v157, v159
    s_add_u32 s31, s30, 0
    buffer_store_dwordx4 v[152:155], v2, s[20:23], s31 offen offset:192
    buffer_store_dwordx4 v[156:159], v2, s[20:23], s31 offen offset:224
    v_accvgpr_read_b32 v104, a64
    v_accvgpr_read_b32 v105, a65
    v_accvgpr_read_b32 v106, a66
    v_accvgpr_read_b32 v107, a67
    v_accvgpr_read_b32 v108, a68
    v_accvgpr_read_b32 v109, a69
    v_accvgpr_read_b32 v110, a70
    v_accvgpr_read_b32 v111, a71
    v_accvgpr_read_b32 v112, a72
    v_accvgpr_read_b32 v113, a73
    v_accvgpr_read_b32 v114, a74
    v_accvgpr_read_b32 v115, a75
    v_accvgpr_read_b32 v116, a76
    v_accvgpr_read_b32 v117, a77
    v_accvgpr_read_b32 v118, a78
    v_accvgpr_read_b32 v119, a79
    v_cvt_pk_bf16_f32 v128, v104, v105
    v_cvt_pk_bf16_f32 v129, v106, v107
    v_cvt_pk_bf16_f32 v130, v108, v109
    v_cvt_pk_bf16_f32 v131, v110, v111
    v_cvt_pk_bf16_f32 v132, v112, v113
    v_cvt_pk_bf16_f32 v133, v114, v115
    v_cvt_pk_bf16_f32 v134, v116, v117
    v_cvt_pk_bf16_f32 v135, v118, v119
    s_nop 1
    v_permlane32_swap_b32 v128, v130
    v_permlane32_swap_b32 v129, v131
    v_permlane32_swap_b32 v132, v134
    v_permlane32_swap_b32 v133, v135
    s_add_u32 s31, s30, 0
    buffer_store_dwordx4 v[128:131], v2, s[20:23], s31 offen offset:256
    buffer_store_dwordx4 v[132:135], v2, s[20:23], s31 offen offset:288
    v_accvgpr_read_b32 v104, a80
    v_accvgpr_read_b32 v105, a81
    v_accvgpr_read_b32 v106, a82
    v_accvgpr_read_b32 v107, a83
    v_accvgpr_read_b32 v108, a84
    v_accvgpr_read_b32 v109, a85
    v_accvgpr_read_b32 v110, a86
    v_accvgpr_read_b32 v111, a87
    v_accvgpr_read_b32 v112, a88
    v_accvgpr_read_b32 v113, a89
    v_accvgpr_read_b32 v114, a90
    v_accvgpr_read_b32 v115, a91
    v_accvgpr_read_b32 v116, a92
    v_accvgpr_read_b32 v117, a93
    v_accvgpr_read_b32 v118, a94
    v_accvgpr_read_b32 v119, a95
    v_cvt_pk_bf16_f32 v136, v104, v105
    v_cvt_pk_bf16_f32 v137, v106, v107
    v_cvt_pk_bf16_f32 v138, v108, v109
    v_cvt_pk_bf16_f32 v139, v110, v111
    v_cvt_pk_bf16_f32 v140, v112, v113
    v_cvt_pk_bf16_f32 v141, v114, v115
    v_cvt_pk_bf16_f32 v142, v116, v117
    v_cvt_pk_bf16_f32 v143, v118, v119
    s_nop 1
    v_permlane32_swap_b32 v136, v138
    v_permlane32_swap_b32 v137, v139
    v_permlane32_swap_b32 v140, v142
    v_permlane32_swap_b32 v141, v143
    s_add_u32 s31, s30, 81920
    buffer_store_dwordx4 v[136:139], v2, s[20:23], s31 offen offset:0
    buffer_store_dwordx4 v[140:143], v2, s[20:23], s31 offen offset:32
    v_accvgpr_read_b32 v104, a96
    v_accvgpr_read_b32 v105, a97
    v_accvgpr_read_b32 v106, a98
    v_accvgpr_read_b32 v107, a99
    v_accvgpr_read_b32 v108, a100
    v_accvgpr_read_b32 v109, a101
    v_accvgpr_read_b32 v110, a102
    v_accvgpr_read_b32 v111, a103
    v_accvgpr_read_b32 v112, a104
    v_accvgpr_read_b32 v113, a105
    v_accvgpr_read_b32 v114, a106
    v_accvgpr_read_b32 v115, a107
    v_accvgpr_read_b32 v116, a108
    v_accvgpr_read_b32 v117, a109
    v_accvgpr_read_b32 v118, a110
    v_accvgpr_read_b32 v119, a111
    v_cvt_pk_bf16_f32 v144, v104, v105
    v_cvt_pk_bf16_f32 v145, v106, v107
    v_cvt_pk_bf16_f32 v146, v108, v109
    v_cvt_pk_bf16_f32 v147, v110, v111
    v_cvt_pk_bf16_f32 v148, v112, v113
    v_cvt_pk_bf16_f32 v149, v114, v115
    v_cvt_pk_bf16_f32 v150, v116, v117
    v_cvt_pk_bf16_f32 v151, v118, v119
    s_nop 1
    v_permlane32_swap_b32 v144, v146
    v_permlane32_swap_b32 v145, v147
    v_permlane32_swap_b32 v148, v150
    v_permlane32_swap_b32 v149, v151
    s_add_u32 s31, s30, 81920
    buffer_store_dwordx4 v[144:147], v2, s[20:23], s31 offen offset:64
    buffer_store_dwordx4 v[148:151], v2, s[20:23], s31 offen offset:96
    v_accvgpr_read_b32 v104, a112
    v_accvgpr_read_b32 v105, a113
    v_accvgpr_read_b32 v106, a114
    v_accvgpr_read_b32 v107, a115
    v_accvgpr_read_b32 v108, a116
    v_accvgpr_read_b32 v109, a117
    v_accvgpr_read_b32 v110, a118
    v_accvgpr_read_b32 v111, a119
    v_accvgpr_read_b32 v112, a120
    v_accvgpr_read_b32 v113, a121
    v_accvgpr_read_b32 v114, a122
    v_accvgpr_read_b32 v115, a123
    v_accvgpr_read_b32 v116, a124
    v_accvgpr_read_b32 v117, a125
    v_accvgpr_read_b32 v118, a126
    v_accvgpr_read_b32 v119, a127
    v_cvt_pk_bf16_f32 v152, v104, v105
    v_cvt_pk_bf16_f32 v153, v106, v107
    v_cvt_pk_bf16_f32 v154, v108, v109
    v_cvt_pk_bf16_f32 v155, v110, v111
    v_cvt_pk_bf16_f32 v156, v112, v113
    v_cvt_pk_bf16_f32 v157, v114, v115
    v_cvt_pk_bf16_f32 v158, v116, v117
    v_cvt_pk_bf16_f32 v159, v118, v119
    s_nop 1
    v_permlane32_swap_b32 v152, v154
    v_permlane32_swap_b32 v153, v155
    v_permlane32_swap_b32 v156, v158
    v_permlane32_swap_b32 v157, v159
    s_add_u32 s31, s30, 81920
    buffer_store_dwordx4 v[152:155], v2, s[20:23], s31 offen offset:128
    buffer_store_dwordx4 v[156:159], v2, s[20:23], s31 offen offset:160
    v_accvgpr_read_b32 v104, a128
    v_accvgpr_read_b32 v105, a129
    v_accvgpr_read_b32 v106, a130
    v_accvgpr_read_b32 v107, a131
    v_accvgpr_read_b32 v108, a132
    v_accvgpr_read_b32 v109, a133
    v_accvgpr_read_b32 v110, a134
    v_accvgpr_read_b32 v111, a135
    v_accvgpr_read_b32 v112, a136
    v_accvgpr_read_b32 v113, a137
    v_accvgpr_read_b32 v114, a138
    v_accvgpr_read_b32 v115, a139
    v_accvgpr_read_b32 v116, a140
    v_accvgpr_read_b32 v117, a141
    v_accvgpr_read_b32 v118, a142
    v_accvgpr_read_b32 v119, a143
    v_cvt_pk_bf16_f32 v128, v104, v105
    v_cvt_pk_bf16_f32 v129, v106, v107
    v_cvt_pk_bf16_f32 v130, v108, v109
    v_cvt_pk_bf16_f32 v131, v110, v111
    v_cvt_pk_bf16_f32 v132, v112, v113
    v_cvt_pk_bf16_f32 v133, v114, v115
    v_cvt_pk_bf16_f32 v134, v116, v117
    v_cvt_pk_bf16_f32 v135, v118, v119
    s_nop 1
    v_permlane32_swap_b32 v128, v130
    v_permlane32_swap_b32 v129, v131
    v_permlane32_swap_b32 v132, v134
    v_permlane32_swap_b32 v133, v135
    s_add_u32 s31, s30, 81920
    buffer_store_dwordx4 v[128:131], v2, s[20:23], s31 offen offset:192
    buffer_store_dwordx4 v[132:135], v2, s[20:23], s31 offen offset:224
    v_accvgpr_read_b32 v104, a144
    v_accvgpr_read_b32 v105, a145
    v_accvgpr_read_b32 v106, a146
    v_accvgpr_read_b32 v107, a147
    v_accvgpr_read_b32 v108, a148
    v_accvgpr_read_b32 v109, a149
    v_accvgpr_read_b32 v110, a150
    v_accvgpr_read_b32 v111, a151
    v_accvgpr_read_b32 v112, a152
    v_accvgpr_read_b32 v113, a153
    v_accvgpr_read_b32 v114, a154
    v_accvgpr_read_b32 v115, a155
    v_accvgpr_read_b32 v116, a156
    v_accvgpr_read_b32 v117, a157
    v_accvgpr_read_b32 v118, a158
    v_accvgpr_read_b32 v119, a159
    v_cvt_pk_bf16_f32 v136, v104, v105
    v_cvt_pk_bf16_f32 v137, v106, v107
    v_cvt_pk_bf16_f32 v138, v108, v109
    v_cvt_pk_bf16_f32 v139, v110, v111
    v_cvt_pk_bf16_f32 v140, v112, v113
    v_cvt_pk_bf16_f32 v141, v114, v115
    v_cvt_pk_bf16_f32 v142, v116, v117
    v_cvt_pk_bf16_f32 v143, v118, v119
    s_nop 1
    v_permlane32_swap_b32 v136, v138
    v_permlane32_swap_b32 v137, v139
    v_permlane32_swap_b32 v140, v142
    v_permlane32_swap_b32 v141, v143
    s_add_u32 s31, s30, 81920
    buffer_store_dwordx4 v[136:139], v2, s[20:23], s31 offen offset:256
    buffer_store_dwordx4 v[140:143], v2, s[20:23], s31 offen offset:288
    s_branch M_fin
M_fin:
    s_waitcnt vmcnt(0)
    s_barrier
    s_and_b32 s44, s97, 1
    s_cmp_lg_u32 s44, 0
    s_cbranch_scc1 WI_26_d
    s_load_dwordx2 s[46:47], s[0:1], 88
    v_mov_b32 v250, 76
    s_mov_b32 s45, 0
    s_waitcnt lgkmcnt(0)
WI_26_l:
    global_load_dword v251, v250, s[46:47] sc1
    s_add_u32 s45, s45, 1
    s_cmp_gt_u32 s45, 200000
    s_cbranch_scc1 WI_26_e
    s_waitcnt vmcnt(0)
    s_movk_i32 s44, 8
    v_cmp_gt_u32 vcc, s44, v251
    s_cbranch_vccz WI_26_e
    s_sleep 4
    s_branch WI_26_l
WI_26_e:
    s_or_b32 s97, s97, 1
WI_26_d:
    s_cmp_lg_u32 s4, 0
    s_cbranch_scc1 SFL_25
    s_load_dwordx2 s[8:9], s[0:1], 96
    s_waitcnt lgkmcnt(0)
    s_mov_b32 s10, 0x10000000
    s_mov_b32 s11, 0x20000
    v_mov_b32 v250, 0
    v_mov_b32 v251, 1
    v_and_b32 v252, 63, v0
    v_cmp_eq_u32 vcc, 0, v252
    s_and_saveexec_b64 s[44:45], vcc
    buffer_store_dword v251, v250, s[8:11], s99 offen sc1
    s_mov_b64 exec, s[44:45]
SFL_25:
    s_branch M_gl
M_gdone:
    s_cmp_ge_u32 s96, 4
    s_cbranch_scc1 M_end
    s_cmp_ge_u32 s95, 28
    s_cbranch_scc1 M_end
    s_cmp_ge_u32 s95, 20
    s_cbranch_scc1 M_p1
    s_mov_b32 s17, s95
    s_sub_u32 s18, s96, 2
    s_load_dwordx2 s[12:13], s[0:1], 40
    v_and_b32 v1, 63, v0
    v_lshrrev_b32 v2, 2, v1
    v_mul_u32_u24 v2, 1280, v2
    v_and_b32 v3, 3, v1
    v_lshl_add_u32 v2, v3, 4, v2
    v_bfe_u32 v4, v1, 2, 2
    v_lshrrev_b32 v5, 5, v1
    v_lshl_add_u32 v4, v5, 2, v4
    v_lshlrev_b32 v4, 6, v4
    v_bfe_u32 v5, v1, 4, 1
    v_lshl_add_u32 v4, v5, 5, v4
    v_and_b32 v5, 3, v1
    v_lshl_add_u32 v4, v5, 3, v4
    s_lshl_b32 s20, s4, 15
    v_add_u32 v4, s20, v4
    s_waitcnt lgkmcnt(0)
    s_mov_b32 s14, 5242880
    s_mov_b32 s15, 0x20000
    s_lshl_b32 s21, s17, 6
    s_mul_i32 s22, s4, 1310720
    s_add_u32 s21, s21, s22
    s_add_u32 m0, s20, 0
    s_add_u32 s23, s21, 0
    buffer_load_dwordx4 v2, s[12:15], s23 offen lds
    s_add_u32 m0, s20, 1024
    s_add_u32 s23, s21, 20480
    buffer_load_dwordx4 v2, s[12:15], s23 offen lds
    s_add_u32 m0, s20, 2048
    s_add_u32 s23, s21, 40960
    buffer_load_dwordx4 v2, s[12:15], s23 offen lds
    s_add_u32 m0, s20, 3072
    s_add_u32 s23, s21, 61440
    buffer_load_dwordx4 v2, s[12:15], s23 offen lds
    s_add_u32 m0, s20, 4096
    s_add_u32 s23, s21, 81920
    buffer_load_dwordx4 v2, s[12:15], s23 offen lds
    s_add_u32 m0, s20, 5120
    s_add_u32 s23, s21, 102400
    buffer_load_dwordx4 v2, s[12:15], s23 offen lds
    s_add_u32 m0, s20, 6144
    s_add_u32 s23, s21, 122880
    buffer_load_dwordx4 v2, s[12:15], s23 offen lds
    s_add_u32 m0, s20, 7168
    s_add_u32 s23, s21, 143360
    buffer_load_dwordx4 v2, s[12:15], s23 offen lds
    s_add_u32 m0, s20, 8192
    s_add_u32 s23, s21, 163840
    buffer_load_dwordx4 v2, s[12:15], s23 offen lds
    s_add_u32 m0, s20, 9216
    s_add_u32 s23, s21, 184320
    buffer_load_dwordx4 v2, s[12:15], s23 offen lds
    s_add_u32 m0, s20, 10240
    s_add_u32 s23, s21, 204800
    buffer_load_dwordx4 v2, s[12:15], s23 offen lds
    s_add_u32 m0, s20, 11264
    s_add_u32 s23, s21, 225280
    buffer_load_dwordx4 v2, s[12:15], s23 offen lds
    s_add_u32 m0, s20, 12288
    s_add_u32 s23, s21, 245760
    buffer_load_dwordx4 v2, s[12:15], s23 offen lds
    s_add_u32 m0, s20, 13312
    s_add_u32 s23, s21, 266240
    buffer_load_dwordx4 v2, s[12:15], s23 offen lds
    s_add_u32 m0, s20, 14336
    s_add_u32 s23, s21, 286720
    buffer_load_dwordx4 v2, s[12:15], s23 offen lds
    s_add_u32 m0, s20, 15360
    s_add_u32 s23, s21, 307200
    buffer_load_dwordx4 v2, s[12:15], s23 offen lds
    s_add_u32 m0, s20, 16384
    s_add_u32 s23, s21, 327680
    buffer_load_dwordx4 v2, s[12:15], s23 offen lds
    s_add_u32 m0, s20, 17408
    s_add_u32 s23, s21, 348160
    buffer_load_dwordx4 v2, s[12:15], s23 offen lds
    s_add_u32 m0, s20, 18432
    s_add_u32 s23, s21, 368640
    buffer_load_dwordx4 v2, s[12:15], s23 offen lds
    s_add_u32 m0, s20, 19456
    s_add_u32 s23, s21, 389120
    buffer_load_dwordx4 v2, s[12:15], s23 offen lds
    s_add_u32 m0, s20, 20480
    s_add_u32 s23, s21, 409600
    buffer_load_dwordx4 v2, s[12:15], s23 offen lds
    s_add_u32 m0, s20, 21504
    s_add_u32 s23, s21, 430080
    buffer_load_dwordx4 v2, s[12:15], s23 offen lds
    s_add_u32 m0, s20, 22528
    s_add_u32 s23, s21, 450560
    buffer_load_dwordx4 v2, s[12:15], s23 offen lds
    s_add_u32 m0, s20, 23552
    s_add_u32 s23, s21, 471040
    buffer_load_dwordx4 v2, s[12:15], s23 offen lds
    s_add_u32 m0, s20, 24576
    s_add_u32 s23, s21, 491520
    buffer_load_dwordx4 v2, s[12:15], s23 offen lds
    s_add_u32 m0, s20, 25600
    s_add_u32 s23, s21, 512000
    buffer_load_dwordx4 v2, s[12:15], s23 offen lds
    s_add_u32 m0, s20, 26624
    s_add_u32 s23, s21, 532480
    buffer_load_dwordx4 v2, s[12:15], s23 offen lds
    s_add_u32 m0, s20, 27648
    s_add_u32 s23, s21, 552960
    buffer_load_dwordx4 v2, s[12:15], s23 offen lds
    s_add_u32 m0, s20, 28672
    s_add_u32 s23, s21, 573440
    buffer_load_dwordx4 v2, s[12:15], s23 offen lds
    s_add_u32 m0, s20, 29696
    s_add_u32 s23, s21, 593920
    buffer_load_dwordx4 v2, s[12:15], s23 offen lds
    s_add_u32 m0, s20, 30720
    s_add_u32 s23, s21, 614400
    buffer_load_dwordx4 v2, s[12:15], s23 offen lds
    s_add_u32 m0, s20, 31744
    s_add_u32 s23, s21, 634880
    buffer_load_dwordx4 v2, s[12:15], s23 offen lds
    s_waitcnt vmcnt(0)
    ds_read_b64_tr_b16 a[0:1], v4 offset:0
    ds_read_b64_tr_b16 a[2:3], v4 offset:512
    ds_read_b64_tr_b16 a[4:5], v4 offset:1024
    ds_read_b64_tr_b16 a[6:7], v4 offset:1536
    ds_read_b64_tr_b16 a[8:9], v4 offset:2048
    ds_read_b64_tr_b16 a[10:11], v4 offset:2560
    ds_read_b64_tr_b16 a[12:13], v4 offset:3072
    ds_read_b64_tr_b16 a[14:15], v4 offset:3584
    ds_read_b64_tr_b16 a[16:17], v4 offset:4096
    ds_read_b64_tr_b16 a[18:19], v4 offset:4608
    ds_read_b64_tr_b16 a[20:21], v4 offset:5120
    ds_read_b64_tr_b16 a[22:23], v4 offset:5632
    ds_read_b64_tr_b16 a[24:25], v4 offset:6144
    ds_read_b64_tr_b16 a[26:27], v4 offset:6656
    ds_read_b64_tr_b16 a[28:29], v4 offset:7168
    ds_read_b64_tr_b16 a[30:31], v4 offset:7680
    ds_read_b64_tr_b16 a[32:33], v4 offset:8192
    ds_read_b64_tr_b16 a[34:35], v4 offset:8704
    ds_read_b64_tr_b16 a[36:37], v4 offset:9216
    ds_read_b64_tr_b16 a[38:39], v4 offset:9728
    ds_read_b64_tr_b16 a[40:41], v4 offset:10240
    ds_read_b64_tr_b16 a[42:43], v4 offset:10752
    ds_read_b64_tr_b16 a[44:45], v4 offset:11264
    ds_read_b64_tr_b16 a[46:47], v4 offset:11776
    ds_read_b64_tr_b16 a[48:49], v4 offset:12288
    ds_read_b64_tr_b16 a[50:51], v4 offset:12800
    ds_read_b64_tr_b16 a[52:53], v4 offset:13312
    ds_read_b64_tr_b16 a[54:55], v4 offset:13824
    ds_read_b64_tr_b16 a[56:57], v4 offset:14336
    ds_read_b64_tr_b16 a[58:59], v4 offset:14848
    ds_read_b64_tr_b16 a[60:61], v4 offset:15360
    ds_read_b64_tr_b16 a[62:63], v4 offset:15872
    ds_read_b64_tr_b16 a[64:65], v4 offset:16384
    ds_read_b64_tr_b16 a[66:67], v4 offset:16896
    ds_read_b64_tr_b16 a[68:69], v4 offset:17408
    ds_read_b64_tr_b16 a[70:71], v4 offset:17920
    ds_read_b64_tr_b16 a[72:73], v4 offset:18432
    ds_read_b64_tr_b16 a[74:75], v4 offset:18944
    ds_read_b64_tr_b16 a[76:77], v4 offset:19456
    ds_read_b64_tr_b16 a[78:79], v4 offset:19968
    ds_read_b64_tr_b16 a[80:81], v4 offset:20480
    ds_read_b64_tr_b16 a[82:83], v4 offset:20992
    ds_read_b64_tr_b16 a[84:85], v4 offset:21504
    ds_read_b64_tr_b16 a[86:87], v4 offset:22016
    ds_read_b64_tr_b16 a[88:89], v4 offset:22528
    ds_read_b64_tr_b16 a[90:91], v4 offset:23040
    ds_read_b64_tr_b16 a[92:93], v4 offset:23552
    ds_read_b64_tr_b16 a[94:95], v4 offset:24064
    ds_read_b64_tr_b16 a[96:97], v4 offset:24576
    ds_read_b64_tr_b16 a[98:99], v4 offset:25088
    ds_read_b64_tr_b16 a[100:101], v4 offset:25600
    ds_read_b64_tr_b16 a[102:103], v4 offset:26112
    ds_read_b64_tr_b16 a[104:105], v4 offset:26624
    ds_read_b64_tr_b16 a[106:107], v4 offset:27136
    ds_read_b64_tr_b16 a[108:109], v4 offset:27648
    ds_read_b64_tr_b16 a[110:111], v4 offset:28160
    ds_read_b64_tr_b16 a[112:113], v4 offset:28672
    ds_read_b64_tr_b16 a[114:115], v4 offset:29184
    ds_read_b64_tr_b16 a[116:117], v4 offset:29696
    ds_read_b64_tr_b16 a[118:119], v4 offset:30208
    ds_read_b64_tr_b16 a[120:121], v4 offset:30720
    ds_read_b64_tr_b16 a[122:123], v4 offset:31232
    ds_read_b64_tr_b16 a[124:125], v4 offset:31744
    ds_read_b64_tr_b16 a[126:127], v4 offset:32256
    s_waitcnt lgkmcnt(0)
    s_add_u32 m0, s20, 0
    s_add_u32 s23, s21, 655360
    buffer_load_dwordx4 v2, s[12:15], s23 offen lds
    s_add_u32 m0, s20, 1024
    s_add_u32 s23, s21, 675840
    buffer_load_dwordx4 v2, s[12:15], s23 offen lds
    s_add_u32 m0, s20, 2048
    s_add_u32 s23, s21, 696320
    buffer_load_dwordx4 v2, s[12:15], s23 offen lds
    s_add_u32 m0, s20, 3072
    s_add_u32 s23, s21, 716800
    buffer_load_dwordx4 v2, s[12:15], s23 offen lds
    s_add_u32 m0, s20, 4096
    s_add_u32 s23, s21, 737280
    buffer_load_dwordx4 v2, s[12:15], s23 offen lds
    s_add_u32 m0, s20, 5120
    s_add_u32 s23, s21, 757760
    buffer_load_dwordx4 v2, s[12:15], s23 offen lds
    s_add_u32 m0, s20, 6144
    s_add_u32 s23, s21, 778240
    buffer_load_dwordx4 v2, s[12:15], s23 offen lds
    s_add_u32 m0, s20, 7168
    s_add_u32 s23, s21, 798720
    buffer_load_dwordx4 v2, s[12:15], s23 offen lds
    s_add_u32 m0, s20, 8192
    s_add_u32 s23, s21, 819200
    buffer_load_dwordx4 v2, s[12:15], s23 offen lds
    s_add_u32 m0, s20, 9216
    s_add_u32 s23, s21, 839680
    buffer_load_dwordx4 v2, s[12:15], s23 offen lds
    s_add_u32 m0, s20, 10240
    s_add_u32 s23, s21, 860160
    buffer_load_dwordx4 v2, s[12:15], s23 offen lds
    s_add_u32 m0, s20, 11264
    s_add_u32 s23, s21, 880640
    buffer_load_dwordx4 v2, s[12:15], s23 offen lds
    s_add_u32 m0, s20, 12288
    s_add_u32 s23, s21, 901120
    buffer_load_dwordx4 v2, s[12:15], s23 offen lds
    s_add_u32 m0, s20, 13312
    s_add_u32 s23, s21, 921600
    buffer_load_dwordx4 v2, s[12:15], s23 offen lds
    s_add_u32 m0, s20, 14336
    s_add_u32 s23, s21, 942080
    buffer_load_dwordx4 v2, s[12:15], s23 offen lds
    s_add_u32 m0, s20, 15360
    s_add_u32 s23, s21, 962560
    buffer_load_dwordx4 v2, s[12:15], s23 offen lds
    s_add_u32 m0, s20, 16384
    s_add_u32 s23, s21, 983040
    buffer_load_dwordx4 v2, s[12:15], s23 offen lds
    s_add_u32 m0, s20, 17408
    s_add_u32 s23, s21, 1003520
    buffer_load_dwordx4 v2, s[12:15], s23 offen lds
    s_add_u32 m0, s20, 18432
    s_add_u32 s23, s21, 1024000
    buffer_load_dwordx4 v2, s[12:15], s23 offen lds
    s_add_u32 m0, s20, 19456
    s_add_u32 s23, s21, 1044480
    buffer_load_dwordx4 v2, s[12:15], s23 offen lds
    s_add_u32 m0, s20, 20480
    s_add_u32 s23, s21, 1064960
    buffer_load_dwordx4 v2, s[12:15], s23 offen lds
    s_add_u32 m0, s20, 21504
    s_add_u32 s23, s21, 1085440
    buffer_load_dwordx4 v2, s[12:15], s23 offen lds
    s_add_u32 m0, s20, 22528
    s_add_u32 s23, s21, 1105920
    buffer_load_dwordx4 v2, s[12:15], s23 offen lds
    s_add_u32 m0, s20, 23552
    s_add_u32 s23, s21, 1126400
    buffer_load_dwordx4 v2, s[12:15], s23 offen lds
    s_add_u32 m0, s20, 24576
    s_add_u32 s23, s21, 1146880
    buffer_load_dwordx4 v2, s[12:15], s23 offen lds
    s_add_u32 m0, s20, 25600
    s_add_u32 s23, s21, 1167360
    buffer_load_dwordx4 v2, s[12:15], s23 offen lds
    s_add_u32 m0, s20, 26624
    s_add_u32 s23, s21, 1187840
    buffer_load_dwordx4 v2, s[12:15], s23 offen lds
    s_add_u32 m0, s20, 27648
    s_add_u32 s23, s21, 1208320
    buffer_load_dwordx4 v2, s[12:15], s23 offen lds
    s_add_u32 m0, s20, 28672
    s_add_u32 s23, s21, 1228800
    buffer_load_dwordx4 v2, s[12:15], s23 offen lds
    s_add_u32 m0, s20, 29696
    s_add_u32 s23, s21, 1249280
    buffer_load_dwordx4 v2, s[12:15], s23 offen lds
    s_add_u32 m0, s20, 30720
    s_add_u32 s23, s21, 1269760
    buffer_load_dwordx4 v2, s[12:15], s23 offen lds
    s_add_u32 m0, s20, 31744
    s_add_u32 s23, s21, 1290240
    buffer_load_dwordx4 v2, s[12:15], s23 offen lds
    s_waitcnt vmcnt(0)
    ds_read_b64_tr_b16 a[128:129], v4 offset:0
    ds_read_b64_tr_b16 a[130:131], v4 offset:512
    ds_read_b64_tr_b16 a[132:133], v4 offset:1024
    ds_read_b64_tr_b16 a[134:135], v4 offset:1536
    ds_read_b64_tr_b16 a[136:137], v4 offset:2048
    ds_read_b64_tr_b16 a[138:139], v4 offset:2560
    ds_read_b64_tr_b16 a[140:141], v4 offset:3072
    ds_read_b64_tr_b16 a[142:143], v4 offset:3584
    ds_read_b64_tr_b16 a[144:145], v4 offset:4096
    ds_read_b64_tr_b16 a[146:147], v4 offset:4608
    ds_read_b64_tr_b16 a[148:149], v4 offset:5120
    ds_read_b64_tr_b16 a[150:151], v4 offset:5632
    ds_read_b64_tr_b16 a[152:153], v4 offset:6144
    ds_read_b64_tr_b16 a[154:155], v4 offset:6656
    ds_read_b64_tr_b16 a[156:157], v4 offset:7168
    ds_read_b64_tr_b16 a[158:159], v4 offset:7680
    ds_read_b64_tr_b16 a[160:161], v4 offset:8192
    ds_read_b64_tr_b16 a[162:163], v4 offset:8704
    ds_read_b64_tr_b16 a[164:165], v4 offset:9216
    ds_read_b64_tr_b16 a[166:167], v4 offset:9728
    ds_read_b64_tr_b16 a[168:169], v4 offset:10240
    ds_read_b64_tr_b16 a[170:171], v4 offset:10752
    ds_read_b64_tr_b16 a[172:173], v4 offset:11264
    ds_read_b64_tr_b16 a[174:175], v4 offset:11776
    ds_read_b64_tr_b16 a[176:177], v4 offset:12288
    ds_read_b64_tr_b16 a[178:179], v4 offset:12800
    ds_read_b64_tr_b16 a[180:181], v4 offset:13312
    ds_read_b64_tr_b16 a[182:183], v4 offset:13824
    ds_read_b64_tr_b16 a[184:185], v4 offset:14336
    ds_read_b64_tr_b16 a[186:187], v4 offset:14848
    ds_read_b64_tr_b16 a[188:189], v4 offset:15360
    ds_read_b64_tr_b16 a[190:191], v4 offset:15872
    ds_read_b64_tr_b16 a[192:193], v4 offset:16384
    ds_read_b64_tr_b16 a[194:195], v4 offset:16896
    ds_read_b64_tr_b16 a[196:197], v4 offset:17408
    ds_read_b64_tr_b16 a[198:199], v4 offset:17920
    ds_read_b64_tr_b16 a[200:201], v4 offset:18432
    ds_read_b64_tr_b16 a[202:203], v4 offset:18944
    ds_read_b64_tr_b16 a[204:205], v4 offset:19456
    ds_read_b64_tr_b16 a[206:207], v4 offset:19968
    ds_read_b64_tr_b16 a[208:209], v4 offset:20480
    ds_read_b64_tr_b16 a[210:211], v4 offset:20992
    ds_read_b64_tr_b16 a[212:213], v4 offset:21504
    ds_read_b64_tr_b16 a[214:215], v4 offset:22016
    ds_read_b64_tr_b16 a[216:217], v4 offset:22528
    ds_read_b64_tr_b16 a[218:219], v4 offset:23040
    ds_read_b64_tr_b16 a[220:221], v4 offset:23552
    ds_read_b64_tr_b16 a[222:223], v4 offset:24064
    ds_read_b64_tr_b16 a[224:225], v4 offset:24576
    ds_read_b64_tr_b16 a[226:227], v4 offset:25088
    ds_read_b64_tr_b16 a[228:229], v4 offset:25600
    ds_read_b64_tr_b16 a[230:231], v4 offset:26112
    ds_read_b64_tr_b16 a[232:233], v4 offset:26624
    ds_read_b64_tr_b16 a[234:235], v4 offset:27136
    ds_read_b64_tr_b16 a[236:237], v4 offset:27648
    ds_read_b64_tr_b16 a[238:239], v4 offset:28160
    ds_read_b64_tr_b16 a[240:241], v4 offset:28672
    ds_read_b64_tr_b16 a[242:243], v4 offset:29184
    ds_read_b64_tr_b16 a[244:245], v4 offset:29696
    ds_read_b64_tr_b16 a[246:247], v4 offset:30208
    ds_read_b64_tr_b16 a[248:249], v4 offset:30720
    ds_read_b64_tr_b16 a[250:251], v4 offset:31232
    ds_read_b64_tr_b16 a[252:253], v4 offset:31744
    ds_read_b64_tr_b16 a[254:255], v4 offset:32256
    s_waitcnt lgkmcnt(0)
    s_load_dwordx2 s[8:9], s[0:1], 96
    s_waitcnt lgkmcnt(0)
    s_mov_b32 s10, 0x10000000
    s_mov_b32 s11, 0x20000
    s_and_b32 s44, s97, 1
    s_cmp_lg_u32 s44, 0
    s_cbranch_scc1 WI_27_d
    s_load_dwordx2 s[46:47], s[0:1], 88
    v_mov_b32 v250, 76
    s_mov_b32 s45, 0
    s_waitcnt lgkmcnt(0)
WI_27_l:
    global_load_dword v251, v250, s[46:47] sc1
    s_add_u32 s45, s45, 1
    s_cmp_gt_u32 s45, 200000
    s_cbranch_scc1 WI_27_e
    s_waitcnt vmcnt(0)
    s_movk_i32 s44, 8
    v_cmp_gt_u32 vcc, s44, v251
    s_cbranch_vccz WI_27_e
    s_sleep 4
    s_branch WI_27_l
WI_27_e:
    s_or_b32 s97, s97, 1
WI_27_d:
    s_load_dwordx2 s[12:13], s[0:1], 80
    s_waitcnt lgkmcnt(0)
    s_mov_b32 s14, 5242880
    s_mov_b32 s15, 0x20000
    v_and_b32 v1, 63, v0
    v_lshlrev_b32 v2, 4, v1
    s_lshl_b32 s20, s4, 12
    s_add_u32 s20, s20, 131072
    v_add_u32 v3, s20, v2
    s_lshl_b32 s20, s4, 10
    s_add_u32 s20, s20, 131072
    v_add_u32 v4, s20, v2
    v_and_b32 v5, 31, v1
    v_mul_u32_u24 v5, 2560, v5
    v_lshrrev_b32 v6, 5, v1
    v_lshl_add_u32 v5, v6, 3, v5
    s_lshl_b32 s20, s17, 6
    s_lshl_b32 s21, s4, 4
    s_add_u32 s20, s20, s21
    v_add_u32 v5, s20, v5
    s_mov_b32 s16, s18
M_p2l:
    s_lshl_b32 s44, s16, 5
    s_lshl_b32 s46, s4, 3
    s_add_u32 s44, s44, s46
    s_lshl_b32 s44, s44, 2
    s_add_u32 s44, s44, 100679680
    v_and_b32 v6, 63, v0
    v_min_u32 v6, 7, v6
    v_lshlrev_b32 v6, 2, v6
    s_mov_b32 s45, 0
WF_28_l:
    buffer_load_dword v7, v6, s[8:11], s44 offen sc1
    s_add_u32 s45, s45, 1
    s_cmp_gt_u32 s45, 200000
    s_cbranch_scc1 WF_28_e
    s_waitcnt vmcnt(0)
    v_cmp_ne_u32 vcc, 1, v7
    s_cbranch_vccz WF_28_e
    s_sleep 8
    s_branch WF_28_l
WF_28_e:
    s_lshl_b32 s22, s16, 5
    s_lshl_b32 s23, s4, 3
    s_add_u32 s22, s22, s23
    s_lshl_b32 s22, s22, 13
    s_add_u32 s22, s22, 50331648
    buffer_load_dwordx4 v[32:35], v2, s[8:11], s22 offen offset:0 sc1
    buffer_load_dwordx4 v[36:39], v2, s[8:11], s22 offen offset:1024 sc1
    buffer_load_dwordx4 v[40:43], v2, s[8:11], s22 offen offset:2048 sc1
    buffer_load_dwordx4 v[44:47], v2, s[8:11], s22 offen offset:3072 sc1
    s_add_u32 s22, s22, 4096
    buffer_load_dwordx4 v[48:51], v2, s[8:11], s22 offen offset:0 sc1
    buffer_load_dwordx4 v[52:55], v2, s[8:11], s22 offen offset:1024 sc1
    buffer_load_dwordx4 v[56:59], v2, s[8:11], s22 offen offset:2048 sc1
    buffer_load_dwordx4 v[60:63], v2, s[8:11], s22 offen offset:3072 sc1
    s_add_u32 s22, s22, 4096
    buffer_load_dwordx4 v[64:67], v2, s[8:11], s22 offen offset:0 sc1
    buffer_load_dwordx4 v[68:71], v2, s[8:11], s22 offen offset:1024 sc1
    buffer_load_dwordx4 v[72:75], v2, s[8:11], s22 offen offset:2048 sc1
    buffer_load_dwordx4 v[76:79], v2, s[8:11], s22 offen offset:3072 sc1
    s_add_u32 s22, s22, 4096
    buffer_load_dwordx4 v[80:83], v2, s[8:11], s22 offen offset:0 sc1
    buffer_load_dwordx4 v[84:87], v2, s[8:11], s22 offen offset:1024 sc1
    buffer_load_dwordx4 v[88:91], v2, s[8:11], s22 offen offset:2048 sc1
    buffer_load_dwordx4 v[92:95], v2, s[8:11], s22 offen offset:3072 sc1
    s_add_u32 s22, s22, 4096
    buffer_load_dwordx4 v[96:99], v2, s[8:11], s22 offen offset:0 sc1
    buffer_load_dwordx4 v[100:103], v2, s[8:11], s22 offen offset:1024 sc1
    buffer_load_dwordx4 v[104:107], v2, s[8:11], s22 offen offset:2048 sc1
    buffer_load_dwordx4 v[108:111], v2, s[8:11], s22 offen offset:3072 sc1
    s_add_u32 s22, s22, 4096
    buffer_load_dwordx4 v[112:115], v2, s[8:11], s22 offen offset:0 sc1
    buffer_load_dwordx4 v[116:119], v2, s[8:11], s22 offen offset:1024 sc1
    buffer_load_dwordx4 v[120:123], v2, s[8:11], s22 offen offset:2048 sc1
    buffer_load_dwordx4 v[124:127], v2, s[8:11], s22 offen offset:3072 sc1
    s_add_u32 s22, s22, 4096
    buffer_load_dwordx4 v[128:131], v2, s[8:11], s22 offen offset:0 sc1
    buffer_load_dwordx4 v[132:135], v2, s[8:11], s22 offen offset:1024 sc1
    buffer_load_dwordx4 v[136:139], v2, s[8:11], s22 offen offset:2048 sc1
    buffer_load_dwordx4 v[140:143], v2, s[8:11], s22 offen offset:3072 sc1
    s_add_u32 s22, s22, 4096
    buffer_load_dwordx4 v[144:147], v2, s[8:11], s22 offen offset:0 sc1
    buffer_load_dwordx4 v[148:151], v2, s[8:11], s22 offen offset:1024 sc1
    buffer_load_dwordx4 v[152:155], v2, s[8:11], s22 offen offset:2048 sc1
    buffer_load_dwordx4 v[156:159], v2, s[8:11], s22 offen offset:3072 sc1
    s_add_u32 s22, s22, 4096
    buffer_load_dwordx4 v[160:163], v2, s[8:11], s22 offen offset:0 sc1
    buffer_load_dwordx4 v[164:167], v2, s[8:11], s22 offen offset:1024 sc1
    buffer_load_dwordx4 v[168:171], v2, s[8:11], s22 offen offset:2048 sc1
    buffer_load_dwordx4 v[172:175], v2, s[8:11], s22 offen offset:3072 sc1
    s_add_u32 s22, s22, 4096
    buffer_load_dwordx4 v[176:179], v2, s[8:11], s22 offen offset:0 sc1
    buffer_load_dwordx4 v[180:183], v2, s[8:11], s22 offen offset:1024 sc1
    buffer_load_dwordx4 v[184:187], v2, s[8:11], s22 offen offset:2048 sc1
    buffer_load_dwordx4 v[188:191], v2, s[8:11], s22 offen offset:3072 sc1
    s_waitcnt vmcnt(39)
    v_mfma_f32_32x32x16_bf16 v[8:23], a[0:3], v[32:35], 0
    s_add_u32 s22, s22, 4096
    buffer_load_dwordx4 v[32:35], v2, s[8:11], s22 offen offset:0 sc1
    s_waitcnt vmcnt(39)
    v_mfma_f32_32x32x16_bf16 v[8:23], a[4:7], v[36:39], v[8:23]
    buffer_load_dwordx4 v[36:39], v2, s[8:11], s22 offen offset:1024 sc1
    s_waitcnt vmcnt(39)
    v_mfma_f32_32x32x16_bf16 v[8:23], a[8:11], v[40:43], v[8:23]
    buffer_load_dwordx4 v[40:43], v2, s[8:11], s22 offen offset:2048 sc1
    s_waitcnt vmcnt(39)
    v_mfma_f32_32x32x16_bf16 v[8:23], a[12:15], v[44:47], v[8:23]
    buffer_load_dwordx4 v[44:47], v2, s[8:11], s22 offen offset:3072 sc1
    s_waitcnt vmcnt(39)
    v_mfma_f32_32x32x16_bf16 v[8:23], a[16:19], v[48:51], v[8:23]
    s_add_u32 s22, s22, 4096
    buffer_load_dwordx4 v[48:51], v2, s[8:11], s22 offen offset:0 sc1
    s_waitcnt vmcnt(39)
    v_mfma_f32_32x32x16_bf16 v[8:23], a[20:23], v[52:55], v[8:23]
    buffer_load_dwordx4 v[52:55], v2, s[8:11], s22 offen offset:1024 sc1
    s_waitcnt vmcnt(39)
    v_mfma_f32_32x32x16_bf16 v[8:23], a[24:27], v[56:59], v[8:23]
    buffer_load_dwordx4 v[56:59], v2, s[8:11], s22 offen offset:2048 sc1
    s_waitcnt vmcnt(39)
    v_mfma_f32_32x32x16_bf16 v[8:23], a[28:31], v[60:63], v[8:23]
    buffer_load_dwordx4 v[60:63], v2, s[8:11], s22 offen offset:3072 sc1
    s_waitcnt vmcnt(39)
    v_mfma_f32_32x32x16_bf16 v[8:23], a[32:35], v[64:67], v[8:23]
    s_add_u32 s22, s22, 4096
    buffer_load_dwordx4 v[64:67], v2, s[8:11], s22 offen offset:0 sc1
    s_waitcnt vmcnt(39)
    v_mfma_f32_32x32x16_bf16 v[8:23], a[36:39], v[68:71], v[8:23]
    buffer_load_dwordx4 v[68:71], v2, s[8:11], s22 offen offset:1024 sc1
    s_waitcnt vmcnt(39)
    v_mfma_f32_32x32x16_bf16 v[8:23], a[40:43], v[72:75], v[8:23]
    buffer_load_dwordx4 v[72:75], v2, s[8:11], s22 offen offset:2048 sc1
    s_waitcnt vmcnt(39)
    v_mfma_f32_32x32x16_bf16 v[8:23], a[44:47], v[76:79], v[8:23]
    buffer_load_dwordx4 v[76:79], v2, s[8:11], s22 offen offset:3072 sc1
    s_waitcnt vmcnt(39)
    v_mfma_f32_32x32x16_bf16 v[8:23], a[48:51], v[80:83], v[8:23]
    s_add_u32 s22, s22, 4096
    buffer_load_dwordx4 v[80:83], v2, s[8:11], s22 offen offset:0 sc1
    s_waitcnt vmcnt(39)
    v_mfma_f32_32x32x16_bf16 v[8:23], a[52:55], v[84:87], v[8:23]
    buffer_load_dwordx4 v[84:87], v2, s[8:11], s22 offen offset:1024 sc1
    s_waitcnt vmcnt(39)
    v_mfma_f32_32x32x16_bf16 v[8:23], a[56:59], v[88:91], v[8:23]
    buffer_load_dwordx4 v[88:91], v2, s[8:11], s22 offen offset:2048 sc1
    s_waitcnt vmcnt(39)
    v_mfma_f32_32x32x16_bf16 v[8:23], a[60:63], v[92:95], v[8:23]
    buffer_load_dwordx4 v[92:95], v2, s[8:11], s22 offen offset:3072 sc1
    s_waitcnt vmcnt(39)
    v_mfma_f32_32x32x16_bf16 v[8:23], a[64:67], v[96:99], v[8:23]
    s_add_u32 s22, s22, 4096
    buffer_load_dwordx4 v[96:99], v2, s[8:11], s22 offen offset:0 sc1
    s_waitcnt vmcnt(39)
    v_mfma_f32_32x32x16_bf16 v[8:23], a[68:71], v[100:103], v[8:23]
    buffer_load_dwordx4 v[100:103], v2, s[8:11], s22 offen offset:1024 sc1
    s_waitcnt vmcnt(39)
    v_mfma_f32_32x32x16_bf16 v[8:23], a[72:75], v[104:107], v[8:23]
    buffer_load_dwordx4 v[104:107], v2, s[8:11], s22 offen offset:2048 sc1
    s_waitcnt vmcnt(39)
    v_mfma_f32_32x32x16_bf16 v[8:23], a[76:79], v[108:111], v[8:23]
    buffer_load_dwordx4 v[108:111], v2, s[8:11], s22 offen offset:3072 sc1
    s_waitcnt vmcnt(39)
    v_mfma_f32_32x32x16_bf16 v[8:23], a[80:83], v[112:115], v[8:23]
    s_add_u32 s22, s22, 4096
    buffer_load_dwordx4 v[112:115], v2, s[8:11], s22 offen offset:0 sc1
    s_waitcnt vmcnt(39)
    v_mfma_f32_32x32x16_bf16 v[8:23], a[84:87], v[116:119], v[8:23]
    buffer_load_dwordx4 v[116:119], v2, s[8:11], s22 offen offset:1024 sc1
    s_waitcnt vmcnt(39)
    v_mfma_f32_32x32x16_bf16 v[8:23], a[88:91], v[120:123], v[8:23]
    buffer_load_dwordx4 v[120:123], v2, s[8:11], s22 offen offset:2048 sc1
    s_waitcnt vmcnt(39)
    v_mfma_f32_32x32x16_bf16 v[8:23], a[92:95], v[124:127], v[8:23]
    buffer_load_dwordx4 v[124:127], v2, s[8:11], s22 offen offset:3072 sc1
    s_waitcnt vmcnt(39)
    v_mfma_f32_32x32x16_bf16 v[8:23], a[96:99], v[128:131], v[8:23]
    s_waitcnt vmcnt(38)
    v_mfma_f32_32x32x16_bf16 v[8:23], a[100:103], v[132:135], v[8:23]
    s_waitcnt vmcnt(37)
    v_mfma_f32_32x32x16_bf16 v[8:23], a[104:107], v[136:139], v[8:23]
    s_waitcnt vmcnt(36)
    v_mfma_f32_32x32x16_bf16 v[8:23], a[108:111], v[140:143], v[8:23]
    s_waitcnt vmcnt(35)
    v_mfma_f32_32x32x16_bf16 v[8:23], a[112:115], v[144:147], v[8:23]
    s_waitcnt vmcnt(34)
    v_mfma_f32_32x32x16_bf16 v[8:23], a[116:119], v[148:151], v[8:23]
    s_waitcnt vmcnt(33)
    v_mfma_f32_32x32x16_bf16 v[8:23], a[120:123], v[152:155], v[8:23]
    s_waitcnt vmcnt(32)
    v_mfma_f32_32x32x16_bf16 v[8:23], a[124:127], v[156:159], v[8:23]
    s_waitcnt vmcnt(31)
    v_mfma_f32_32x32x16_bf16 v[8:23], a[128:131], v[160:163], v[8:23]
    s_waitcnt vmcnt(30)
    v_mfma_f32_32x32x16_bf16 v[8:23], a[132:135], v[164:167], v[8:23]
    s_waitcnt vmcnt(29)
    v_mfma_f32_32x32x16_bf16 v[8:23], a[136:139], v[168:171], v[8:23]
    s_waitcnt vmcnt(28)
    v_mfma_f32_32x32x16_bf16 v[8:23], a[140:143], v[172:175], v[8:23]
    s_waitcnt vmcnt(27)
    v_mfma_f32_32x32x16_bf16 v[8:23], a[144:147], v[176:179], v[8:23]
    s_waitcnt vmcnt(26)
    v_mfma_f32_32x32x16_bf16 v[8:23], a[148:151], v[180:183], v[8:23]
    s_waitcnt vmcnt(25)
    v_mfma_f32_32x32x16_bf16 v[8:23], a[152:155], v[184:187], v[8:23]
    s_waitcnt vmcnt(24)
    v_mfma_f32_32x32x16_bf16 v[8:23], a[156:159], v[188:191], v[8:23]
    s_waitcnt vmcnt(23)
    v_mfma_f32_32x32x16_bf16 v[8:23], a[160:163], v[32:35], v[8:23]
    s_waitcnt vmcnt(22)
    v_mfma_f32_32x32x16_bf16 v[8:23], a[164:167], v[36:39], v[8:23]
    s_waitcnt vmcnt(21)
    v_mfma_f32_32x32x16_bf16 v[8:23], a[168:171], v[40:43], v[8:23]
    s_waitcnt vmcnt(20)
    v_mfma_f32_32x32x16_bf16 v[8:23], a[172:175], v[44:47], v[8:23]
    s_waitcnt vmcnt(19)
    v_mfma_f32_32x32x16_bf16 v[8:23], a[176:179], v[48:51], v[8:23]
    s_waitcnt vmcnt(18)
    v_mfma_f32_32x32x16_bf16 v[8:23], a[180:183], v[52:55], v[8:23]
    s_waitcnt vmcnt(17)
    v_mfma_f32_32x32x16_bf16 v[8:23], a[184:187], v[56:59], v[8:23]
    s_waitcnt vmcnt(16)
    v_mfma_f32_32x32x16_bf16 v[8:23], a[188:191], v[60:63], v[8:23]
    s_waitcnt vmcnt(15)
    v_mfma_f32_32x32x16_bf16 v[8:23], a[192:195], v[64:67], v[8:23]
    s_waitcnt vmcnt(14)
    v_mfma_f32_32x32x16_bf16 v[8:23], a[196:199], v[68:71], v[8:23]
    s_waitcnt vmcnt(13)
    v_mfma_f32_32x32x16_bf16 v[8:23], a[200:203], v[72:75], v[8:23]
    s_waitcnt vmcnt(12)
    v_mfma_f32_32x32x16_bf16 v[8:23], a[204:207], v[76:79], v[8:23]
    s_waitcnt vmcnt(11)
    v_mfma_f32_32x32x16_bf16 v[8:23], a[208:211], v[80:83], v[8:23]
    s_waitcnt vmcnt(10)
    v_mfma_f32_32x32x16_bf16 v[8:23], a[212:215], v[84:87], v[8:23]
    s_waitcnt vmcnt(9)
    v_mfma_f32_32x32x16_bf16 v[8:23], a[216:219], v[88:91], v[8:23]
    s_waitcnt vmcnt(8)
    v_mfma_f32_32x32x16_bf16 v[8:23], a[220:223], v[92:95], v[8:23]
    s_waitcnt vmcnt(7)
    v_mfma_f32_32x32x16_bf16 v[8:23], a[224:227], v[96:99], v[8:23]
    s_waitcnt vmcnt(6)
    v_mfma_f32_32x32x16_bf16 v[8:23], a[228:231], v[100:103], v[8:23]
    s_waitcnt vmcnt(5)
    v_mfma_f32_32x32x16_bf16 v[8:23], a[232:235], v[104:107], v[8:23]
    s_waitcnt vmcnt(4)
    v_mfma_f32_32x32x16_bf16 v[8:23], a[236:239], v[108:111], v[8:23]
    s_waitcnt vmcnt(3)
    v_mfma_f32_32x32x16_bf16 v[8:23], a[240:243], v[112:115], v[8:23]
    s_waitcnt vmcnt(2)
    v_mfma_f32_32x32x16_bf16 v[8:23], a[244:247], v[116:119], v[8:23]
    s_waitcnt vmcnt(1)
    v_mfma_f32_32x32x16_bf16 v[8:23], a[248:251], v[120:123], v[8:23]
    s_waitcnt vmcnt(0)
    v_mfma_f32_32x32x16_bf16 v[8:23], a[252:255], v[124:127], v[8:23]
    s_nop 7
    s_nop 3
    ds_write_b128 v3, v[8:11] offset:0
    ds_write_b128 v3, v[12:15] offset:1024
    ds_write_b128 v3, v[16:19] offset:2048
    ds_write_b128 v3, v[20:23] offset:3072
    s_waitcnt lgkmcnt(0)
    s_barrier
    ds_read_b128 v[32:35], v4 offset:0
    ds_read_b128 v[36:39], v4 offset:4096
    ds_read_b128 v[40:43], v4 offset:8192
    ds_read_b128 v[44:47], v4 offset:12288
    s_waitcnt lgkmcnt(0)
    v_pk_add_f32 v[32:33], v[32:33], v[36:37]
    v_pk_add_f32 v[34:35], v[34:35], v[38:39]
    v_pk_add_f32 v[32:33], v[32:33], v[40:41]
    v_pk_add_f32 v[34:35], v[34:35], v[42:43]
    v_pk_add_f32 v[32:33], v[32:33], v[44:45]
    v_pk_add_f32 v[34:35], v[34:35], v[46:47]
    v_cvt_pk_bf16_f32 v32, v32, v33
    v_cvt_pk_bf16_f32 v33, v34, v35
    s_mul_i32 s22, s16, 81920
    buffer_store_dwordx2 v[32:33], v5, s[12:15], s22 offen
    s_barrier
    s_add_u32 s16, s16, 2
    s_cmp_lt_u32 s16, 64
    s_cbranch_scc1 M_p2l
    s_branch M_end
M_p1:
    s_sub_u32 s18, s96, 2
    s_sub_u32 s17, s95, 20
    s_lshl_b32 s17, s17, 2
    s_add_u32 s17, s17, s4
    s_load_dwordx2 s[8:9], s[0:1], 96
    s_waitcnt lgkmcnt(0)
    s_mov_b32 s10, 0x10000000
    s_mov_b32 s11, 0x20000
    s_and_b32 s44, s97, 1
    s_cmp_lg_u32 s44, 0
    s_cbranch_scc1 WI_29_d
    s_load_dwordx2 s[46:47], s[0:1], 88
    v_mov_b32 v250, 76
    s_mov_b32 s45, 0
    s_waitcnt lgkmcnt(0)
WI_29_l:
    global_load_dword v251, v250, s[46:47] sc1
    s_add_u32 s45, s45, 1
    s_cmp_gt_u32 s45, 200000
    s_cbranch_scc1 WI_29_e
    s_waitcnt vmcnt(0)
    s_movk_i32 s44, 8
    v_cmp_gt_u32 vcc, s44, v251
    s_cbranch_vccz WI_29_e
    s_sleep 4
    s_branch WI_29_l
WI_29_e:
    s_or_b32 s97, s97, 1
WI_29_d:
    s_and_b32 s44, s97, 2
    s_cmp_lg_u32 s44, 0
    s_cbranch_scc1 WI_30_d
    s_load_dwordx2 s[46:47], s[0:1], 88
    v_mov_b32 v250, 72
    s_mov_b32 s45, 0
    s_waitcnt lgkmcnt(0)
WI_30_l:
    global_load_dword v251, v250, s[46:47] sc1
    s_add_u32 s45, s45, 1
    s_cmp_gt_u32 s45, 200000
    s_cbranch_scc1 WI_30_e
    s_waitcnt vmcnt(0)
    s_movk_i32 s44, 128
    v_cmp_gt_u32 vcc, s44, v251
    s_cbranch_vccz WI_30_e
    s_sleep 4
    s_branch WI_30_l
WI_30_e:
    s_or_b32 s97, s97, 2
WI_30_d:
    v_and_b32 v1, 63, v0
    v_lshlrev_b32 v2, 4, v1
    v_and_b32 v3, 31, v1
    v_lshrrev_b32 v4, 5, v1
    v_and_b32 v5, 7, v1
    v_lshlrev_b32 v5, 4, v5
    v_lshl_add_u32 v5, v4, 7, v5
    v_lshlrev_b32 v6, 10, v4
    v_lshl_add_u32 v6, v3, 2, v6
    v_lshlrev_b32 v7, 2, v4
    v_sub_u32 v7, v3, v7
    s_mov_b32 s20, 0x3e0293ee
    s_mov_b32 s21, s20
    s_mov_b32 s16, s18
M_p1l:
    s_and_b32 s44, s16, 6
    s_cmp_lg_u32 s44, 0
    s_cbranch_scc1 P1F_31
    s_lshr_b32 s44, s16, 3
    s_mul_i32 s44, s44, 48
    s_lshr_b32 s46, s17, 1
    s_add_u32 s44, s44, s46
    s_add_u32 s44, s44, 0
    s_lshl_b32 s44, s44, 2
    s_add_u32 s44, s44, 100663296
    v_and_b32 v250, 63, v0
    v_min_u32 v250, 0, v250
    v_lshlrev_b32 v250, 2, v250
    s_mov_b32 s45, 0
WF_32_l:
    buffer_load_dword v251, v250, s[8:11], s44 offen sc1
    s_add_u32 s45, s45, 1
    s_cmp_gt_u32 s45, 200000
    s_cbranch_scc1 WF_32_e
    s_waitcnt vmcnt(0)
    v_cmp_ne_u32 vcc, 1, v251
    s_cbranch_vccz WF_32_e
    s_sleep 8
    s_branch WF_32_l
WF_32_e:
    s_cmp_ge_u32 s16, 8
    s_cbranch_scc1 H2_33
    s_lshr_b32 s46, s17, 1
    s_add_u32 s44, s46, 0
    s_lshl_b32 s44, s44, 2
    s_add_u32 s44, s44, 100665344
    v_and_b32 v250, 63, v0
    v_min_u32 v250, 0, v250
    v_lshlrev_b32 v250, 2, v250
    s_mov_b32 s45, 0
WF_34_l:
    buffer_load_dword v251, v250, s[8:11], s44 offen sc1
    s_add_u32 s45, s45, 1
    s_cmp_gt_u32 s45, 200000
    s_cbranch_scc1 WF_34_e
    s_waitcnt vmcnt(0)
    v_cmp_ne_u32 vcc, 1, v251
    s_cbranch_vccz WF_34_e
    s_sleep 8
    s_branch WF_34_l
WF_34_e:
H2_33:
    s_lshr_b32 s44, s16, 3
    s_mul_i32 s44, s44, 48
    s_lshr_b32 s46, s17, 1
    s_add_u32 s44, s44, s46
    s_add_u32 s44, s44, 16
    s_lshl_b32 s44, s44, 2
    s_add_u32 s44, s44, 100663296
    v_and_b32 v250, 63, v0
    v_min_u32 v250, 0, v250
    v_lshlrev_b32 v250, 2, v250
    s_mov_b32 s45, 0
WF_35_l:
    buffer_load_dword v251, v250, s[8:11], s44 offen sc1
    s_add_u32 s45, s45, 1
    s_cmp_gt_u32 s45, 200000
    s_cbranch_scc1 WF_35_e
    s_waitcnt vmcnt(0)
    v_cmp_ne_u32 vcc, 1, v251
    s_cbranch_vccz WF_35_e
    s_sleep 8
    s_branch WF_35_l
WF_35_e:
    s_cmp_ge_u32 s16, 8
    s_cbranch_scc1 H2_36
    s_lshr_b32 s46, s17, 1
    s_add_u32 s44, s46, 16
    s_lshl_b32 s44, s44, 2
    s_add_u32 s44, s44, 100665344
    v_and_b32 v250, 63, v0
    v_min_u32 v250, 0, v250
    v_lshlrev_b32 v250, 2, v250
    s_mov_b32 s45, 0
WF_37_l:
    buffer_load_dword v251, v250, s[8:11], s44 offen sc1
    s_add_u32 s45, s45, 1
    s_cmp_gt_u32 s45, 200000
    s_cbranch_scc1 WF_37_e
    s_waitcnt vmcnt(0)
    v_cmp_ne_u32 vcc, 1, v251
    s_cbranch_vccz WF_37_e
    s_sleep 8
    s_branch WF_37_l
WF_37_e:
H2_36:
    s_lshr_b32 s44, s16, 3
    s_mul_i32 s44, s44, 48
    s_lshr_b32 s46, s17, 1
    s_add_u32 s44, s44, s46
    s_add_u32 s44, s44, 32
    s_lshl_b32 s44, s44, 2
    s_add_u32 s44, s44, 100663296
    v_and_b32 v250, 63, v0
    v_min_u32 v250, 0, v250
    v_lshlrev_b32 v250, 2, v250
    s_mov_b32 s45, 0
WF_38_l:
    buffer_load_dword v251, v250, s[8:11], s44 offen sc1
    s_add_u32 s45, s45, 1
    s_cmp_gt_u32 s45, 200000
    s_cbranch_scc1 WF_38_e
    s_waitcnt vmcnt(0)
    v_cmp_ne_u32 vcc, 1, v251
    s_cbranch_vccz WF_38_e
    s_sleep 8
    s_branch WF_38_l
WF_38_e:
P1F_31:
    s_lshl_b32 s22, s16, 5
    s_add_u32 s22, s22, s17
    s_lshl_b32 s23, s22, 13
    s_add_u32 s24, s23, 0
    s_add_u32 s25, s24, 4096
    buffer_load_dwordx4 v[32:35], v2, s[8:11], s24 offen offset:0 sc1
    buffer_load_dwordx4 v[36:39], v2, s[8:11], s24 offen offset:1024 sc1
    buffer_load_dwordx4 v[40:43], v2, s[8:11], s24 offen offset:2048 sc1
    buffer_load_dwordx4 v[44:47], v2, s[8:11], s24 offen offset:3072 sc1
    buffer_load_dwordx4 v[48:51], v2, s[8:11], s25 offen offset:0 sc1
    buffer_load_dwordx4 v[52:55], v2, s[8:11], s25 offen offset:1024 sc1
    buffer_load_dwordx4 v[56:59], v2, s[8:11], s25 offen offset:2048 sc1
    buffer_load_dwordx4 v[60:63], v2, s[8:11], s25 offen offset:3072 sc1
    s_add_u32 s24, s23, 16777216
    s_add_u32 s25, s24, 4096
    buffer_load_dwordx4 v[64:67], v2, s[8:11], s24 offen offset:0 sc1
    buffer_load_dwordx4 v[68:71], v2, s[8:11], s24 offen offset:1024 sc1
    buffer_load_dwordx4 v[72:75], v2, s[8:11], s24 offen offset:2048 sc1
    buffer_load_dwordx4 v[76:79], v2, s[8:11], s24 offen offset:3072 sc1
    buffer_load_dwordx4 v[80:83], v2, s[8:11], s25 offen offset:0 sc1
    buffer_load_dwordx4 v[84:87], v2, s[8:11], s25 offen offset:1024 sc1
    buffer_load_dwordx4 v[88:91], v2, s[8:11], s25 offen offset:2048 sc1
    buffer_load_dwordx4 v[92:95], v2, s[8:11], s25 offen offset:3072 sc1
    s_add_u32 s24, s23, 33554432
    s_add_u32 s25, s24, 4096
    buffer_load_dwordx4 v[128:131], v2, s[8:11], s24 offen offset:0 sc1
    buffer_load_dwordx4 v[132:135], v2, s[8:11], s24 offen offset:1024 sc1
    buffer_load_dwordx4 v[136:139], v2, s[8:11], s24 offen offset:2048 sc1
    buffer_load_dwordx4 v[140:143], v2, s[8:11], s24 offen offset:3072 sc1
    buffer_load_dwordx4 v[144:147], v2, s[8:11], s25 offen offset:0 sc1
    buffer_load_dwordx4 v[148:151], v2, s[8:11], s25 offen offset:1024 sc1
    buffer_load_dwordx4 v[152:155], v2, s[8:11], s25 offen offset:2048 sc1
    buffer_load_dwordx4 v[156:159], v2, s[8:11], s25 offen offset:3072 sc1
    s_waitcnt vmcnt(0)
    v_mfma_f32_32x32x16_bf16 v[176:191], v[64:67], v[32:35], 0
    v_mfma_f32_32x32x16_bf16 v[176:191], v[68:71], v[36:39], v[176:191]
    v_mfma_f32_32x32x16_bf16 v[176:191], v[72:75], v[40:43], v[176:191]
    v_mfma_f32_32x32x16_bf16 v[176:191], v[76:79], v[44:47], v[176:191]
    v_mfma_f32_32x32x16_bf16 v[176:191], v[80:83], v[48:51], v[176:191]
    v_mfma_f32_32x32x16_bf16 v[176:191], v[84:87], v[52:55], v[176:191]
    v_mfma_f32_32x32x16_bf16 v[176:191], v[88:91], v[56:59], v[176:191]
    v_mfma_f32_32x32x16_bf16 v[176:191], v[92:95], v[60:63], v[176:191]
    v_mov_b32 v10, 0xff800000
    s_nop 7
    s_nop 3
    v_cmp_le_i32 vcc, 0, v7
    s_nop 1
    v_cndmask_b32 v176, v10, v176, vcc
    v_cmp_le_i32 vcc, 1, v7
    s_nop 1
    v_cndmask_b32 v177, v10, v177, vcc
    v_cmp_le_i32 vcc, 2, v7
    s_nop 1
    v_cndmask_b32 v178, v10, v178, vcc
    v_cmp_le_i32 vcc, 3, v7
    s_nop 1
    v_cndmask_b32 v179, v10, v179, vcc
    v_cmp_le_i32 vcc, 8, v7
    s_nop 1
    v_cndmask_b32 v180, v10, v180, vcc
    v_cmp_le_i32 vcc, 9, v7
    s_nop 1
    v_cndmask_b32 v181, v10, v181, vcc
    v_cmp_le_i32 vcc, 10, v7
    s_nop 1
    v_cndmask_b32 v182, v10, v182, vcc
    v_cmp_le_i32 vcc, 11, v7
    s_nop 1
    v_cndmask_b32 v183, v10, v183, vcc
    v_cmp_le_i32 vcc, 16, v7
    s_nop 1
    v_cndmask_b32 v184, v10, v184, vcc
    v_cmp_le_i32 vcc, 17, v7
    s_nop 1
    v_cndmask_b32 v185, v10, v185, vcc
    v_cmp_le_i32 vcc, 18, v7
    s_nop 1
    v_cndmask_b32 v186, v10, v186, vcc
    v_cmp_le_i32 vcc, 19, v7
    s_nop 1
    v_cndmask_b32 v187, v10, v187, vcc
    v_cmp_le_i32 vcc, 24, v7
    s_nop 1
    v_cndmask_b32 v188, v10, v188, vcc
    v_cmp_le_i32 vcc, 25, v7
    s_nop 1
    v_cndmask_b32 v189, v10, v189, vcc
    v_cmp_le_i32 vcc, 26, v7
    s_nop 1
    v_cndmask_b32 v190, v10, v190, vcc
    v_cmp_le_i32 vcc, 27, v7
    s_nop 1
    v_cndmask_b32 v191, v10, v191, vcc
    v_max3_f32 v11, v176, v177, v178
    v_max3_f32 v11, v11, v179, v180
    v_max3_f32 v11, v11, v181, v182
    v_max3_f32 v11, v11, v183, v184
    v_max3_f32 v11, v11, v185, v186
    v_max3_f32 v11, v11, v187, v188
    v_max3_f32 v11, v11, v189, v190
    v_max_f32 v11, v11, v191
    s_lshl_b32 s26, s22, 11
    s_add_u32 s27, s26, 71305212
    v_mov_b32 v8, 0
    s_mov_b32 s45, 0
M_p1p:
    buffer_load_dword v9, v8, s[8:11], s27 offen sc1
    s_add_u32 s45, s45, 1
    s_cmp_gt_u32 s45, 200000
    s_cbranch_scc1 M_p1q
    s_waitcnt vmcnt(0)
    v_cmp_eq_u32 vcc, -1, v9
    s_cbranch_vccz M_p1q
    s_sleep 8
    s_branch M_p1p
M_p1q:
    s_mov_b32 s45, 0
M_p1m:
    s_lshl_b32 s26, s22, 11
    s_add_u32 s27, s26, 67108864
    buffer_load_dwordx4 v[96:99], v5, s[8:11], s27 offen offset:0 sc1
    buffer_load_dwordx4 v[100:103], v5, s[8:11], s27 offen offset:256 sc1
    buffer_load_dwordx4 v[104:107], v5, s[8:11], s27 offen offset:512 sc1
    buffer_load_dwordx4 v[108:111], v5, s[8:11], s27 offen offset:768 sc1
    buffer_load_dwordx4 v[112:115], v5, s[8:11], s27 offen offset:1024 sc1
    buffer_load_dwordx4 v[116:119], v5, s[8:11], s27 offen offset:1280 sc1
    buffer_load_dwordx4 v[120:123], v5, s[8:11], s27 offen offset:1536 sc1
    buffer_load_dwordx4 v[124:127], v5, s[8:11], s27 offen offset:1792 sc1
    s_add_u32 s27, s26, 71303168
    buffer_load_dword v160, v6, s[8:11], s27 offen offset:0 sc1
    buffer_load_dword v161, v6, s[8:11], s27 offen offset:512 sc1
    buffer_load_dword v164, v6, s[8:11], s27 offen offset:128 sc1
    buffer_load_dword v165, v6, s[8:11], s27 offen offset:640 sc1
    buffer_load_dword v168, v6, s[8:11], s27 offen offset:256 sc1
    buffer_load_dword v169, v6, s[8:11], s27 offen offset:768 sc1
    buffer_load_dword v172, v6, s[8:11], s27 offen offset:384 sc1
    buffer_load_dword v173, v6, s[8:11], s27 offen offset:896 sc1
    s_add_u32 s45, s45, 1
    s_cmp_gt_u32 s45, 200000
    s_cbranch_scc1 M_p1k
    s_waitcnt vmcnt(0)
    v_max3_u32 v13, v96, v97, v98
    v_max3_u32 v13, v13, v99, v100
    v_max3_u32 v13, v13, v101, v102
    v_max3_u32 v13, v13, v103, v104
    v_max3_u32 v13, v13, v105, v106
    v_max3_u32 v13, v13, v107, v108
    v_max3_u32 v13, v13, v109, v110
    v_max3_u32 v13, v13, v111, v112
    v_max3_u32 v13, v13, v113, v114
    v_max3_u32 v13, v13, v115, v116
    v_max3_u32 v13, v13, v117, v118
    v_max3_u32 v13, v13, v119, v120
    v_max3_u32 v13, v13, v121, v122
    v_max3_u32 v13, v13, v123, v124
    v_max3_u32 v13, v13, v125, v126
    v_max3_u32 v13, v13, v127, v160
    v_max3_u32 v13, v13, v161, v164
    v_max3_u32 v13, v13, v165, v168
    v_max3_u32 v13, v13, v169, v172
    v_max_u32 v13, v13, v173
    v_cmp_eq_u32 vcc, -1, v13
    s_cbranch_vccz M_p1k
    s_sleep 4
    s_branch M_p1m
M_p1k:
    s_waitcnt vmcnt(0)
    v_mov_b64 v[162:163], 0
    v_mov_b64 v[166:167], 0
    v_mov_b64 v[170:171], 0
    v_mov_b64 v[174:175], 0
    v_mfma_f32_32x32x16_bf16 v[192:207], v[96:99], v[32:35], 0
    v_mfma_f32_32x32x16_bf16 v[192:207], v[100:103], v[36:39], v[192:207]
    v_mfma_f32_32x32x16_bf16 v[192:207], v[104:107], v[40:43], v[192:207]
    v_mfma_f32_32x32x16_bf16 v[192:207], v[108:111], v[44:47], v[192:207]
    v_mfma_f32_32x32x16_bf16 v[192:207], v[112:115], v[48:51], v[192:207]
    v_mfma_f32_32x32x16_bf16 v[192:207], v[116:119], v[52:55], v[192:207]
    v_mfma_f32_32x32x16_bf16 v[192:207], v[120:123], v[56:59], v[192:207]
    v_mfma_f32_32x32x16_bf16 v[192:207], v[124:127], v[60:63], v[192:207]
    s_nop 7
    s_nop 3
    v_max3_f32 v11, v11, v192, v193
    v_max3_f32 v11, v11, v194, v195
    v_mov_b32 v12, v11
    s_nop 1
    v_permlane32_swap_b32 v11, v12
    v_max_f32 v11, v11, v12
    v_mul_f32 v12, s20, v11
    v_pk_fma_f32 v[176:177], v[176:177], s[20:21], v[12:13] op_sel_hi:[1,1,0] neg_lo:[0,0,1] neg_hi:[0,0,1]
    v_pk_fma_f32 v[178:179], v[178:179], s[20:21], v[12:13] op_sel_hi:[1,1,0] neg_lo:[0,0,1] neg_hi:[0,0,1]
    v_pk_fma_f32 v[180:181], v[180:181], s[20:21], v[12:13] op_sel_hi:[1,1,0] neg_lo:[0,0,1] neg_hi:[0,0,1]
    v_pk_fma_f32 v[182:183], v[182:183], s[20:21], v[12:13] op_sel_hi:[1,1,0] neg_lo:[0,0,1] neg_hi:[0,0,1]
    v_pk_fma_f32 v[184:185], v[184:185], s[20:21], v[12:13] op_sel_hi:[1,1,0] neg_lo:[0,0,1] neg_hi:[0,0,1]
    v_pk_fma_f32 v[186:187], v[186:187], s[20:21], v[12:13] op_sel_hi:[1,1,0] neg_lo:[0,0,1] neg_hi:[0,0,1]
    v_pk_fma_f32 v[188:189], v[188:189], s[20:21], v[12:13] op_sel_hi:[1,1,0] neg_lo:[0,0,1] neg_hi:[0,0,1]
    v_pk_fma_f32 v[190:191], v[190:191], s[20:21], v[12:13] op_sel_hi:[1,1,0] neg_lo:[0,0,1] neg_hi:[0,0,1]
    v_pk_fma_f32 v[192:193], v[192:193], s[20:21], v[12:13] op_sel_hi:[1,1,0] neg_lo:[0,0,1] neg_hi:[0,0,1]
    v_pk_fma_f32 v[194:195], v[194:195], s[20:21], v[12:13] op_sel_hi:[1,1,0] neg_lo:[0,0,1] neg_hi:[0,0,1]
    v_exp_f32 v176, v176
    v_exp_f32 v177, v177
    v_exp_f32 v178, v178
    v_exp_f32 v179, v179
    v_exp_f32 v180, v180
    v_exp_f32 v181, v181
    v_exp_f32 v182, v182
    v_exp_f32 v183, v183
    v_exp_f32 v184, v184
    v_exp_f32 v185, v185
    v_exp_f32 v186, v186
    v_exp_f32 v187, v187
    v_exp_f32 v188, v188
    v_exp_f32 v189, v189
    v_exp_f32 v190, v190
    v_exp_f32 v191, v191
    v_exp_f32 v192, v192
    v_exp_f32 v193, v193
    v_exp_f32 v194, v194
    v_exp_f32 v195, v195
    s_nop 0
    v_pk_add_f32 v[14:15], v[176:177], v[178:179]
    v_pk_add_f32 v[14:15], v[14:15], v[180:181]
    v_pk_add_f32 v[14:15], v[14:15], v[182:183]
    v_pk_add_f32 v[14:15], v[14:15], v[184:185]
    v_pk_add_f32 v[14:15], v[14:15], v[186:187]
    v_pk_add_f32 v[14:15], v[14:15], v[188:189]
    v_pk_add_f32 v[14:15], v[14:15], v[190:191]
    v_pk_add_f32 v[14:15], v[14:15], v[192:193]
    v_pk_add_f32 v[14:15], v[14:15], v[194:195]
    v_add_f32 v14, v14, v15
    v_cvt_pk_bf16_f32 v208, v176, v177
    v_cvt_pk_bf16_f32 v209, v178, v179
    v_cvt_pk_bf16_f32 v210, v180, v181
    v_cvt_pk_bf16_f32 v211, v182, v183
    v_cvt_pk_bf16_f32 v212, v184, v185
    v_cvt_pk_bf16_f32 v213, v186, v187
    v_cvt_pk_bf16_f32 v214, v188, v189
    v_cvt_pk_bf16_f32 v215, v190, v191
    v_cvt_pk_bf16_f32 v216, v192, v193
    v_cvt_pk_bf16_f32 v217, v194, v195
    v_mov_b64 v[218:219], 0
    v_mov_b32 v15, v14
    s_nop 1
    v_permlane32_swap_b32 v14, v15
    v_add_f32 v14, v14, v15
    v_rcp_f32 v14, v14
    v_mfma_f32_32x32x16_bf16 v[32:47], v[128:131], v[208:211], 0
    v_mfma_f32_32x32x16_bf16 v[32:47], v[132:135], v[212:215], v[32:47]
    v_mfma_f32_32x32x16_bf16 v[32:47], v[160:163], v[216:219], v[32:47]
    v_mfma_f32_32x32x16_bf16 v[48:63], v[136:139], v[208:211], 0
    v_mfma_f32_32x32x16_bf16 v[48:63], v[140:143], v[212:215], v[48:63]
    v_mfma_f32_32x32x16_bf16 v[48:63], v[164:167], v[216:219], v[48:63]
    v_mfma_f32_32x32x16_bf16 v[64:79], v[144:147], v[208:211], 0
    v_mfma_f32_32x32x16_bf16 v[64:79], v[148:151], v[212:215], v[64:79]
    v_mfma_f32_32x32x16_bf16 v[64:79], v[168:171], v[216:219], v[64:79]
    v_mfma_f32_32x32x16_bf16 v[80:95], v[152:155], v[208:211], 0
    v_mfma_f32_32x32x16_bf16 v[80:95], v[156:159], v[212:215], v[80:95]
    v_mfma_f32_32x32x16_bf16 v[80:95], v[172:175], v[216:219], v[80:95]
    s_nop 7
    s_nop 3
    s_add_u32 s24, s23, 50331648
    s_add_u32 s25, s24, 4096
    v_pk_mul_f32 v[32:33], v[32:33], v[14:15] op_sel_hi:[1,0]
    v_pk_mul_f32 v[34:35], v[34:35], v[14:15] op_sel_hi:[1,0]
    v_pk_mul_f32 v[36:37], v[36:37], v[14:15] op_sel_hi:[1,0]
    v_pk_mul_f32 v[38:39], v[38:39], v[14:15] op_sel_hi:[1,0]
    v_pk_mul_f32 v[40:41], v[40:41], v[14:15] op_sel_hi:[1,0]
    v_pk_mul_f32 v[42:43], v[42:43], v[14:15] op_sel_hi:[1,0]
    v_pk_mul_f32 v[44:45], v[44:45], v[14:15] op_sel_hi:[1,0]
    v_pk_mul_f32 v[46:47], v[46:47], v[14:15] op_sel_hi:[1,0]
    v_cvt_pk_bf16_f32 v32, v32, v33
    v_cvt_pk_bf16_f32 v33, v34, v35
    v_cvt_pk_bf16_f32 v34, v36, v37
    v_cvt_pk_bf16_f32 v35, v38, v39
    v_cvt_pk_bf16_f32 v36, v40, v41
    v_cvt_pk_bf16_f32 v37, v42, v43
    v_cvt_pk_bf16_f32 v38, v44, v45
    v_cvt_pk_bf16_f32 v39, v46, v47
    buffer_store_dwordx4 v[32:35], v2, s[8:11], s24 offen offset:0 sc1
    buffer_store_dwordx4 v[36:39], v2, s[8:11], s24 offen offset:1024 sc1
    v_pk_mul_f32 v[48:49], v[48:49], v[14:15] op_sel_hi:[1,0]
    v_pk_mul_f32 v[50:51], v[50:51], v[14:15] op_sel_hi:[1,0]
    v_pk_mul_f32 v[52:53], v[52:53], v[14:15] op_sel_hi:[1,0]
    v_pk_mul_f32 v[54:55], v[54:55], v[14:15] op_sel_hi:[1,0]
    v_pk_mul_f32 v[56:57], v[56:57], v[14:15] op_sel_hi:[1,0]
    v_pk_mul_f32 v[58:59], v[58:59], v[14:15] op_sel_hi:[1,0]
    v_pk_mul_f32 v[60:61], v[60:61], v[14:15] op_sel_hi:[1,0]
    v_pk_mul_f32 v[62:63], v[62:63], v[14:15] op_sel_hi:[1,0]
    v_cvt_pk_bf16_f32 v48, v48, v49
    v_cvt_pk_bf16_f32 v49, v50, v51
    v_cvt_pk_bf16_f32 v50, v52, v53
    v_cvt_pk_bf16_f32 v51, v54, v55
    v_cvt_pk_bf16_f32 v52, v56, v57
    v_cvt_pk_bf16_f32 v53, v58, v59
    v_cvt_pk_bf16_f32 v54, v60, v61
    v_cvt_pk_bf16_f32 v55, v62, v63
    buffer_store_dwordx4 v[48:51], v2, s[8:11], s24 offen offset:2048 sc1
    buffer_store_dwordx4 v[52:55], v2, s[8:11], s24 offen offset:3072 sc1
    v_pk_mul_f32 v[64:65], v[64:65], v[14:15] op_sel_hi:[1,0]
    v_pk_mul_f32 v[66:67], v[66:67], v[14:15] op_sel_hi:[1,0]
    v_pk_mul_f32 v[68:69], v[68:69], v[14:15] op_sel_hi:[1,0]
    v_pk_mul_f32 v[70:71], v[70:71], v[14:15] op_sel_hi:[1,0]
    v_pk_mul_f32 v[72:73], v[72:73], v[14:15] op_sel_hi:[1,0]
    v_pk_mul_f32 v[74:75], v[74:75], v[14:15] op_sel_hi:[1,0]
    v_pk_mul_f32 v[76:77], v[76:77], v[14:15] op_sel_hi:[1,0]
    v_pk_mul_f32 v[78:79], v[78:79], v[14:15] op_sel_hi:[1,0]
    v_cvt_pk_bf16_f32 v64, v64, v65
    v_cvt_pk_bf16_f32 v65, v66, v67
    v_cvt_pk_bf16_f32 v66, v68, v69
    v_cvt_pk_bf16_f32 v67, v70, v71
    v_cvt_pk_bf16_f32 v68, v72, v73
    v_cvt_pk_bf16_f32 v69, v74, v75
    v_cvt_pk_bf16_f32 v70, v76, v77
    v_cvt_pk_bf16_f32 v71, v78, v79
    buffer_store_dwordx4 v[64:67], v2, s[8:11], s25 offen offset:0 sc1
    buffer_store_dwordx4 v[68:71], v2, s[8:11], s25 offen offset:1024 sc1
    v_pk_mul_f32 v[80:81], v[80:81], v[14:15] op_sel_hi:[1,0]
    v_pk_mul_f32 v[82:83], v[82:83], v[14:15] op_sel_hi:[1,0]
    v_pk_mul_f32 v[84:85], v[84:85], v[14:15] op_sel_hi:[1,0]
    v_pk_mul_f32 v[86:87], v[86:87], v[14:15] op_sel_hi:[1,0]
    v_pk_mul_f32 v[88:89], v[88:89], v[14:15] op_sel_hi:[1,0]
    v_pk_mul_f32 v[90:91], v[90:91], v[14:15] op_sel_hi:[1,0]
    v_pk_mul_f32 v[92:93], v[92:93], v[14:15] op_sel_hi:[1,0]
    v_pk_mul_f32 v[94:95], v[94:95], v[14:15] op_sel_hi:[1,0]
    v_cvt_pk_bf16_f32 v80, v80, v81
    v_cvt_pk_bf16_f32 v81, v82, v83
    v_cvt_pk_bf16_f32 v82, v84, v85
    v_cvt_pk_bf16_f32 v83, v86, v87
    v_cvt_pk_bf16_f32 v84, v88, v89
    v_cvt_pk_bf16_f32 v85, v90, v91
    v_cvt_pk_bf16_f32 v86, v92, v93
    v_cvt_pk_bf16_f32 v87, v94, v95
    buffer_store_dwordx4 v[80:83], v2, s[8:11], s25 offen offset:2048 sc1
    buffer_store_dwordx4 v[84:87], v2, s[8:11], s25 offen offset:3072 sc1
    s_waitcnt vmcnt(0)
    s_lshl_b32 s44, s16, 5
    s_add_u32 s44, s44, s17
    s_lshl_b32 s44, s44, 2
    s_add_u32 s44, s44, 100679680
    v_mov_b32 v10, 0
    v_mov_b32 v11, 1
    v_cmp_eq_u32 vcc, 0, v1
    s_and_saveexec_b64 s[46:47], vcc
    buffer_store_dword v11, v10, s[8:11], s44 offen sc1
    s_mov_b64 exec, s[46:47]
    s_add_u32 s16, s16, 2
    s_cmp_lt_u32 s16, 64
    s_cbranch_scc1 M_p1l
    s_branch M_end
M_chain:
    s_lshr_b32 s44, s6, 1
    s_lshl_b32 s7, s5, 4
    s_add_u32 s7, s7, s44
    s_and_b32 s3, s6, 1
    s_load_dwordx2 s[8:9], s[0:1], 96
    s_load_dwordx2 s[60:61], s[0:1], 88
    s_waitcnt lgkmcnt(0)
    s_mov_b32 s10, 0x10000000
    s_mov_b32 s11, 0x20000
    s_add_u32 s44, s8, 92274688
    s_and_b32 s44, s44, 0x1fffff
    s_sub_u32 s44, 0x200000, s44
    s_and_b32 s44, s44, 0x1fffff
    s_add_u32 s33, s44, 92274688
    v_and_b32 v1, 63, v0
    v_and_b32 v30, 15, v1
    v_lshrrev_b32 v31, 4, v1
    v_and_b32 v32, 7, v1
    v_bfe_u32 v33, v1, 1, 1
    v_lshrrev_b32 v38, 2, v30
    v_and_b32 v39, 1, v1
    v_lshl_add_u32 v38, v38, 1, v39
    v_mov_b32 v34, 0x4444
    v_mov_b32 v35, 0xeeee
    v_cmp_eq_u32 vcc, 1, v33
    s_nop 1
    v_cndmask_b32 v2, v34, v35, vcc
    v_cmp_gt_u32 s[36:37], 8, v30
    v_cmp_eq_u32 s[88:89], 0, v33
    v_cmp_gt_u32 s[94:95], 16, v1
    v_lshlrev_b32 v19, 4, v1
    v_lshl_add_u32 v34, v31, 1, v33
    v_lshlrev_b32 v34, 7, v34
    v_lshl_add_u32 v34, v38, 4, v34
    v_add_u32 v4, 81920, v34
    v_mul_u32_u24 v34, 576, v31
    v_bfe_u32 v35, v30, 2, 1
    v_lshlrev_b32 v35, 3, v35
    v_lshrrev_b32 v36, 3, v30
    v_lshl_add_u32 v35, v36, 2, v35
    v_and_b32 v36, 3, v30
    v_add_u32 v35, v35, v36
    s_lshl_b32 s44, s4, 5
    v_add_u32 v35, s44, v35
    v_lshl_add_u32 v34, v35, 1, v34
    v_add_u32 v5, 92160, v34
    v_mul_u32_u24 v34, 288, v32
    v_lshl_add_u32 v34, v31, 4, v34
    v_add_u32 v6, 92160, v34
    v_lshrrev_b32 v34, 3, v30
    v_lshlrev_b32 v34, 4, v34
    v_bfe_u32 v35, v30, 2, 1
    v_lshl_add_u32 v34, v35, 2, v34
    v_and_b32 v35, 3, v30
    v_add_u32 v34, v34, v35
    v_and_b32 v35, 1, v31
    v_lshl_add_u32 v34, v35, 5, v34
    v_lshlrev_b32 v34, 4, v34
    v_lshrrev_b32 v35, 1, v31
    v_lshl_add_u32 v34, v35, 10, v34
    v_add_u32 v7, 98304, v34
    v_and_b32 v34, 1, v31
    v_lshl_add_u32 v34, v34, 5, v30
    v_lshlrev_b32 v34, 4, v34
    v_lshl_add_u32 v34, v35, 10, v34
    s_lshl_b32 s44, s4, 11
    s_add_u32 s44, s44, 106496
    v_add_u32 v8, s44, v34
    v_mul_u32_u24 v34, 304, v32
    v_lshl_add_u32 v35, v31, 3, v34
    s_lshl_b32 s44, s4, 6
    s_add_u32 s44, s44, 94464
    v_add_u32 v9, s44, v35
    v_mul_u32_u24 v34, 304, v38
    v_lshl_add_u32 v35, v31, 1, v33
    v_lshl_add_u32 v35, v35, 4, v34
    v_add_u32 v10, 94464, v35
    s_lshr_b32 s44, s4, 1
    s_lshl_b32 s45, s3, 1
    s_add_u32 s44, s44, s45
    s_lshl_b32 s44, s44, 9
    s_and_b32 s45, s4, 1
    s_lshl_b32 s45, s45, 8
    s_add_u32 s44, s44, s45
    v_and_b32 v34, 1, v31
    v_lshlrev_b32 v34, 7, v34
    v_lshrrev_b32 v35, 1, v31
    v_lshl_add_u32 v34, v35, 3, v34
    v_lshl_add_u32 v34, v32, 4, v34
    v_add_u32 v11, s44, v34
    v_lshlrev_b32 v35, 7, v31
    v_lshl_add_u32 v35, v33, 9, v35
    v_lshl_add_u32 v12, v38, 4, v35
    v_lshl_add_u32 v34, v31, 4, v30
    s_mul_i32 s44, s4, 80
    v_add_u32 v34, s44, v34
    s_mov_b32 s44, 0xCCCCCCCD
    v_mul_hi_u32 v36, v34, s44
    v_lshrrev_b32 v36, 4, v36
    v_mul_u32_u24 v37, 20, v36
    v_sub_u32 v37, v34, v37
    s_lshl_b32 s45, s3, 4
    v_add_u32 v36, s45, v36
    v_lshlrev_b32 v36, 14, v36
    v_lshl_add_u32 v13, v37, 4, v36
    s_mul_i32 s44, s4, 80
    s_add_u32 s44, s44, 64
    v_add_u32 v34, s44, v30
    s_mov_b32 s44, 0xCCCCCCCD
    v_mul_hi_u32 v36, v34, s44
    v_lshrrev_b32 v36, 4, v36
    v_mul_u32_u24 v37, 20, v36
    v_sub_u32 v37, v34, v37
    s_lshl_b32 s45, s3, 4
    v_add_u32 v36, s45, v36
    v_lshlrev_b32 v36, 14, v36
    v_lshl_add_u32 v14, v37, 4, v36
    v_mul_u32_u24 v34, 320, v31
    v_lshl_add_u32 v34, v30, 4, v34
    s_and_b32 s44, s4, 1
    s_lshl_b32 s44, s44, 8
    v_add_u32 v15, s44, v34
    s_and_b32 s44, s4, 1
    s_cmp_eq_u32 s44, 0
    s_cselect_b32 s44, 16, 4
    v_cmp_gt_u32 s[40:41], s44, v30
    s_mul_i32 s44, s6, 20
    s_and_b32 s45, s4, 1
    s_lshl_b32 s46, s45, 4
    s_add_u32 s44, s44, s46
    v_add_u32 v34, s44, v30
    v_lshlrev_b32 v34, 4, v34
    v_and_b32 v35, 1, v31
    v_lshl_add_u32 v16, v35, 3, v34
    s_cmp_eq_u32 s45, 0
    s_cselect_b32 s46, 16, 4
    v_cmp_gt_u32 vcc, s46, v30
    v_cmp_gt_u32 s[46:47], 32, v1
    s_nop 3
    s_and_b64 s[42:43], vcc, s[46:47]
    s_mov_b32 s92, 0
    s_mov_b32 s93, -1
    s_lshl_b32 s44, s4, 5
    v_add_u32 v34, s44, v30
    v_lshlrev_b32 v34, 2, v34
    v_lshl_add_u32 v17, v31, 9, v34
    s_mul_i32 s44, s4, 20480
    v_add_u32 v18, s44, v19
    v_mov_b32 v20, 0
    v_mov_b32 v34, 0x3f80
    v_cmp_eq_u32 vcc, 0, v30
    s_nop 1
    v_cndmask_b32 v20, v20, v34, vcc
    v_mov_b32 v34, 0x3f800000
    v_cmp_eq_u32 vcc, 1, v30
    s_nop 1
    v_cndmask_b32 v20, v20, v34, vcc
    v_mov_b32 v21, 0
    v_mov_b32 v34, 0x3f80
    v_cmp_eq_u32 vcc, 2, v30
    s_nop 1
    v_cndmask_b32 v21, v21, v34, vcc
    v_mov_b32 v34, 0x3f800000
    v_cmp_eq_u32 vcc, 3, v30
    s_nop 1
    v_cndmask_b32 v21, v21, v34, vcc
    v_mov_b32 v22, 0
    v_mov_b32 v34, 0x3f80
    v_cmp_eq_u32 vcc, 4, v30
    s_nop 1
    v_cndmask_b32 v22, v22, v34, vcc
    v_mov_b32 v34, 0x3f800000
    v_cmp_eq_u32 vcc, 5, v30
    s_nop 1
    v_cndmask_b32 v22, v22, v34, vcc
    v_mov_b32 v23, 0
    v_mov_b32 v34, 0x3f80
    v_cmp_eq_u32 vcc, 6, v30
    s_nop 1
    v_cndmask_b32 v23, v23, v34, vcc
    v_mov_b32 v34, 0x3f800000
    v_cmp_eq_u32 vcc, 7, v30
    s_nop 1
    v_cndmask_b32 v23, v23, v34, vcc
    v_lshlrev_b32 v35, 1, v31
    v_mov_b32 v24, 0
    v_add_u32 v36, 0, v35
    v_mov_b32 v34, 0x3f80
    v_cmp_eq_u32 vcc, v36, v32
    s_nop 1
    v_cndmask_b32 v24, v24, v34, vcc
    v_add_u32 v36, 1, v35
    v_mov_b32 v34, 0x3f800000
    v_cmp_eq_u32 vcc, v36, v32
    s_nop 1
    v_cndmask_b32 v24, v24, v34, vcc
    v_mov_b32 v25, 0
    v_mov_b32 v27, 0
    v_mov_b32 v28, 0
    s_mov_b32 s35, 0x3e0293ee
    v_mov_b64 v[108:109], -1
    v_mov_b64 v[110:111], -1
    s_mov_b32 s34, 0
    s_lshl_b32 s47, s5, 19
    s_add_u32 s47, s47, s33
    s_and_b32 s48, s7, 15
    s_mul_i32 s48, s48, 320
    s_sub_u32 s49, 8192, s34
    s_add_u32 s17, s47, s48
    s_add_u32 s17, s17, s49
    s_lshl_b32 s50, s6, 14
    s_add_u32 s50, s50, s47
    s_add_u32 s19, s50, s49
    s_lshr_b32 s48, s6, 4
    s_mul_i32 s49, s48, 11264
    s_add_u32 s49, s49, s34
    s_add_u32 s21, s47, s49
    s_add_u32 s21, s21, 32768
    s_lshl_b32 s50, s5, 19
    s_xor_b32 s50, s50, 0x80000
    s_add_u32 s50, s50, s33
    s_add_u32 s90, s50, s49
    s_add_u32 s22, s21, 65536
    s_add_u32 s23, s90, 65536
    s_mov_b32 s29, 0
    s_lshr_b32 s48, s4, 1
    s_mul_i32 s49, s48, 11264
    s_add_u32 s49, s49, s34
    s_add_u32 s49, s49, s47
    s_mul_i32 s48, s4, 2560
    s_add_u32 s49, s49, s48
    v_and_b32 v40, 15, v1
    v_lshrrev_b32 v41, 5, v1
    v_lshl_add_u32 v40, v41, 4, v40
    v_lshlrev_b32 v40, 4, v40
    v_bfe_u32 v41, v1, 4, 1
    v_xor_b32 v41, 1, v41
    v_lshl_add_u32 v40, v41, 15, v40
    v_add_u32 v3, s49, v40
    s_lshl_b32 s47, s7, 11
    s_add_u32 s47, s47, s33
    s_add_u32 s24, s47, 3145728
    s_add_u32 s27, s24, 0x10000
    s_add_u32 s47, s7, 32
    s_lshl_b32 s47, s47, 13
    s_lshr_b32 s48, s4, 1
    s_lshl_b32 s48, s48, 24
    s_add_u32 s47, s47, s48
    s_and_b32 s48, s4, 1
    s_lshl_b32 s48, s48, 12
    s_add_u32 s47, s47, s48
    s_add_u32 s25, s47, 16777216
    s_lshl_b32 s47, s4, 12
    s_add_u32 s30, s47, 114688
    s_lshl_b32 s47, s4, 10
    s_add_u32 s28, s19, s47
    s_add_u32 s28, s28, 0x100000
    s_lshl_b32 s47, s4, 8
    s_add_u32 s47, s47, 1052672
    s_add_u32 s91, s19, s47
    s_lshl_b32 s59, s3, 2
    s_add_u32 s59, s59, s4
    s_mov_b32 s86, s35
    s_mov_b32 s87, s35
    s_lshl_b32 s26, s7, 11
    s_mov_b64 exec, s[36:37]
    s_add_u32 s44, s24, 0
    buffer_store_dwordx2 v[108:109], v11, s[8:11], s44 offen
    s_mov_b64 exec, s[42:43]
    s_add_u32 s44, s21, 0
    buffer_store_dwordx2 v[108:109], v16, s[8:11], s44 offen sc1
    s_add_u32 s44, s90, 0
    buffer_store_dwordx2 v[108:109], v16, s[8:11], s44 offen sc1
    s_add_u32 s44, s21, 65536
    buffer_store_dwordx2 v[108:109], v16, s[8:11], s44 offen sc1
    s_add_u32 s44, s90, 65536
    buffer_store_dwordx2 v[108:109], v16, s[8:11], s44 offen sc1
    s_add_u32 s44, s21, 131072
    buffer_store_dwordx2 v[108:109], v16, s[8:11], s44 offen sc1
    s_add_u32 s44, s90, 131072
    buffer_store_dwordx2 v[108:109], v16, s[8:11], s44 offen sc1
    s_mov_b64 exec, s[40:41]
    s_add_u32 s44, s19, 0
    buffer_store_dwordx4 v[108:111], v15, s[8:11], s44 offen offset:0 sc1
    buffer_store_dwordx4 v[108:111], v15, s[8:11], s44 offen offset:1280 sc1
    buffer_store_dwordx4 v[108:111], v15, s[8:11], s44 offen offset:2560 sc1
    buffer_store_dwordx4 v[108:111], v15, s[8:11], s44 offen offset:3840 sc1
    s_mov_b64 exec, -1
    s_mov_b64 exec, s[36:37]
    s_add_u32 s44, s24, 65536
    buffer_store_dwordx2 v[108:109], v11, s[8:11], s44 offen
    s_mov_b64 exec, s[40:41]
    s_add_u32 s44, s19, 1048576
    buffer_store_dwordx4 v[108:111], v15, s[8:11], s44 offen offset:0 sc1
    buffer_store_dwordx4 v[108:111], v15, s[8:11], s44 offen offset:1280 sc1
    buffer_store_dwordx4 v[108:111], v15, s[8:11], s44 offen offset:2560 sc1
    buffer_store_dwordx4 v[108:111], v15, s[8:11], s44 offen offset:3840 sc1
    s_mov_b64 exec, -1
    s_mov_b32 s34, 8192
    s_lshl_b32 s47, s5, 19
    s_add_u32 s47, s47, s33
    s_and_b32 s48, s7, 15
    s_mul_i32 s48, s48, 320
    s_sub_u32 s49, 8192, s34
    s_add_u32 s17, s47, s48
    s_add_u32 s17, s17, s49
    s_lshl_b32 s50, s6, 14
    s_add_u32 s50, s50, s47
    s_add_u32 s19, s50, s49
    s_lshr_b32 s48, s6, 4
    s_mul_i32 s49, s48, 11264
    s_add_u32 s49, s49, s34
    s_add_u32 s21, s47, s49
    s_add_u32 s21, s21, 32768
    s_lshl_b32 s50, s5, 19
    s_xor_b32 s50, s50, 0x80000
    s_add_u32 s50, s50, s33
    s_add_u32 s90, s50, s49
    s_add_u32 s22, s21, 65536
    s_add_u32 s23, s90, 65536
    s_mov_b32 s29, 0
    s_lshr_b32 s48, s4, 1
    s_mul_i32 s49, s48, 11264
    s_add_u32 s49, s49, s34
    s_add_u32 s49, s49, s47
    s_mul_i32 s48, s4, 2560
    s_add_u32 s49, s49, s48
    v_and_b32 v40, 15, v1
    v_lshrrev_b32 v41, 5, v1
    v_lshl_add_u32 v40, v41, 4, v40
    v_lshlrev_b32 v40, 4, v40
    v_bfe_u32 v41, v1, 4, 1
    v_xor_b32 v41, 1, v41
    v_lshl_add_u32 v40, v41, 15, v40
    v_add_u32 v3, s49, v40
    s_lshl_b32 s47, s7, 11
    s_add_u32 s47, s47, s33
    s_add_u32 s24, s47, 3145728
    s_add_u32 s27, s24, 0x10000
    s_add_u32 s47, s7, 32
    s_lshl_b32 s47, s47, 13
    s_lshr_b32 s48, s4, 1
    s_lshl_b32 s48, s48, 24
    s_add_u32 s47, s47, s48
    s_and_b32 s48, s4, 1
    s_lshl_b32 s48, s48, 12
    s_add_u32 s47, s47, s48
    s_add_u32 s25, s47, 16777216
    s_lshl_b32 s47, s4, 12
    s_add_u32 s30, s47, 114688
    s_lshl_b32 s47, s4, 10
    s_add_u32 s28, s19, s47
    s_add_u32 s28, s28, 0x100000
    s_lshl_b32 s47, s4, 8
    s_add_u32 s47, s47, 1052672
    s_add_u32 s91, s19, s47
    s_lshl_b32 s59, s3, 2
    s_add_u32 s59, s59, s4
    s_mov_b32 s86, s35
    s_mov_b32 s87, s35
    s_lshl_b32 s26, s7, 11
    s_mov_b64 exec, s[42:43]
    s_add_u32 s44, s21, 0
    buffer_store_dwordx2 v[108:109], v16, s[8:11], s44 offen sc1
    s_add_u32 s44, s90, 0
    buffer_store_dwordx2 v[108:109], v16, s[8:11], s44 offen sc1
    s_add_u32 s44, s21, 65536
    buffer_store_dwordx2 v[108:109], v16, s[8:11], s44 offen sc1
    s_add_u32 s44, s90, 65536
    buffer_store_dwordx2 v[108:109], v16, s[8:11], s44 offen sc1
    s_add_u32 s44, s21, 131072
    buffer_store_dwordx2 v[108:109], v16, s[8:11], s44 offen sc1
    s_add_u32 s44, s90, 131072
    buffer_store_dwordx2 v[108:109], v16, s[8:11], s44 offen sc1
    s_mov_b64 exec, s[40:41]
    s_add_u32 s44, s19, 0
    buffer_store_dwordx4 v[108:111], v15, s[8:11], s44 offen offset:0 sc1
    buffer_store_dwordx4 v[108:111], v15, s[8:11], s44 offen offset:1280 sc1
    buffer_store_dwordx4 v[108:111], v15, s[8:11], s44 offen offset:2560 sc1
    buffer_store_dwordx4 v[108:111], v15, s[8:11], s44 offen offset:3840 sc1
    s_mov_b64 exec, -1
    s_mov_b64 exec, s[40:41]
    s_add_u32 s44, s19, 1048576
    buffer_store_dwordx4 v[108:111], v15, s[8:11], s44 offen offset:0 sc1
    buffer_store_dwordx4 v[108:111], v15, s[8:11], s44 offen offset:1280 sc1
    buffer_store_dwordx4 v[108:111], v15, s[8:11], s44 offen offset:2560 sc1
    buffer_store_dwordx4 v[108:111], v15, s[8:11], s44 offen offset:3840 sc1
    s_mov_b64 exec, -1
    v_lshrrev_b32 v40, 4, v1
    s_lshl_b32 s44, s4, 4
    s_add_u32 s44, s44, 0
    v_add_u32 v41, s44, v40
    v_and_b32 v42, 0x30, v41
    v_bfe_u32 v60, v41, 1, 1
    v_lshl_add_u32 v42, v60, 3, v42
    v_bfe_u32 v60, v41, 2, 2
    v_lshl_add_u32 v42, v60, 1, v42
    v_and_b32 v60, 1, v41
    v_add_u32 v42, v42, v60
    v_lshlrev_b32 v42, 13, v42
    v_lshlrev_b32 v43, 1, v40
    v_or_b32 v43, 0, v43
    v_and_b32 v44, 15, v1
    v_xor_b32 v44, v44, v43
    v_lshl_add_u32 v66, v44, 4, v42
    v_lshrrev_b32 v40, 4, v1
    s_lshl_b32 s44, s4, 4
    s_add_u32 s44, s44, 4
    v_add_u32 v41, s44, v40
    v_and_b32 v42, 0x30, v41
    v_bfe_u32 v60, v41, 1, 1
    v_lshl_add_u32 v42, v60, 3, v42
    v_bfe_u32 v60, v41, 2, 2
    v_lshl_add_u32 v42, v60, 1, v42
    v_and_b32 v60, 1, v41
    v_add_u32 v42, v42, v60
    v_lshlrev_b32 v42, 13, v42
    v_lshlrev_b32 v43, 1, v40
    v_or_b32 v43, 0, v43
    v_and_b32 v44, 15, v1
    v_xor_b32 v44, v44, v43
    v_lshl_add_u32 v67, v44, 4, v42
    v_lshrrev_b32 v40, 4, v1
    s_lshl_b32 s44, s4, 4
    s_add_u32 s44, s44, 8
    v_add_u32 v41, s44, v40
    v_and_b32 v42, 0x30, v41
    v_bfe_u32 v60, v41, 1, 1
    v_lshl_add_u32 v42, v60, 3, v42
    v_bfe_u32 v60, v41, 2, 2
    v_lshl_add_u32 v42, v60, 1, v42
    v_and_b32 v60, 1, v41
    v_add_u32 v42, v42, v60
    v_lshlrev_b32 v42, 13, v42
    v_lshlrev_b32 v43, 1, v40
    v_or_b32 v43, 8, v43
    v_and_b32 v44, 15, v1
    v_xor_b32 v44, v44, v43
    v_lshl_add_u32 v68, v44, 4, v42
    v_lshrrev_b32 v40, 4, v1
    s_lshl_b32 s44, s4, 4
    s_add_u32 s44, s44, 12
    v_add_u32 v41, s44, v40
    v_and_b32 v42, 0x30, v41
    v_bfe_u32 v60, v41, 1, 1
    v_lshl_add_u32 v42, v60, 3, v42
    v_bfe_u32 v60, v41, 2, 2
    v_lshl_add_u32 v42, v60, 1, v42
    v_and_b32 v60, 1, v41
    v_add_u32 v42, v42, v60
    v_lshlrev_b32 v42, 13, v42
    v_lshlrev_b32 v43, 1, v40
    v_or_b32 v43, 8, v43
    v_and_b32 v44, 15, v1
    v_xor_b32 v44, v44, v43
    v_lshl_add_u32 v69, v44, 4, v42
    v_lshrrev_b32 v40, 3, v1
    s_lshl_b32 s44, s4, 4
    s_add_u32 s44, s44, 0
    v_add_u32 v41, s44, v40
    v_and_b32 v42, 0x30, v41
    v_bfe_u32 v60, v41, 1, 1
    v_lshl_add_u32 v42, v60, 3, v42
    v_bfe_u32 v60, v41, 2, 2
    v_lshl_add_u32 v42, v60, 1, v42
    v_and_b32 v60, 1, v41
    v_add_u32 v42, v42, v60
    v_lshlrev_b32 v42, 13, v42
    v_bfe_u32 v43, v41, 1, 1
    v_or_b32 v43, 0, v43
    v_lshlrev_b32 v43, 1, v43
    v_and_b32 v44, 7, v1
    v_xor_b32 v44, v44, v43
    v_lshl_add_u32 v70, v44, 4, v42
    v_lshrrev_b32 v40, 3, v1
    s_lshl_b32 s44, s4, 4
    s_add_u32 s44, s44, 8
    v_add_u32 v41, s44, v40
    v_and_b32 v42, 0x30, v41
    v_bfe_u32 v60, v41, 1, 1
    v_lshl_add_u32 v42, v60, 3, v42
    v_bfe_u32 v60, v41, 2, 2
    v_lshl_add_u32 v42, v60, 1, v42
    v_and_b32 v60, 1, v41
    v_add_u32 v42, v42, v60
    v_lshlrev_b32 v42, 13, v42
    v_bfe_u32 v43, v41, 1, 1
    v_or_b32 v43, 2, v43
    v_lshlrev_b32 v43, 1, v43
    v_and_b32 v44, 7, v1
    v_xor_b32 v44, v44, v43
    v_lshl_add_u32 v71, v44, 4, v42
    v_add_u32 v40, 0, v1
    s_mov_b32 s44, 0xCCCCCCCD
    v_mul_hi_u32 v41, v40, s44
    v_lshrrev_b32 v41, 5, v41
    v_mul_u32_u24 v44, 40, v41
    v_sub_u32 v44, v40, v44
    s_lshl_b32 s44, s4, 4
    v_add_u32 v41, s44, v41
    v_and_b32 v42, 0x30, v41
    v_bfe_u32 v60, v41, 1, 1
    v_lshl_add_u32 v42, v60, 3, v42
    v_bfe_u32 v60, v41, 2, 2
    v_lshl_add_u32 v42, v60, 1, v42
    v_and_b32 v60, 1, v41
    v_add_u32 v42, v42, v60
    v_mul_u32_u24 v42, 1280, v42
    v_bfe_u32 v43, v41, 1, 1
    v_bfe_u32 v45, v41, 3, 1
    v_lshl_add_u32 v43, v45, 1, v43
    v_lshlrev_b32 v43, 1, v43
    v_xor_b32 v44, v44, v43
    v_lshl_add_u32 v72, v44, 4, v42
    v_add_u32 v40, 64, v1
    s_mov_b32 s44, 0xCCCCCCCD
    v_mul_hi_u32 v41, v40, s44
    v_lshrrev_b32 v41, 5, v41
    v_mul_u32_u24 v44, 40, v41
    v_sub_u32 v44, v40, v44
    s_lshl_b32 s44, s4, 4
    v_add_u32 v41, s44, v41
    v_and_b32 v42, 0x30, v41
    v_bfe_u32 v60, v41, 1, 1
    v_lshl_add_u32 v42, v60, 3, v42
    v_bfe_u32 v60, v41, 2, 2
    v_lshl_add_u32 v42, v60, 1, v42
    v_and_b32 v60, 1, v41
    v_add_u32 v42, v42, v60
    v_mul_u32_u24 v42, 1280, v42
    v_bfe_u32 v43, v41, 1, 1
    v_bfe_u32 v45, v41, 3, 1
    v_lshl_add_u32 v43, v45, 1, v43
    v_lshlrev_b32 v43, 1, v43
    v_xor_b32 v44, v44, v43
    v_lshl_add_u32 v73, v44, 4, v42
    v_add_u32 v40, 128, v1
    s_mov_b32 s44, 0xCCCCCCCD
    v_mul_hi_u32 v41, v40, s44
    v_lshrrev_b32 v41, 5, v41
    v_mul_u32_u24 v44, 40, v41
    v_sub_u32 v44, v40, v44
    s_lshl_b32 s44, s4, 4
    v_add_u32 v41, s44, v41
    v_and_b32 v42, 0x30, v41
    v_bfe_u32 v60, v41, 1, 1
    v_lshl_add_u32 v42, v60, 3, v42
    v_bfe_u32 v60, v41, 2, 2
    v_lshl_add_u32 v42, v60, 1, v42
    v_and_b32 v60, 1, v41
    v_add_u32 v42, v42, v60
    v_mul_u32_u24 v42, 1280, v42
    v_bfe_u32 v43, v41, 1, 1
    v_bfe_u32 v45, v41, 3, 1
    v_lshl_add_u32 v43, v45, 1, v43
    v_lshlrev_b32 v43, 1, v43
    v_xor_b32 v44, v44, v43
    v_lshl_add_u32 v74, v44, 4, v42
    v_add_u32 v40, 192, v1
    s_mov_b32 s44, 0xCCCCCCCD
    v_mul_hi_u32 v41, v40, s44
    v_lshrrev_b32 v41, 5, v41
    v_mul_u32_u24 v44, 40, v41
    v_sub_u32 v44, v40, v44
    s_lshl_b32 s44, s4, 4
    v_add_u32 v41, s44, v41
    v_and_b32 v42, 0x30, v41
    v_bfe_u32 v60, v41, 1, 1
    v_lshl_add_u32 v42, v60, 3, v42
    v_bfe_u32 v60, v41, 2, 2
    v_lshl_add_u32 v42, v60, 1, v42
    v_and_b32 v60, 1, v41
    v_add_u32 v42, v42, v60
    v_mul_u32_u24 v42, 1280, v42
    v_bfe_u32 v43, v41, 1, 1
    v_bfe_u32 v45, v41, 3, 1
    v_lshl_add_u32 v43, v45, 1, v43
    v_lshlrev_b32 v43, 1, v43
    v_xor_b32 v44, v44, v43
    v_lshl_add_u32 v75, v44, 4, v42
    v_add_u32 v40, 256, v1
    s_mov_b32 s44, 0xCCCCCCCD
    v_mul_hi_u32 v41, v40, s44
    v_lshrrev_b32 v41, 5, v41
    v_mul_u32_u24 v44, 40, v41
    v_sub_u32 v44, v40, v44
    s_lshl_b32 s44, s4, 4
    v_add_u32 v41, s44, v41
    v_and_b32 v42, 0x30, v41
    v_bfe_u32 v60, v41, 1, 1
    v_lshl_add_u32 v42, v60, 3, v42
    v_bfe_u32 v60, v41, 2, 2
    v_lshl_add_u32 v42, v60, 1, v42
    v_and_b32 v60, 1, v41
    v_add_u32 v42, v42, v60
    v_mul_u32_u24 v42, 1280, v42
    v_bfe_u32 v43, v41, 1, 1
    v_bfe_u32 v45, v41, 3, 1
    v_lshl_add_u32 v43, v45, 1, v43
    v_lshlrev_b32 v43, 1, v43
    v_xor_b32 v44, v44, v43
    v_lshl_add_u32 v76, v44, 4, v42
    v_add_u32 v40, 320, v1
    s_mov_b32 s44, 0xCCCCCCCD
    v_mul_hi_u32 v41, v40, s44
    v_lshrrev_b32 v41, 5, v41
    v_mul_u32_u24 v44, 40, v41
    v_sub_u32 v44, v40, v44
    s_lshl_b32 s44, s4, 4
    v_add_u32 v41, s44, v41
    v_and_b32 v42, 0x30, v41
    v_bfe_u32 v60, v41, 1, 1
    v_lshl_add_u32 v42, v60, 3, v42
    v_bfe_u32 v60, v41, 2, 2
    v_lshl_add_u32 v42, v60, 1, v42
    v_and_b32 v60, 1, v41
    v_add_u32 v42, v42, v60
    v_mul_u32_u24 v42, 1280, v42
    v_bfe_u32 v43, v41, 1, 1
    v_bfe_u32 v45, v41, 3, 1
    v_lshl_add_u32 v43, v45, 1, v43
    v_lshlrev_b32 v43, 1, v43
    v_xor_b32 v44, v44, v43
    v_lshl_add_u32 v77, v44, 4, v42
    v_add_u32 v40, 384, v1
    s_mov_b32 s44, 0xCCCCCCCD
    v_mul_hi_u32 v41, v40, s44
    v_lshrrev_b32 v41, 5, v41
    v_mul_u32_u24 v44, 40, v41
    v_sub_u32 v44, v40, v44
    s_lshl_b32 s44, s4, 4
    v_add_u32 v41, s44, v41
    v_and_b32 v42, 0x30, v41
    v_bfe_u32 v60, v41, 1, 1
    v_lshl_add_u32 v42, v60, 3, v42
    v_bfe_u32 v60, v41, 2, 2
    v_lshl_add_u32 v42, v60, 1, v42
    v_and_b32 v60, 1, v41
    v_add_u32 v42, v42, v60
    v_mul_u32_u24 v42, 1280, v42
    v_bfe_u32 v43, v41, 1, 1
    v_bfe_u32 v45, v41, 3, 1
    v_lshl_add_u32 v43, v45, 1, v43
    v_lshlrev_b32 v43, 1, v43
    v_xor_b32 v44, v44, v43
    v_lshl_add_u32 v78, v44, 4, v42
    v_add_u32 v40, 448, v1
    s_mov_b32 s44, 0xCCCCCCCD
    v_mul_hi_u32 v41, v40, s44
    v_lshrrev_b32 v41, 5, v41
    v_mul_u32_u24 v44, 40, v41
    v_sub_u32 v44, v40, v44
    s_lshl_b32 s44, s4, 4
    v_add_u32 v41, s44, v41
    v_and_b32 v42, 0x30, v41
    v_bfe_u32 v60, v41, 1, 1
    v_lshl_add_u32 v42, v60, 3, v42
    v_bfe_u32 v60, v41, 2, 2
    v_lshl_add_u32 v42, v60, 1, v42
    v_and_b32 v60, 1, v41
    v_add_u32 v42, v42, v60
    v_mul_u32_u24 v42, 1280, v42
    v_bfe_u32 v43, v41, 1, 1
    v_bfe_u32 v45, v41, 3, 1
    v_lshl_add_u32 v43, v45, 1, v43
    v_lshlrev_b32 v43, 1, v43
    v_xor_b32 v44, v44, v43
    v_lshl_add_u32 v79, v44, 4, v42
    v_add_u32 v40, 512, v1
    s_mov_b32 s44, 0xCCCCCCCD
    v_mul_hi_u32 v41, v40, s44
    v_lshrrev_b32 v41, 5, v41
    v_mul_u32_u24 v44, 40, v41
    v_sub_u32 v44, v40, v44
    s_lshl_b32 s44, s4, 4
    v_add_u32 v41, s44, v41
    v_and_b32 v42, 0x30, v41
    v_bfe_u32 v60, v41, 1, 1
    v_lshl_add_u32 v42, v60, 3, v42
    v_bfe_u32 v60, v41, 2, 2
    v_lshl_add_u32 v42, v60, 1, v42
    v_and_b32 v60, 1, v41
    v_add_u32 v42, v42, v60
    v_mul_u32_u24 v42, 1280, v42
    v_bfe_u32 v43, v41, 1, 1
    v_bfe_u32 v45, v41, 3, 1
    v_lshl_add_u32 v43, v45, 1, v43
    v_lshlrev_b32 v43, 1, v43
    v_xor_b32 v44, v44, v43
    v_lshl_add_u32 v80, v44, 4, v42
    v_add_u32 v40, 576, v1
    s_mov_b32 s44, 0xCCCCCCCD
    v_mul_hi_u32 v41, v40, s44
    v_lshrrev_b32 v41, 5, v41
    v_mul_u32_u24 v44, 40, v41
    v_sub_u32 v44, v40, v44
    s_lshl_b32 s44, s4, 4
    v_add_u32 v41, s44, v41
    v_and_b32 v42, 0x30, v41
    v_bfe_u32 v60, v41, 1, 1
    v_lshl_add_u32 v42, v60, 3, v42
    v_bfe_u32 v60, v41, 2, 2
    v_lshl_add_u32 v42, v60, 1, v42
    v_and_b32 v60, 1, v41
    v_add_u32 v42, v42, v60
    v_mul_u32_u24 v42, 1280, v42
    v_bfe_u32 v43, v41, 1, 1
    v_bfe_u32 v45, v41, 3, 1
    v_lshl_add_u32 v43, v45, 1, v43
    v_lshlrev_b32 v43, 1, v43
    v_xor_b32 v44, v44, v43
    v_lshl_add_u32 v81, v44, 4, v42
    v_lshrrev_b32 v40, 4, v1
    v_bfe_u32 v41, v1, 2, 2
    v_and_b32 v42, 3, v1
    v_lshl_add_u32 v43, v40, 3, v41
    v_lshrrev_b32 v44, 1, v42
    v_and_b32 v45, 1, v42
    v_lshlrev_b32 v45, 3, v45
    v_and_b32 v46, 1, v40
    v_lshl_add_u32 v46, v46, 2, v41
    v_lshlrev_b32 v46, 1, v46
    s_lshl_b32 s44, s4, 2
    s_add_u32 s44, s44, 0
    v_add_u32 v47, s44, v44
    v_xor_b32 v47, v47, v46
    v_lshlrev_b32 v47, 4, v47
    v_lshl_add_u32 v47, v43, 8, v47
    v_add_u32 v82, v47, v45
    s_lshl_b32 s44, s4, 2
    s_add_u32 s44, s44, 2
    v_add_u32 v47, s44, v44
    v_xor_b32 v47, v47, v46
    v_lshlrev_b32 v47, 4, v47
    v_lshl_add_u32 v47, v43, 8, v47
    v_add_u32 v83, v47, v45
    v_bfe_u32 v46, v41, 1, 1
    v_and_b32 v47, 1, v40
    v_lshl_add_u32 v46, v47, 1, v46
    v_lshlrev_b32 v46, 1, v46
    s_lshl_b32 s44, s4, 1
    v_add_u32 v47, s44, v44
    v_xor_b32 v47, v47, v46
    v_lshlrev_b32 v47, 4, v47
    v_lshl_add_u32 v47, v43, 7, v47
    v_add_u32 v84, v47, v45
    s_mul_i32 s44, s4, 10
    s_add_u32 s44, s44, 0
    v_add_u32 v47, s44, v44
    v_xor_b32 v47, v47, v46
    v_lshlrev_b32 v47, 4, v47
    v_mul_u32_u24 v48, 640, v43
    v_add3_u32 v47, v47, v48, v45
    v_add_u32 v85, 81920, v47
    s_mul_i32 s44, s4, 10
    s_add_u32 s44, s44, 2
    v_add_u32 v47, s44, v44
    v_xor_b32 v47, v47, v46
    v_lshlrev_b32 v47, 4, v47
    v_mul_u32_u24 v48, 640, v43
    v_add3_u32 v47, v47, v48, v45
    v_add_u32 v86, 81920, v47
    s_mul_i32 s44, s4, 10
    s_add_u32 s44, s44, 4
    v_add_u32 v47, s44, v44
    v_xor_b32 v47, v47, v46
    v_lshlrev_b32 v47, 4, v47
    v_mul_u32_u24 v48, 640, v43
    v_add3_u32 v47, v47, v48, v45
    v_add_u32 v87, 81920, v47
    s_mul_i32 s44, s4, 10
    s_add_u32 s44, s44, 6
    v_add_u32 v47, s44, v44
    v_xor_b32 v47, v47, v46
    v_lshlrev_b32 v47, 4, v47
    v_mul_u32_u24 v48, 640, v43
    v_add3_u32 v47, v47, v48, v45
    v_add_u32 v88, 81920, v47
    s_mul_i32 s44, s4, 10
    s_add_u32 s44, s44, 8
    v_add_u32 v47, s44, v44
    v_xor_b32 v47, v47, v46
    v_lshlrev_b32 v47, 4, v47
    v_mul_u32_u24 v48, 640, v43
    v_add3_u32 v47, v47, v48, v45
    v_add_u32 v89, 81920, v47
    v_add_u32 v82, 81920, v82
    v_add_u32 v83, 81920, v83
    v_add_u32 v84, 114688, v84
    v_add_u32 v90, 16384, v82
    v_add_u32 v91, 16384, v83
    s_load_dwordx2 s[44:45], s[0:1], 16
    s_load_dwordx2 s[46:47], s[0:1], 24
    s_load_dwordx2 s[48:49], s[0:1], 32
    s_waitcnt lgkmcnt(0)
    s_mov_b32 s12, s44
    s_mov_b32 s13, s45
    s_mov_b32 s14, 5242880
    s_mov_b32 s15, 0x20000
    s_mov_b32 s52, s46
    s_mov_b32 s53, s47
    s_mov_b32 s54, 5242880
    s_mov_b32 s55, 0x20000
    s_mov_b32 s56, s48
    s_mov_b32 s57, s49
    s_mov_b32 s58, 5242880
    s_mov_b32 s59, 0x20000
    s_lshl_b32 s46, s7, 8
    s_lshl_b32 s47, s3, 7
    s_add_u32 s47, s47, s46
    s_lshl_b32 s48, s4, 12
    s_lshl_b32 s49, s4, 11
    s_load_dwordx2 s[64:65], s[0:1], 8
    s_load_dwordx2 s[76:77], s[0:1], 40
    s_waitcnt lgkmcnt(0)
    s_mov_b32 s66, 10240
    s_mov_b32 s67, 0x20000
    s_mov_b32 s78, 5242880
    s_mov_b32 s79, 0x20000
    s_cmp_ge_u32 s4, 2
    s_cbranch_scc1 M0_40
    v_add_u32 v40, 0, v0
    v_and_b32 v41, 7, v40
    v_lshrrev_b32 v42, 3, v40
    v_mul_u32_u24 v41, 1280, v41
    v_lshl_add_u32 v41, v42, 4, v41
    buffer_load_dwordx4 v[92:95], v41, s[64:67], 0 offen
    v_add_u32 v40, 128, v0
    v_and_b32 v41, 7, v40
    v_lshrrev_b32 v42, 3, v40
    v_mul_u32_u24 v41, 1280, v41
    v_lshl_add_u32 v41, v42, 4, v41
    buffer_load_dwordx4 v[96:99], v41, s[64:67], 0 offen
    v_add_u32 v40, 256, v0
    v_and_b32 v41, 7, v40
    v_lshrrev_b32 v42, 3, v40
    v_mul_u32_u24 v41, 1280, v41
    v_lshl_add_u32 v41, v42, 4, v41
    buffer_load_dwordx4 v[100:103], v41, s[64:67], 0 offen
    v_add_u32 v40, 384, v0
    v_and_b32 v41, 7, v40
    v_lshrrev_b32 v42, 3, v40
    v_mul_u32_u24 v41, 1280, v41
    v_lshl_add_u32 v41, v42, 4, v41
    buffer_load_dwordx4 v[104:107], v41, s[64:67], 0 offen
    v_add_u32 v40, 512, v0
    v_and_b32 v41, 7, v40
    v_lshrrev_b32 v42, 3, v40
    v_mul_u32_u24 v41, 1280, v41
    v_lshl_add_u32 v41, v42, 4, v41
    buffer_load_dwordx4 v[108:111], v41, s[64:67], 0 offen
M0_40:
    v_subrev_u32 v82, 81920, v82
    v_subrev_u32 v83, 81920, v83
    v_subrev_u32 v84, 81920, v84
    v_subrev_u32 v90, 81920, v90
    v_subrev_u32 v91, 81920, v91
    s_cmp_eq_u32 s3, 0
    s_cbranch_scc0 QL_41_1
    s_add_u32 s50, s46, 0
    s_add_u32 s51, s47, 0
    s_add_u32 m0, s48, 0
    s_nop 0
    buffer_load_dwordx4 v66, s[12:15], s50 offen lds
    s_add_u32 m0, s48, 1024
    s_nop 0
    buffer_load_dwordx4 v67, s[12:15], s50 offen lds
    s_add_u32 m0, s48, 2048
    s_nop 0
    buffer_load_dwordx4 v68, s[12:15], s50 offen lds
    s_add_u32 m0, s48, 3072
    s_nop 0
    buffer_load_dwordx4 v69, s[12:15], s50 offen lds
    s_add_u32 m0, s48, 16384
    s_nop 0
    buffer_load_dwordx4 v66, s[56:59], s50 offen lds
    s_add_u32 m0, s48, 17408
    s_nop 0
    buffer_load_dwordx4 v67, s[56:59], s50 offen lds
    s_add_u32 m0, s48, 18432
    s_nop 0
    buffer_load_dwordx4 v68, s[56:59], s50 offen lds
    s_add_u32 m0, s48, 19456
    s_nop 0
    buffer_load_dwordx4 v69, s[56:59], s50 offen lds
    s_add_u32 m0, s49, 32768
    s_nop 0
    buffer_load_dwordx4 v70, s[52:55], s51 offen lds
    s_add_u32 m0, s49, 33792
    s_nop 0
    buffer_load_dwordx4 v71, s[52:55], s51 offen lds
    s_add_u32 s50, s46, 524288
    s_add_u32 s51, s47, 524288
    s_add_u32 m0, s48, 40960
    s_nop 0
    buffer_load_dwordx4 v66, s[12:15], s50 offen lds
    s_add_u32 m0, s48, 41984
    s_nop 0
    buffer_load_dwordx4 v67, s[12:15], s50 offen lds
    s_add_u32 m0, s48, 43008
    s_nop 0
    buffer_load_dwordx4 v68, s[12:15], s50 offen lds
    s_add_u32 m0, s48, 44032
    s_nop 0
    buffer_load_dwordx4 v69, s[12:15], s50 offen lds
    s_add_u32 m0, s48, 57344
    s_nop 0
    buffer_load_dwordx4 v66, s[56:59], s50 offen lds
    s_add_u32 m0, s48, 58368
    s_nop 0
    buffer_load_dwordx4 v67, s[56:59], s50 offen lds
    s_add_u32 m0, s48, 59392
    s_nop 0
    buffer_load_dwordx4 v68, s[56:59], s50 offen lds
    s_add_u32 m0, s48, 60416
    s_nop 0
    buffer_load_dwordx4 v69, s[56:59], s50 offen lds
    s_add_u32 m0, s49, 73728
    s_nop 0
    buffer_load_dwordx4 v70, s[52:55], s51 offen lds
    s_add_u32 m0, s49, 74752
    s_nop 0
    buffer_load_dwordx4 v71, s[52:55], s51 offen lds
    s_add_u32 s50, s46, 1048576
    s_add_u32 s51, s47, 1048576
    s_add_u32 m0, s48, 81920
    s_nop 0
    buffer_load_dwordx4 v66, s[12:15], s50 offen lds
    s_add_u32 m0, s48, 82944
    s_nop 0
    buffer_load_dwordx4 v67, s[12:15], s50 offen lds
    s_add_u32 m0, s48, 83968
    s_nop 0
    buffer_load_dwordx4 v68, s[12:15], s50 offen lds
    s_add_u32 m0, s48, 84992
    s_nop 0
    buffer_load_dwordx4 v69, s[12:15], s50 offen lds
    s_add_u32 m0, s48, 98304
    s_nop 0
    buffer_load_dwordx4 v66, s[56:59], s50 offen lds
    s_add_u32 m0, s48, 99328
    s_nop 0
    buffer_load_dwordx4 v67, s[56:59], s50 offen lds
    s_add_u32 m0, s48, 100352
    s_nop 0
    buffer_load_dwordx4 v68, s[56:59], s50 offen lds
    s_add_u32 m0, s48, 101376
    s_nop 0
    buffer_load_dwordx4 v69, s[56:59], s50 offen lds
    s_add_u32 m0, s49, 114688
    s_nop 0
    buffer_load_dwordx4 v70, s[52:55], s51 offen lds
    s_add_u32 m0, s49, 115712
    s_nop 0
    buffer_load_dwordx4 v71, s[52:55], s51 offen lds
    s_waitcnt vmcnt(20)
    s_barrier
    s_cmp_lg_u32 s4, 0
    s_cbranch_scc1 RD_42
    v_mov_b32 v40, 64
    v_mov_b32 v41, 1
    v_cmp_eq_u32 vcc, 0, v1
    s_and_saveexec_b64 s[62:63], vcc
    global_atomic_add v40, v41, s[60:61]
    s_mov_b64 exec, -1
RD_42:
    ds_read_b64_tr_b16 a[0:1], v82 offset:0
    ds_read_b64_tr_b16 a[2:3], v82 offset:1024
    ds_read_b64_tr_b16 a[4:5], v82 offset:8192
    ds_read_b64_tr_b16 a[6:7], v82 offset:9216
    ds_read_b64_tr_b16 a[80:81], v83 offset:0
    ds_read_b64_tr_b16 a[82:83], v83 offset:1024
    ds_read_b64_tr_b16 a[84:85], v83 offset:8192
    ds_read_b64_tr_b16 a[86:87], v83 offset:9216
    ds_read_b64_tr_b16 a[240:241], v90 offset:0
    ds_read_b64_tr_b16 a[242:243], v90 offset:1024
    ds_read_b64_tr_b16 a[244:245], v90 offset:8192
    ds_read_b64_tr_b16 a[246:247], v90 offset:9216
    ds_read_b64_tr_b16 v[176:177], v91 offset:0
    ds_read_b64_tr_b16 v[178:179], v91 offset:1024
    ds_read_b64_tr_b16 v[180:181], v91 offset:8192
    ds_read_b64_tr_b16 v[182:183], v91 offset:9216
    ds_read_b64_tr_b16 a[160:161], v84 offset:0
    ds_read_b64_tr_b16 a[162:163], v84 offset:512
    ds_read_b64_tr_b16 a[164:165], v84 offset:4096
    ds_read_b64_tr_b16 a[166:167], v84 offset:4608
    s_add_u32 s50, s46, 1572864
    s_add_u32 s51, s47, 1572864
    s_add_u32 m0, s48, 122880
    s_nop 0
    buffer_load_dwordx4 v66, s[12:15], s50 offen lds
    s_add_u32 m0, s48, 123904
    s_nop 0
    buffer_load_dwordx4 v67, s[12:15], s50 offen lds
    s_add_u32 m0, s48, 124928
    s_nop 0
    buffer_load_dwordx4 v68, s[12:15], s50 offen lds
    s_add_u32 m0, s48, 125952
    s_nop 0
    buffer_load_dwordx4 v69, s[12:15], s50 offen lds
    s_add_u32 m0, s48, 139264
    s_nop 0
    buffer_load_dwordx4 v66, s[56:59], s50 offen lds
    s_add_u32 m0, s48, 140288
    s_nop 0
    buffer_load_dwordx4 v67, s[56:59], s50 offen lds
    s_add_u32 m0, s48, 141312
    s_nop 0
    buffer_load_dwordx4 v68, s[56:59], s50 offen lds
    s_add_u32 m0, s48, 142336
    s_nop 0
    buffer_load_dwordx4 v69, s[56:59], s50 offen lds
    s_add_u32 m0, s49, 155648
    s_nop 0
    buffer_load_dwordx4 v70, s[52:55], s51 offen lds
    s_add_u32 m0, s49, 156672
    s_nop 0
    buffer_load_dwordx4 v71, s[52:55], s51 offen lds
    s_waitcnt lgkmcnt(0)
    v_add_u32 v82, 40960, v82
    v_add_u32 v83, 40960, v83
    v_add_u32 v84, 40960, v84
    v_add_u32 v90, 40960, v90
    v_add_u32 v91, 40960, v91
    s_waitcnt vmcnt(20)
    s_barrier
    ds_read_b64_tr_b16 a[8:9], v82 offset:0
    ds_read_b64_tr_b16 a[10:11], v82 offset:1024
    ds_read_b64_tr_b16 a[12:13], v82 offset:8192
    ds_read_b64_tr_b16 a[14:15], v82 offset:9216
    ds_read_b64_tr_b16 a[88:89], v83 offset:0
    ds_read_b64_tr_b16 a[90:91], v83 offset:1024
    ds_read_b64_tr_b16 a[92:93], v83 offset:8192
    ds_read_b64_tr_b16 a[94:95], v83 offset:9216
    ds_read_b64_tr_b16 a[248:249], v90 offset:0
    ds_read_b64_tr_b16 a[250:251], v90 offset:1024
    ds_read_b64_tr_b16 a[252:253], v90 offset:8192
    ds_read_b64_tr_b16 a[254:255], v90 offset:9216
    ds_read_b64_tr_b16 v[184:185], v91 offset:0
    ds_read_b64_tr_b16 v[186:187], v91 offset:1024
    ds_read_b64_tr_b16 v[188:189], v91 offset:8192
    ds_read_b64_tr_b16 v[190:191], v91 offset:9216
    ds_read_b64_tr_b16 a[168:169], v84 offset:0
    ds_read_b64_tr_b16 a[170:171], v84 offset:512
    ds_read_b64_tr_b16 a[172:173], v84 offset:4096
    ds_read_b64_tr_b16 a[174:175], v84 offset:4608
    s_add_u32 s50, s46, 2097152
    s_add_u32 s51, s47, 2097152
    s_add_u32 m0, s48, 0
    s_nop 0
    buffer_load_dwordx4 v66, s[12:15], s50 offen lds
    s_add_u32 m0, s48, 1024
    s_nop 0
    buffer_load_dwordx4 v67, s[12:15], s50 offen lds
    s_add_u32 m0, s48, 2048
    s_nop 0
    buffer_load_dwordx4 v68, s[12:15], s50 offen lds
    s_add_u32 m0, s48, 3072
    s_nop 0
    buffer_load_dwordx4 v69, s[12:15], s50 offen lds
    s_add_u32 m0, s48, 16384
    s_nop 0
    buffer_load_dwordx4 v66, s[56:59], s50 offen lds
    s_add_u32 m0, s48, 17408
    s_nop 0
    buffer_load_dwordx4 v67, s[56:59], s50 offen lds
    s_add_u32 m0, s48, 18432
    s_nop 0
    buffer_load_dwordx4 v68, s[56:59], s50 offen lds
    s_add_u32 m0, s48, 19456
    s_nop 0
    buffer_load_dwordx4 v69, s[56:59], s50 offen lds
    s_add_u32 m0, s49, 32768
    s_nop 0
    buffer_load_dwordx4 v70, s[52:55], s51 offen lds
    s_add_u32 m0, s49, 33792
    s_nop 0
    buffer_load_dwordx4 v71, s[52:55], s51 offen lds
    s_waitcnt lgkmcnt(0)
    v_add_u32 v82, 40960, v82
    v_add_u32 v83, 40960, v83
    v_add_u32 v84, 40960, v84
    v_add_u32 v90, 40960, v90
    v_add_u32 v91, 40960, v91
    s_waitcnt vmcnt(20)
    s_barrier
    ds_read_b64_tr_b16 a[16:17], v82 offset:0
    ds_read_b64_tr_b16 a[18:19], v82 offset:1024
    ds_read_b64_tr_b16 a[20:21], v82 offset:8192
    ds_read_b64_tr_b16 a[22:23], v82 offset:9216
    ds_read_b64_tr_b16 a[96:97], v83 offset:0
    ds_read_b64_tr_b16 a[98:99], v83 offset:1024
    ds_read_b64_tr_b16 a[100:101], v83 offset:8192
    ds_read_b64_tr_b16 a[102:103], v83 offset:9216
    ds_read_b64_tr_b16 v[112:113], v90 offset:0
    ds_read_b64_tr_b16 v[114:115], v90 offset:1024
    ds_read_b64_tr_b16 v[116:117], v90 offset:8192
    ds_read_b64_tr_b16 v[118:119], v90 offset:9216
    ds_read_b64_tr_b16 v[192:193], v91 offset:0
    ds_read_b64_tr_b16 v[194:195], v91 offset:1024
    ds_read_b64_tr_b16 v[196:197], v91 offset:8192
    ds_read_b64_tr_b16 v[198:199], v91 offset:9216
    ds_read_b64_tr_b16 a[176:177], v84 offset:0
    ds_read_b64_tr_b16 a[178:179], v84 offset:512
    ds_read_b64_tr_b16 a[180:181], v84 offset:4096
    ds_read_b64_tr_b16 a[182:183], v84 offset:4608
    s_add_u32 s50, s46, 2621440
    s_add_u32 s51, s47, 2621440
    s_add_u32 m0, s48, 40960
    s_nop 0
    buffer_load_dwordx4 v66, s[12:15], s50 offen lds
    s_add_u32 m0, s48, 41984
    s_nop 0
    buffer_load_dwordx4 v67, s[12:15], s50 offen lds
    s_add_u32 m0, s48, 43008
    s_nop 0
    buffer_load_dwordx4 v68, s[12:15], s50 offen lds
    s_add_u32 m0, s48, 44032
    s_nop 0
    buffer_load_dwordx4 v69, s[12:15], s50 offen lds
    s_add_u32 m0, s48, 57344
    s_nop 0
    buffer_load_dwordx4 v66, s[56:59], s50 offen lds
    s_add_u32 m0, s48, 58368
    s_nop 0
    buffer_load_dwordx4 v67, s[56:59], s50 offen lds
    s_add_u32 m0, s48, 59392
    s_nop 0
    buffer_load_dwordx4 v68, s[56:59], s50 offen lds
    s_add_u32 m0, s48, 60416
    s_nop 0
    buffer_load_dwordx4 v69, s[56:59], s50 offen lds
    s_add_u32 m0, s49, 73728
    s_nop 0
    buffer_load_dwordx4 v70, s[52:55], s51 offen lds
    s_add_u32 m0, s49, 74752
    s_nop 0
    buffer_load_dwordx4 v71, s[52:55], s51 offen lds
    s_waitcnt lgkmcnt(0)
    v_add_u32 v82, 40960, v82
    v_add_u32 v83, 40960, v83
    v_add_u32 v84, 40960, v84
    v_add_u32 v90, 40960, v90
    v_add_u32 v91, 40960, v91
    s_waitcnt vmcnt(20)
    s_barrier
    ds_read_b64_tr_b16 a[24:25], v82 offset:0
    ds_read_b64_tr_b16 a[26:27], v82 offset:1024
    ds_read_b64_tr_b16 a[28:29], v82 offset:8192
    ds_read_b64_tr_b16 a[30:31], v82 offset:9216
    ds_read_b64_tr_b16 a[104:105], v83 offset:0
    ds_read_b64_tr_b16 a[106:107], v83 offset:1024
    ds_read_b64_tr_b16 a[108:109], v83 offset:8192
    ds_read_b64_tr_b16 a[110:111], v83 offset:9216
    ds_read_b64_tr_b16 v[120:121], v90 offset:0
    ds_read_b64_tr_b16 v[122:123], v90 offset:1024
    ds_read_b64_tr_b16 v[124:125], v90 offset:8192
    ds_read_b64_tr_b16 v[126:127], v90 offset:9216
    ds_read_b64_tr_b16 v[200:201], v91 offset:0
    ds_read_b64_tr_b16 v[202:203], v91 offset:1024
    ds_read_b64_tr_b16 v[204:205], v91 offset:8192
    ds_read_b64_tr_b16 v[206:207], v91 offset:9216
    ds_read_b64_tr_b16 a[184:185], v84 offset:0
    ds_read_b64_tr_b16 a[186:187], v84 offset:512
    ds_read_b64_tr_b16 a[188:189], v84 offset:4096
    ds_read_b64_tr_b16 a[190:191], v84 offset:4608
    s_add_u32 s50, s46, 3145728
    s_add_u32 s51, s47, 3145728
    s_add_u32 m0, s48, 81920
    s_nop 0
    buffer_load_dwordx4 v66, s[12:15], s50 offen lds
    s_add_u32 m0, s48, 82944
    s_nop 0
    buffer_load_dwordx4 v67, s[12:15], s50 offen lds
    s_add_u32 m0, s48, 83968
    s_nop 0
    buffer_load_dwordx4 v68, s[12:15], s50 offen lds
    s_add_u32 m0, s48, 84992
    s_nop 0
    buffer_load_dwordx4 v69, s[12:15], s50 offen lds
    s_add_u32 m0, s48, 98304
    s_nop 0
    buffer_load_dwordx4 v66, s[56:59], s50 offen lds
    s_add_u32 m0, s48, 99328
    s_nop 0
    buffer_load_dwordx4 v67, s[56:59], s50 offen lds
    s_add_u32 m0, s48, 100352
    s_nop 0
    buffer_load_dwordx4 v68, s[56:59], s50 offen lds
    s_add_u32 m0, s48, 101376
    s_nop 0
    buffer_load_dwordx4 v69, s[56:59], s50 offen lds
    s_add_u32 m0, s49, 114688
    s_nop 0
    buffer_load_dwordx4 v70, s[52:55], s51 offen lds
    s_add_u32 m0, s49, 115712
    s_nop 0
    buffer_load_dwordx4 v71, s[52:55], s51 offen lds
    s_waitcnt lgkmcnt(0)
    v_add_u32 v82, 4294844416, v82
    v_add_u32 v83, 4294844416, v83
    v_add_u32 v84, 4294844416, v84
    v_add_u32 v90, 4294844416, v90
    v_add_u32 v91, 4294844416, v91
    s_waitcnt vmcnt(20)
    s_barrier
    ds_read_b64_tr_b16 a[32:33], v82 offset:0
    ds_read_b64_tr_b16 a[34:35], v82 offset:1024
    ds_read_b64_tr_b16 a[36:37], v82 offset:8192
    ds_read_b64_tr_b16 a[38:39], v82 offset:9216
    ds_read_b64_tr_b16 a[112:113], v83 offset:0
    ds_read_b64_tr_b16 a[114:115], v83 offset:1024
    ds_read_b64_tr_b16 a[116:117], v83 offset:8192
    ds_read_b64_tr_b16 a[118:119], v83 offset:9216
    ds_read_b64_tr_b16 v[128:129], v90 offset:0
    ds_read_b64_tr_b16 v[130:131], v90 offset:1024
    ds_read_b64_tr_b16 v[132:133], v90 offset:8192
    ds_read_b64_tr_b16 v[134:135], v90 offset:9216
    ds_read_b64_tr_b16 v[208:209], v91 offset:0
    ds_read_b64_tr_b16 v[210:211], v91 offset:1024
    ds_read_b64_tr_b16 v[212:213], v91 offset:8192
    ds_read_b64_tr_b16 v[214:215], v91 offset:9216
    ds_read_b64_tr_b16 a[192:193], v84 offset:0
    ds_read_b64_tr_b16 a[194:195], v84 offset:512
    ds_read_b64_tr_b16 a[196:197], v84 offset:4096
    ds_read_b64_tr_b16 a[198:199], v84 offset:4608
    s_add_u32 s50, s46, 3670016
    s_add_u32 s51, s47, 3670016
    s_add_u32 m0, s48, 122880
    s_nop 0
    buffer_load_dwordx4 v66, s[12:15], s50 offen lds
    s_add_u32 m0, s48, 123904
    s_nop 0
    buffer_load_dwordx4 v67, s[12:15], s50 offen lds
    s_add_u32 m0, s48, 124928
    s_nop 0
    buffer_load_dwordx4 v68, s[12:15], s50 offen lds
    s_add_u32 m0, s48, 125952
    s_nop 0
    buffer_load_dwordx4 v69, s[12:15], s50 offen lds
    s_add_u32 m0, s48, 139264
    s_nop 0
    buffer_load_dwordx4 v66, s[56:59], s50 offen lds
    s_add_u32 m0, s48, 140288
    s_nop 0
    buffer_load_dwordx4 v67, s[56:59], s50 offen lds
    s_add_u32 m0, s48, 141312
    s_nop 0
    buffer_load_dwordx4 v68, s[56:59], s50 offen lds
    s_add_u32 m0, s48, 142336
    s_nop 0
    buffer_load_dwordx4 v69, s[56:59], s50 offen lds
    s_add_u32 m0, s49, 155648
    s_nop 0
    buffer_load_dwordx4 v70, s[52:55], s51 offen lds
    s_add_u32 m0, s49, 156672
    s_nop 0
    buffer_load_dwordx4 v71, s[52:55], s51 offen lds
    s_waitcnt lgkmcnt(0)
    v_add_u32 v82, 40960, v82
    v_add_u32 v83, 40960, v83
    v_add_u32 v84, 40960, v84
    v_add_u32 v90, 40960, v90
    v_add_u32 v91, 40960, v91
    s_waitcnt vmcnt(20)
    s_barrier
    ds_read_b64_tr_b16 a[40:41], v82 offset:0
    ds_read_b64_tr_b16 a[42:43], v82 offset:1024
    ds_read_b64_tr_b16 a[44:45], v82 offset:8192
    ds_read_b64_tr_b16 a[46:47], v82 offset:9216
    ds_read_b64_tr_b16 a[120:121], v83 offset:0
    ds_read_b64_tr_b16 a[122:123], v83 offset:1024
    ds_read_b64_tr_b16 a[124:125], v83 offset:8192
    ds_read_b64_tr_b16 a[126:127], v83 offset:9216
    ds_read_b64_tr_b16 v[136:137], v90 offset:0
    ds_read_b64_tr_b16 v[138:139], v90 offset:1024
    ds_read_b64_tr_b16 v[140:141], v90 offset:8192
    ds_read_b64_tr_b16 v[142:143], v90 offset:9216
    ds_read_b64_tr_b16 v[216:217], v91 offset:0
    ds_read_b64_tr_b16 v[218:219], v91 offset:1024
    ds_read_b64_tr_b16 v[220:221], v91 offset:8192
    ds_read_b64_tr_b16 v[222:223], v91 offset:9216
    ds_read_b64_tr_b16 a[200:201], v84 offset:0
    ds_read_b64_tr_b16 a[202:203], v84 offset:512
    ds_read_b64_tr_b16 a[204:205], v84 offset:4096
    ds_read_b64_tr_b16 a[206:207], v84 offset:4608
    s_add_u32 s50, s46, 4194304
    s_add_u32 s51, s47, 4194304
    s_add_u32 m0, s48, 0
    s_nop 0
    buffer_load_dwordx4 v66, s[12:15], s50 offen lds
    s_add_u32 m0, s48, 1024
    s_nop 0
    buffer_load_dwordx4 v67, s[12:15], s50 offen lds
    s_add_u32 m0, s48, 2048
    s_nop 0
    buffer_load_dwordx4 v68, s[12:15], s50 offen lds
    s_add_u32 m0, s48, 3072
    s_nop 0
    buffer_load_dwordx4 v69, s[12:15], s50 offen lds
    s_add_u32 m0, s48, 16384
    s_nop 0
    buffer_load_dwordx4 v66, s[56:59], s50 offen lds
    s_add_u32 m0, s48, 17408
    s_nop 0
    buffer_load_dwordx4 v67, s[56:59], s50 offen lds
    s_add_u32 m0, s48, 18432
    s_nop 0
    buffer_load_dwordx4 v68, s[56:59], s50 offen lds
    s_add_u32 m0, s48, 19456
    s_nop 0
    buffer_load_dwordx4 v69, s[56:59], s50 offen lds
    s_add_u32 m0, s49, 32768
    s_nop 0
    buffer_load_dwordx4 v70, s[52:55], s51 offen lds
    s_add_u32 m0, s49, 33792
    s_nop 0
    buffer_load_dwordx4 v71, s[52:55], s51 offen lds
    s_waitcnt lgkmcnt(0)
    v_add_u32 v82, 40960, v82
    v_add_u32 v83, 40960, v83
    v_add_u32 v84, 40960, v84
    v_add_u32 v90, 40960, v90
    v_add_u32 v91, 40960, v91
    s_waitcnt vmcnt(20)
    s_barrier
    ds_read_b64_tr_b16 a[48:49], v82 offset:0
    ds_read_b64_tr_b16 a[50:51], v82 offset:1024
    ds_read_b64_tr_b16 a[52:53], v82 offset:8192
    ds_read_b64_tr_b16 a[54:55], v82 offset:9216
    ds_read_b64_tr_b16 a[128:129], v83 offset:0
    ds_read_b64_tr_b16 a[130:131], v83 offset:1024
    ds_read_b64_tr_b16 a[132:133], v83 offset:8192
    ds_read_b64_tr_b16 a[134:135], v83 offset:9216
    ds_read_b64_tr_b16 v[144:145], v90 offset:0
    ds_read_b64_tr_b16 v[146:147], v90 offset:1024
    ds_read_b64_tr_b16 v[148:149], v90 offset:8192
    ds_read_b64_tr_b16 v[150:151], v90 offset:9216
    ds_read_b64_tr_b16 v[224:225], v91 offset:0
    ds_read_b64_tr_b16 v[226:227], v91 offset:1024
    ds_read_b64_tr_b16 v[228:229], v91 offset:8192
    ds_read_b64_tr_b16 v[230:231], v91 offset:9216
    ds_read_b64_tr_b16 a[208:209], v84 offset:0
    ds_read_b64_tr_b16 a[210:211], v84 offset:512
    ds_read_b64_tr_b16 a[212:213], v84 offset:4096
    ds_read_b64_tr_b16 a[214:215], v84 offset:4608
    s_add_u32 s50, s46, 4718592
    s_add_u32 s51, s47, 4718592
    s_add_u32 m0, s48, 40960
    s_nop 0
    buffer_load_dwordx4 v66, s[12:15], s50 offen lds
    s_add_u32 m0, s48, 41984
    s_nop 0
    buffer_load_dwordx4 v67, s[12:15], s50 offen lds
    s_add_u32 m0, s48, 43008
    s_nop 0
    buffer_load_dwordx4 v68, s[12:15], s50 offen lds
    s_add_u32 m0, s48, 44032
    s_nop 0
    buffer_load_dwordx4 v69, s[12:15], s50 offen lds
    s_add_u32 m0, s48, 57344
    s_nop 0
    buffer_load_dwordx4 v66, s[56:59], s50 offen lds
    s_add_u32 m0, s48, 58368
    s_nop 0
    buffer_load_dwordx4 v67, s[56:59], s50 offen lds
    s_add_u32 m0, s48, 59392
    s_nop 0
    buffer_load_dwordx4 v68, s[56:59], s50 offen lds
    s_add_u32 m0, s48, 60416
    s_nop 0
    buffer_load_dwordx4 v69, s[56:59], s50 offen lds
    s_add_u32 m0, s49, 73728
    s_nop 0
    buffer_load_dwordx4 v70, s[52:55], s51 offen lds
    s_add_u32 m0, s49, 74752
    s_nop 0
    buffer_load_dwordx4 v71, s[52:55], s51 offen lds
    s_mul_i32 s80, s7, 163840
    s_mul_i32 s81, s3, 640
    s_add_u32 s80, s80, s81
    buffer_load_dwordx4 v[44:47], v72, s[76:79], s80 offen
    buffer_load_dwordx4 v[44:47], v73, s[76:79], s80 offen
    buffer_load_dwordx4 v[44:47], v74, s[76:79], s80 offen
    buffer_load_dwordx4 v[44:47], v75, s[76:79], s80 offen
    buffer_load_dwordx4 v[44:47], v76, s[76:79], s80 offen
    buffer_load_dwordx4 v[44:47], v77, s[76:79], s80 offen
    buffer_load_dwordx4 v[44:47], v78, s[76:79], s80 offen
    buffer_load_dwordx4 v[44:47], v79, s[76:79], s80 offen
    buffer_load_dwordx4 v[44:47], v80, s[76:79], s80 offen
    buffer_load_dwordx4 v[44:47], v81, s[76:79], s80 offen
    s_add_u32 s80, s80, 81920
    buffer_load_dwordx4 v[44:47], v72, s[76:79], s80 offen
    buffer_load_dwordx4 v[44:47], v73, s[76:79], s80 offen
    buffer_load_dwordx4 v[44:47], v74, s[76:79], s80 offen
    buffer_load_dwordx4 v[44:47], v75, s[76:79], s80 offen
    buffer_load_dwordx4 v[44:47], v76, s[76:79], s80 offen
    buffer_load_dwordx4 v[44:47], v77, s[76:79], s80 offen
    buffer_load_dwordx4 v[44:47], v78, s[76:79], s80 offen
    buffer_load_dwordx4 v[44:47], v79, s[76:79], s80 offen
    buffer_load_dwordx4 v[44:47], v80, s[76:79], s80 offen
    buffer_load_dwordx4 v[44:47], v81, s[76:79], s80 offen
    s_add_u32 s80, s80, 81920
    s_waitcnt lgkmcnt(0)
    v_add_u32 v82, 40960, v82
    v_add_u32 v83, 40960, v83
    v_add_u32 v84, 40960, v84
    v_add_u32 v90, 40960, v90
    v_add_u32 v91, 40960, v91
    s_waitcnt vmcnt(40)
    s_barrier
    ds_read_b64_tr_b16 a[56:57], v82 offset:0
    ds_read_b64_tr_b16 a[58:59], v82 offset:1024
    ds_read_b64_tr_b16 a[60:61], v82 offset:8192
    ds_read_b64_tr_b16 a[62:63], v82 offset:9216
    ds_read_b64_tr_b16 a[136:137], v83 offset:0
    ds_read_b64_tr_b16 a[138:139], v83 offset:1024
    ds_read_b64_tr_b16 a[140:141], v83 offset:8192
    ds_read_b64_tr_b16 a[142:143], v83 offset:9216
    ds_read_b64_tr_b16 v[152:153], v90 offset:0
    ds_read_b64_tr_b16 v[154:155], v90 offset:1024
    ds_read_b64_tr_b16 v[156:157], v90 offset:8192
    ds_read_b64_tr_b16 v[158:159], v90 offset:9216
    ds_read_b64_tr_b16 v[232:233], v91 offset:0
    ds_read_b64_tr_b16 v[234:235], v91 offset:1024
    ds_read_b64_tr_b16 v[236:237], v91 offset:8192
    ds_read_b64_tr_b16 v[238:239], v91 offset:9216
    ds_read_b64_tr_b16 a[216:217], v84 offset:0
    ds_read_b64_tr_b16 a[218:219], v84 offset:512
    ds_read_b64_tr_b16 a[220:221], v84 offset:4096
    ds_read_b64_tr_b16 a[222:223], v84 offset:4608
    s_waitcnt lgkmcnt(0)
    v_add_u32 v82, 4294844416, v82
    v_add_u32 v83, 4294844416, v83
    v_add_u32 v84, 4294844416, v84
    v_add_u32 v90, 4294844416, v90
    v_add_u32 v91, 4294844416, v91
    s_waitcnt vmcnt(30)
    s_barrier
    ds_read_b64_tr_b16 a[64:65], v82 offset:0
    ds_read_b64_tr_b16 a[66:67], v82 offset:1024
    ds_read_b64_tr_b16 a[68:69], v82 offset:8192
    ds_read_b64_tr_b16 a[70:71], v82 offset:9216
    ds_read_b64_tr_b16 a[144:145], v83 offset:0
    ds_read_b64_tr_b16 a[146:147], v83 offset:1024
    ds_read_b64_tr_b16 a[148:149], v83 offset:8192
    ds_read_b64_tr_b16 a[150:151], v83 offset:9216
    ds_read_b64_tr_b16 v[160:161], v90 offset:0
    ds_read_b64_tr_b16 v[162:163], v90 offset:1024
    ds_read_b64_tr_b16 v[164:165], v90 offset:8192
    ds_read_b64_tr_b16 v[166:167], v90 offset:9216
    ds_read_b64_tr_b16 v[240:241], v91 offset:0
    ds_read_b64_tr_b16 v[242:243], v91 offset:1024
    ds_read_b64_tr_b16 v[244:245], v91 offset:8192
    ds_read_b64_tr_b16 v[246:247], v91 offset:9216
    ds_read_b64_tr_b16 a[224:225], v84 offset:0
    ds_read_b64_tr_b16 a[226:227], v84 offset:512
    ds_read_b64_tr_b16 a[228:229], v84 offset:4096
    ds_read_b64_tr_b16 a[230:231], v84 offset:4608
    s_waitcnt lgkmcnt(0)
    v_add_u32 v82, 40960, v82
    v_add_u32 v83, 40960, v83
    v_add_u32 v84, 40960, v84
    v_add_u32 v90, 40960, v90
    v_add_u32 v91, 40960, v91
    s_waitcnt vmcnt(20)
    s_barrier
    ds_read_b64_tr_b16 a[72:73], v82 offset:0
    ds_read_b64_tr_b16 a[74:75], v82 offset:1024
    ds_read_b64_tr_b16 a[76:77], v82 offset:8192
    ds_read_b64_tr_b16 a[78:79], v82 offset:9216
    ds_read_b64_tr_b16 a[152:153], v83 offset:0
    ds_read_b64_tr_b16 a[154:155], v83 offset:1024
    ds_read_b64_tr_b16 a[156:157], v83 offset:8192
    ds_read_b64_tr_b16 a[158:159], v83 offset:9216
    ds_read_b64_tr_b16 v[168:169], v90 offset:0
    ds_read_b64_tr_b16 v[170:171], v90 offset:1024
    ds_read_b64_tr_b16 v[172:173], v90 offset:8192
    ds_read_b64_tr_b16 v[174:175], v90 offset:9216
    ds_read_b64_tr_b16 v[248:249], v91 offset:0
    ds_read_b64_tr_b16 v[250:251], v91 offset:1024
    ds_read_b64_tr_b16 v[252:253], v91 offset:8192
    ds_read_b64_tr_b16 v[254:255], v91 offset:9216
    ds_read_b64_tr_b16 a[232:233], v84 offset:0
    ds_read_b64_tr_b16 a[234:235], v84 offset:512
    ds_read_b64_tr_b16 a[236:237], v84 offset:4096
    ds_read_b64_tr_b16 a[238:239], v84 offset:4608
    s_waitcnt lgkmcnt(0)
    v_add_u32 v82, 40960, v82
    v_add_u32 v83, 40960, v83
    v_add_u32 v84, 40960, v84
    v_add_u32 v90, 40960, v90
    v_add_u32 v91, 40960, v91
    s_branch QL_41_2
QL_41_1:
    s_add_u32 s50, s46, 1572864
    s_add_u32 s51, s47, 1572864
    s_add_u32 m0, s48, 0
    s_nop 0
    buffer_load_dwordx4 v66, s[12:15], s50 offen lds
    s_add_u32 m0, s48, 1024
    s_nop 0
    buffer_load_dwordx4 v67, s[12:15], s50 offen lds
    s_add_u32 m0, s48, 2048
    s_nop 0
    buffer_load_dwordx4 v68, s[12:15], s50 offen lds
    s_add_u32 m0, s48, 3072
    s_nop 0
    buffer_load_dwordx4 v69, s[12:15], s50 offen lds
    s_add_u32 m0, s48, 16384
    s_nop 0
    buffer_load_dwordx4 v66, s[56:59], s50 offen lds
    s_add_u32 m0, s48, 17408
    s_nop 0
    buffer_load_dwordx4 v67, s[56:59], s50 offen lds
    s_add_u32 m0, s48, 18432
    s_nop 0
    buffer_load_dwordx4 v68, s[56:59], s50 offen lds
    s_add_u32 m0, s48, 19456
    s_nop 0
    buffer_load_dwordx4 v69, s[56:59], s50 offen lds
    s_add_u32 m0, s49, 32768
    s_nop 0
    buffer_load_dwordx4 v70, s[52:55], s51 offen lds
    s_add_u32 m0, s49, 33792
    s_nop 0
    buffer_load_dwordx4 v71, s[52:55], s51 offen lds
    s_add_u32 s50, s46, 2097152
    s_add_u32 s51, s47, 2097152
    s_add_u32 m0, s48, 40960
    s_nop 0
    buffer_load_dwordx4 v66, s[12:15], s50 offen lds
    s_add_u32 m0, s48, 41984
    s_nop 0
    buffer_load_dwordx4 v67, s[12:15], s50 offen lds
    s_add_u32 m0, s48, 43008
    s_nop 0
    buffer_load_dwordx4 v68, s[12:15], s50 offen lds
    s_add_u32 m0, s48, 44032
    s_nop 0
    buffer_load_dwordx4 v69, s[12:15], s50 offen lds
    s_add_u32 m0, s48, 57344
    s_nop 0
    buffer_load_dwordx4 v66, s[56:59], s50 offen lds
    s_add_u32 m0, s48, 58368
    s_nop 0
    buffer_load_dwordx4 v67, s[56:59], s50 offen lds
    s_add_u32 m0, s48, 59392
    s_nop 0
    buffer_load_dwordx4 v68, s[56:59], s50 offen lds
    s_add_u32 m0, s48, 60416
    s_nop 0
    buffer_load_dwordx4 v69, s[56:59], s50 offen lds
    s_add_u32 m0, s49, 73728
    s_nop 0
    buffer_load_dwordx4 v70, s[52:55], s51 offen lds
    s_add_u32 m0, s49, 74752
    s_nop 0
    buffer_load_dwordx4 v71, s[52:55], s51 offen lds
    s_add_u32 s50, s46, 2621440
    s_add_u32 s51, s47, 2621440
    s_add_u32 m0, s48, 81920
    s_nop 0
    buffer_load_dwordx4 v66, s[12:15], s50 offen lds
    s_add_u32 m0, s48, 82944
    s_nop 0
    buffer_load_dwordx4 v67, s[12:15], s50 offen lds
    s_add_u32 m0, s48, 83968
    s_nop 0
    buffer_load_dwordx4 v68, s[12:15], s50 offen lds
    s_add_u32 m0, s48, 84992
    s_nop 0
    buffer_load_dwordx4 v69, s[12:15], s50 offen lds
    s_add_u32 m0, s48, 98304
    s_nop 0
    buffer_load_dwordx4 v66, s[56:59], s50 offen lds
    s_add_u32 m0, s48, 99328
    s_nop 0
    buffer_load_dwordx4 v67, s[56:59], s50 offen lds
    s_add_u32 m0, s48, 100352
    s_nop 0
    buffer_load_dwordx4 v68, s[56:59], s50 offen lds
    s_add_u32 m0, s48, 101376
    s_nop 0
    buffer_load_dwordx4 v69, s[56:59], s50 offen lds
    s_add_u32 m0, s49, 114688
    s_nop 0
    buffer_load_dwordx4 v70, s[52:55], s51 offen lds
    s_add_u32 m0, s49, 115712
    s_nop 0
    buffer_load_dwordx4 v71, s[52:55], s51 offen lds
    s_waitcnt vmcnt(20)
    s_barrier
    s_cmp_lg_u32 s4, 0
    s_cbranch_scc1 RD_43
    v_mov_b32 v40, 64
    v_mov_b32 v41, 1
    v_cmp_eq_u32 vcc, 0, v1
    s_and_saveexec_b64 s[62:63], vcc
    global_atomic_add v40, v41, s[60:61]
    s_mov_b64 exec, -1
RD_43:
    ds_read_b64_tr_b16 a[24:25], v82 offset:0
    ds_read_b64_tr_b16 a[26:27], v82 offset:1024
    ds_read_b64_tr_b16 a[28:29], v82 offset:8192
    ds_read_b64_tr_b16 a[30:31], v82 offset:9216
    ds_read_b64_tr_b16 a[104:105], v83 offset:0
    ds_read_b64_tr_b16 a[106:107], v83 offset:1024
    ds_read_b64_tr_b16 a[108:109], v83 offset:8192
    ds_read_b64_tr_b16 a[110:111], v83 offset:9216
    ds_read_b64_tr_b16 v[120:121], v90 offset:0
    ds_read_b64_tr_b16 v[122:123], v90 offset:1024
    ds_read_b64_tr_b16 v[124:125], v90 offset:8192
    ds_read_b64_tr_b16 v[126:127], v90 offset:9216
    ds_read_b64_tr_b16 v[200:201], v91 offset:0
    ds_read_b64_tr_b16 v[202:203], v91 offset:1024
    ds_read_b64_tr_b16 v[204:205], v91 offset:8192
    ds_read_b64_tr_b16 v[206:207], v91 offset:9216
    ds_read_b64_tr_b16 a[184:185], v84 offset:0
    ds_read_b64_tr_b16 a[186:187], v84 offset:512
    ds_read_b64_tr_b16 a[188:189], v84 offset:4096
    ds_read_b64_tr_b16 a[190:191], v84 offset:4608
    s_add_u32 s50, s46, 0
    s_add_u32 s51, s47, 0
    s_add_u32 m0, s48, 122880
    s_nop 0
    buffer_load_dwordx4 v66, s[12:15], s50 offen lds
    s_add_u32 m0, s48, 123904
    s_nop 0
    buffer_load_dwordx4 v67, s[12:15], s50 offen lds
    s_add_u32 m0, s48, 124928
    s_nop 0
    buffer_load_dwordx4 v68, s[12:15], s50 offen lds
    s_add_u32 m0, s48, 125952
    s_nop 0
    buffer_load_dwordx4 v69, s[12:15], s50 offen lds
    s_add_u32 m0, s48, 139264
    s_nop 0
    buffer_load_dwordx4 v66, s[56:59], s50 offen lds
    s_add_u32 m0, s48, 140288
    s_nop 0
    buffer_load_dwordx4 v67, s[56:59], s50 offen lds
    s_add_u32 m0, s48, 141312
    s_nop 0
    buffer_load_dwordx4 v68, s[56:59], s50 offen lds
    s_add_u32 m0, s48, 142336
    s_nop 0
    buffer_load_dwordx4 v69, s[56:59], s50 offen lds
    s_add_u32 m0, s49, 155648
    s_nop 0
    buffer_load_dwordx4 v70, s[52:55], s51 offen lds
    s_add_u32 m0, s49, 156672
    s_nop 0
    buffer_load_dwordx4 v71, s[52:55], s51 offen lds
    s_waitcnt lgkmcnt(0)
    v_add_u32 v82, 40960, v82
    v_add_u32 v83, 40960, v83
    v_add_u32 v84, 40960, v84
    v_add_u32 v90, 40960, v90
    v_add_u32 v91, 40960, v91
    s_waitcnt vmcnt(20)
    s_barrier
    ds_read_b64_tr_b16 a[32:33], v82 offset:0
    ds_read_b64_tr_b16 a[34:35], v82 offset:1024
    ds_read_b64_tr_b16 a[36:37], v82 offset:8192
    ds_read_b64_tr_b16 a[38:39], v82 offset:9216
    ds_read_b64_tr_b16 a[112:113], v83 offset:0
    ds_read_b64_tr_b16 a[114:115], v83 offset:1024
    ds_read_b64_tr_b16 a[116:117], v83 offset:8192
    ds_read_b64_tr_b16 a[118:119], v83 offset:9216
    ds_read_b64_tr_b16 v[128:129], v90 offset:0
    ds_read_b64_tr_b16 v[130:131], v90 offset:1024
    ds_read_b64_tr_b16 v[132:133], v90 offset:8192
    ds_read_b64_tr_b16 v[134:135], v90 offset:9216
    ds_read_b64_tr_b16 v[208:209], v91 offset:0
    ds_read_b64_tr_b16 v[210:211], v91 offset:1024
    ds_read_b64_tr_b16 v[212:213], v91 offset:8192
    ds_read_b64_tr_b16 v[214:215], v91 offset:9216
    ds_read_b64_tr_b16 a[192:193], v84 offset:0
    ds_read_b64_tr_b16 a[194:195], v84 offset:512
    ds_read_b64_tr_b16 a[196:197], v84 offset:4096
    ds_read_b64_tr_b16 a[198:199], v84 offset:4608
    s_add_u32 s50, s46, 524288
    s_add_u32 s51, s47, 524288
    s_add_u32 m0, s48, 0
    s_nop 0
    buffer_load_dwordx4 v66, s[12:15], s50 offen lds
    s_add_u32 m0, s48, 1024
    s_nop 0
    buffer_load_dwordx4 v67, s[12:15], s50 offen lds
    s_add_u32 m0, s48, 2048
    s_nop 0
    buffer_load_dwordx4 v68, s[12:15], s50 offen lds
    s_add_u32 m0, s48, 3072
    s_nop 0
    buffer_load_dwordx4 v69, s[12:15], s50 offen lds
    s_add_u32 m0, s48, 16384
    s_nop 0
    buffer_load_dwordx4 v66, s[56:59], s50 offen lds
    s_add_u32 m0, s48, 17408
    s_nop 0
    buffer_load_dwordx4 v67, s[56:59], s50 offen lds
    s_add_u32 m0, s48, 18432
    s_nop 0
    buffer_load_dwordx4 v68, s[56:59], s50 offen lds
    s_add_u32 m0, s48, 19456
    s_nop 0
    buffer_load_dwordx4 v69, s[56:59], s50 offen lds
    s_add_u32 m0, s49, 32768
    s_nop 0
    buffer_load_dwordx4 v70, s[52:55], s51 offen lds
    s_add_u32 m0, s49, 33792
    s_nop 0
    buffer_load_dwordx4 v71, s[52:55], s51 offen lds
    s_waitcnt lgkmcnt(0)
    v_add_u32 v82, 40960, v82
    v_add_u32 v83, 40960, v83
    v_add_u32 v84, 40960, v84
    v_add_u32 v90, 40960, v90
    v_add_u32 v91, 40960, v91
    s_waitcnt vmcnt(20)
    s_barrier
    ds_read_b64_tr_b16 a[40:41], v82 offset:0
    ds_read_b64_tr_b16 a[42:43], v82 offset:1024
    ds_read_b64_tr_b16 a[44:45], v82 offset:8192
    ds_read_b64_tr_b16 a[46:47], v82 offset:9216
    ds_read_b64_tr_b16 a[120:121], v83 offset:0
    ds_read_b64_tr_b16 a[122:123], v83 offset:1024
    ds_read_b64_tr_b16 a[124:125], v83 offset:8192
    ds_read_b64_tr_b16 a[126:127], v83 offset:9216
    ds_read_b64_tr_b16 v[136:137], v90 offset:0
    ds_read_b64_tr_b16 v[138:139], v90 offset:1024
    ds_read_b64_tr_b16 v[140:141], v90 offset:8192
    ds_read_b64_tr_b16 v[142:143], v90 offset:9216
    ds_read_b64_tr_b16 v[216:217], v91 offset:0
    ds_read_b64_tr_b16 v[218:219], v91 offset:1024
    ds_read_b64_tr_b16 v[220:221], v91 offset:8192
    ds_read_b64_tr_b16 v[222:223], v91 offset:9216
    ds_read_b64_tr_b16 a[200:201], v84 offset:0
    ds_read_b64_tr_b16 a[202:203], v84 offset:512
    ds_read_b64_tr_b16 a[204:205], v84 offset:4096
    ds_read_b64_tr_b16 a[206:207], v84 offset:4608
    s_add_u32 s50, s46, 1048576
    s_add_u32 s51, s47, 1048576
    s_add_u32 m0, s48, 40960
    s_nop 0
    buffer_load_dwordx4 v66, s[12:15], s50 offen lds
    s_add_u32 m0, s48, 41984
    s_nop 0
    buffer_load_dwordx4 v67, s[12:15], s50 offen lds
    s_add_u32 m0, s48, 43008
    s_nop 0
    buffer_load_dwordx4 v68, s[12:15], s50 offen lds
    s_add_u32 m0, s48, 44032
    s_nop 0
    buffer_load_dwordx4 v69, s[12:15], s50 offen lds
    s_add_u32 m0, s48, 57344
    s_nop 0
    buffer_load_dwordx4 v66, s[56:59], s50 offen lds
    s_add_u32 m0, s48, 58368
    s_nop 0
    buffer_load_dwordx4 v67, s[56:59], s50 offen lds
    s_add_u32 m0, s48, 59392
    s_nop 0
    buffer_load_dwordx4 v68, s[56:59], s50 offen lds
    s_add_u32 m0, s48, 60416
    s_nop 0
    buffer_load_dwordx4 v69, s[56:59], s50 offen lds
    s_add_u32 m0, s49, 73728
    s_nop 0
    buffer_load_dwordx4 v70, s[52:55], s51 offen lds
    s_add_u32 m0, s49, 74752
    s_nop 0
    buffer_load_dwordx4 v71, s[52:55], s51 offen lds
    s_waitcnt lgkmcnt(0)
    v_add_u32 v82, 40960, v82
    v_add_u32 v83, 40960, v83
    v_add_u32 v84, 40960, v84
    v_add_u32 v90, 40960, v90
    v_add_u32 v91, 40960, v91
    s_waitcnt vmcnt(20)
    s_barrier
    ds_read_b64_tr_b16 a[0:1], v82 offset:0
    ds_read_b64_tr_b16 a[2:3], v82 offset:1024
    ds_read_b64_tr_b16 a[4:5], v82 offset:8192
    ds_read_b64_tr_b16 a[6:7], v82 offset:9216
    ds_read_b64_tr_b16 a[80:81], v83 offset:0
    ds_read_b64_tr_b16 a[82:83], v83 offset:1024
    ds_read_b64_tr_b16 a[84:85], v83 offset:8192
    ds_read_b64_tr_b16 a[86:87], v83 offset:9216
    ds_read_b64_tr_b16 a[240:241], v90 offset:0
    ds_read_b64_tr_b16 a[242:243], v90 offset:1024
    ds_read_b64_tr_b16 a[244:245], v90 offset:8192
    ds_read_b64_tr_b16 a[246:247], v90 offset:9216
    ds_read_b64_tr_b16 v[176:177], v91 offset:0
    ds_read_b64_tr_b16 v[178:179], v91 offset:1024
    ds_read_b64_tr_b16 v[180:181], v91 offset:8192
    ds_read_b64_tr_b16 v[182:183], v91 offset:9216
    ds_read_b64_tr_b16 a[160:161], v84 offset:0
    ds_read_b64_tr_b16 a[162:163], v84 offset:512
    ds_read_b64_tr_b16 a[164:165], v84 offset:4096
    ds_read_b64_tr_b16 a[166:167], v84 offset:4608
    s_add_u32 s50, s46, 4718592
    s_add_u32 s51, s47, 4718592
    s_add_u32 m0, s48, 81920
    s_nop 0
    buffer_load_dwordx4 v66, s[12:15], s50 offen lds
    s_add_u32 m0, s48, 82944
    s_nop 0
    buffer_load_dwordx4 v67, s[12:15], s50 offen lds
    s_add_u32 m0, s48, 83968
    s_nop 0
    buffer_load_dwordx4 v68, s[12:15], s50 offen lds
    s_add_u32 m0, s48, 84992
    s_nop 0
    buffer_load_dwordx4 v69, s[12:15], s50 offen lds
    s_add_u32 m0, s48, 98304
    s_nop 0
    buffer_load_dwordx4 v66, s[56:59], s50 offen lds
    s_add_u32 m0, s48, 99328
    s_nop 0
    buffer_load_dwordx4 v67, s[56:59], s50 offen lds
    s_add_u32 m0, s48, 100352
    s_nop 0
    buffer_load_dwordx4 v68, s[56:59], s50 offen lds
    s_add_u32 m0, s48, 101376
    s_nop 0
    buffer_load_dwordx4 v69, s[56:59], s50 offen lds
    s_add_u32 m0, s49, 114688
    s_nop 0
    buffer_load_dwordx4 v70, s[52:55], s51 offen lds
    s_add_u32 m0, s49, 115712
    s_nop 0
    buffer_load_dwordx4 v71, s[52:55], s51 offen lds
    s_waitcnt lgkmcnt(0)
    v_add_u32 v82, 4294844416, v82
    v_add_u32 v83, 4294844416, v83
    v_add_u32 v84, 4294844416, v84
    v_add_u32 v90, 4294844416, v90
    v_add_u32 v91, 4294844416, v91
    s_waitcnt vmcnt(20)
    s_barrier
    ds_read_b64_tr_b16 a[8:9], v82 offset:0
    ds_read_b64_tr_b16 a[10:11], v82 offset:1024
    ds_read_b64_tr_b16 a[12:13], v82 offset:8192
    ds_read_b64_tr_b16 a[14:15], v82 offset:9216
    ds_read_b64_tr_b16 a[88:89], v83 offset:0
    ds_read_b64_tr_b16 a[90:91], v83 offset:1024
    ds_read_b64_tr_b16 a[92:93], v83 offset:8192
    ds_read_b64_tr_b16 a[94:95], v83 offset:9216
    ds_read_b64_tr_b16 a[248:249], v90 offset:0
    ds_read_b64_tr_b16 a[250:251], v90 offset:1024
    ds_read_b64_tr_b16 a[252:253], v90 offset:8192
    ds_read_b64_tr_b16 a[254:255], v90 offset:9216
    ds_read_b64_tr_b16 v[184:185], v91 offset:0
    ds_read_b64_tr_b16 v[186:187], v91 offset:1024
    ds_read_b64_tr_b16 v[188:189], v91 offset:8192
    ds_read_b64_tr_b16 v[190:191], v91 offset:9216
    ds_read_b64_tr_b16 a[168:169], v84 offset:0
    ds_read_b64_tr_b16 a[170:171], v84 offset:512
    ds_read_b64_tr_b16 a[172:173], v84 offset:4096
    ds_read_b64_tr_b16 a[174:175], v84 offset:4608
    s_add_u32 s50, s46, 4194304
    s_add_u32 s51, s47, 4194304
    s_add_u32 m0, s48, 122880
    s_nop 0
    buffer_load_dwordx4 v66, s[12:15], s50 offen lds
    s_add_u32 m0, s48, 123904
    s_nop 0
    buffer_load_dwordx4 v67, s[12:15], s50 offen lds
    s_add_u32 m0, s48, 124928
    s_nop 0
    buffer_load_dwordx4 v68, s[12:15], s50 offen lds
    s_add_u32 m0, s48, 125952
    s_nop 0
    buffer_load_dwordx4 v69, s[12:15], s50 offen lds
    s_add_u32 m0, s48, 139264
    s_nop 0
    buffer_load_dwordx4 v66, s[56:59], s50 offen lds
    s_add_u32 m0, s48, 140288
    s_nop 0
    buffer_load_dwordx4 v67, s[56:59], s50 offen lds
    s_add_u32 m0, s48, 141312
    s_nop 0
    buffer_load_dwordx4 v68, s[56:59], s50 offen lds
    s_add_u32 m0, s48, 142336
    s_nop 0
    buffer_load_dwordx4 v69, s[56:59], s50 offen lds
    s_add_u32 m0, s49, 155648
    s_nop 0
    buffer_load_dwordx4 v70, s[52:55], s51 offen lds
    s_add_u32 m0, s49, 156672
    s_nop 0
    buffer_load_dwordx4 v71, s[52:55], s51 offen lds
    s_waitcnt lgkmcnt(0)
    v_add_u32 v82, 40960, v82
    v_add_u32 v83, 40960, v83
    v_add_u32 v84, 40960, v84
    v_add_u32 v90, 40960, v90
    v_add_u32 v91, 40960, v91
    s_waitcnt vmcnt(20)
    s_barrier
    ds_read_b64_tr_b16 a[16:17], v82 offset:0
    ds_read_b64_tr_b16 a[18:19], v82 offset:1024
    ds_read_b64_tr_b16 a[20:21], v82 offset:8192
    ds_read_b64_tr_b16 a[22:23], v82 offset:9216
    ds_read_b64_tr_b16 a[96:97], v83 offset:0
    ds_read_b64_tr_b16 a[98:99], v83 offset:1024
    ds_read_b64_tr_b16 a[100:101], v83 offset:8192
    ds_read_b64_tr_b16 a[102:103], v83 offset:9216
    ds_read_b64_tr_b16 v[112:113], v90 offset:0
    ds_read_b64_tr_b16 v[114:115], v90 offset:1024
    ds_read_b64_tr_b16 v[116:117], v90 offset:8192
    ds_read_b64_tr_b16 v[118:119], v90 offset:9216
    ds_read_b64_tr_b16 v[192:193], v91 offset:0
    ds_read_b64_tr_b16 v[194:195], v91 offset:1024
    ds_read_b64_tr_b16 v[196:197], v91 offset:8192
    ds_read_b64_tr_b16 v[198:199], v91 offset:9216
    ds_read_b64_tr_b16 a[176:177], v84 offset:0
    ds_read_b64_tr_b16 a[178:179], v84 offset:512
    ds_read_b64_tr_b16 a[180:181], v84 offset:4096
    ds_read_b64_tr_b16 a[182:183], v84 offset:4608
    s_add_u32 s50, s46, 3145728
    s_add_u32 s51, s47, 3145728
    s_add_u32 m0, s48, 0
    s_nop 0
    buffer_load_dwordx4 v66, s[12:15], s50 offen lds
    s_add_u32 m0, s48, 1024
    s_nop 0
    buffer_load_dwordx4 v67, s[12:15], s50 offen lds
    s_add_u32 m0, s48, 2048
    s_nop 0
    buffer_load_dwordx4 v68, s[12:15], s50 offen lds
    s_add_u32 m0, s48, 3072
    s_nop 0
    buffer_load_dwordx4 v69, s[12:15], s50 offen lds
    s_add_u32 m0, s48, 16384
    s_nop 0
    buffer_load_dwordx4 v66, s[56:59], s50 offen lds
    s_add_u32 m0, s48, 17408
    s_nop 0
    buffer_load_dwordx4 v67, s[56:59], s50 offen lds
    s_add_u32 m0, s48, 18432
    s_nop 0
    buffer_load_dwordx4 v68, s[56:59], s50 offen lds
    s_add_u32 m0, s48, 19456
    s_nop 0
    buffer_load_dwordx4 v69, s[56:59], s50 offen lds
    s_add_u32 m0, s49, 32768
    s_nop 0
    buffer_load_dwordx4 v70, s[52:55], s51 offen lds
    s_add_u32 m0, s49, 33792
    s_nop 0
    buffer_load_dwordx4 v71, s[52:55], s51 offen lds
    s_waitcnt lgkmcnt(0)
    v_add_u32 v82, 40960, v82
    v_add_u32 v83, 40960, v83
    v_add_u32 v84, 40960, v84
    v_add_u32 v90, 40960, v90
    v_add_u32 v91, 40960, v91
    s_waitcnt vmcnt(20)
    s_barrier
    ds_read_b64_tr_b16 a[72:73], v82 offset:0
    ds_read_b64_tr_b16 a[74:75], v82 offset:1024
    ds_read_b64_tr_b16 a[76:77], v82 offset:8192
    ds_read_b64_tr_b16 a[78:79], v82 offset:9216
    ds_read_b64_tr_b16 a[152:153], v83 offset:0
    ds_read_b64_tr_b16 a[154:155], v83 offset:1024
    ds_read_b64_tr_b16 a[156:157], v83 offset:8192
    ds_read_b64_tr_b16 a[158:159], v83 offset:9216
    ds_read_b64_tr_b16 v[168:169], v90 offset:0
    ds_read_b64_tr_b16 v[170:171], v90 offset:1024
    ds_read_b64_tr_b16 v[172:173], v90 offset:8192
    ds_read_b64_tr_b16 v[174:175], v90 offset:9216
    ds_read_b64_tr_b16 v[248:249], v91 offset:0
    ds_read_b64_tr_b16 v[250:251], v91 offset:1024
    ds_read_b64_tr_b16 v[252:253], v91 offset:8192
    ds_read_b64_tr_b16 v[254:255], v91 offset:9216
    ds_read_b64_tr_b16 a[232:233], v84 offset:0
    ds_read_b64_tr_b16 a[234:235], v84 offset:512
    ds_read_b64_tr_b16 a[236:237], v84 offset:4096
    ds_read_b64_tr_b16 a[238:239], v84 offset:4608
    s_add_u32 s50, s46, 3670016
    s_add_u32 s51, s47, 3670016
    s_add_u32 m0, s48, 40960
    s_nop 0
    buffer_load_dwordx4 v66, s[12:15], s50 offen lds
    s_add_u32 m0, s48, 41984
    s_nop 0
    buffer_load_dwordx4 v67, s[12:15], s50 offen lds
    s_add_u32 m0, s48, 43008
    s_nop 0
    buffer_load_dwordx4 v68, s[12:15], s50 offen lds
    s_add_u32 m0, s48, 44032
    s_nop 0
    buffer_load_dwordx4 v69, s[12:15], s50 offen lds
    s_add_u32 m0, s48, 57344
    s_nop 0
    buffer_load_dwordx4 v66, s[56:59], s50 offen lds
    s_add_u32 m0, s48, 58368
    s_nop 0
    buffer_load_dwordx4 v67, s[56:59], s50 offen lds
    s_add_u32 m0, s48, 59392
    s_nop 0
    buffer_load_dwordx4 v68, s[56:59], s50 offen lds
    s_add_u32 m0, s48, 60416
    s_nop 0
    buffer_load_dwordx4 v69, s[56:59], s50 offen lds
    s_add_u32 m0, s49, 73728
    s_nop 0
    buffer_load_dwordx4 v70, s[52:55], s51 offen lds
    s_add_u32 m0, s49, 74752
    s_nop 0
    buffer_load_dwordx4 v71, s[52:55], s51 offen lds
    s_mul_i32 s80, s7, 163840
    s_mul_i32 s81, s3, 640
    s_add_u32 s80, s80, s81
    buffer_load_dwordx4 v[44:47], v72, s[76:79], s80 offen
    buffer_load_dwordx4 v[44:47], v73, s[76:79], s80 offen
    buffer_load_dwordx4 v[44:47], v74, s[76:79], s80 offen
    buffer_load_dwordx4 v[44:47], v75, s[76:79], s80 offen
    buffer_load_dwordx4 v[44:47], v76, s[76:79], s80 offen
    buffer_load_dwordx4 v[44:47], v77, s[76:79], s80 offen
    buffer_load_dwordx4 v[44:47], v78, s[76:79], s80 offen
    buffer_load_dwordx4 v[44:47], v79, s[76:79], s80 offen
    buffer_load_dwordx4 v[44:47], v80, s[76:79], s80 offen
    buffer_load_dwordx4 v[44:47], v81, s[76:79], s80 offen
    s_add_u32 s80, s80, 81920
    buffer_load_dwordx4 v[44:47], v72, s[76:79], s80 offen
    buffer_load_dwordx4 v[44:47], v73, s[76:79], s80 offen
    buffer_load_dwordx4 v[44:47], v74, s[76:79], s80 offen
    buffer_load_dwordx4 v[44:47], v75, s[76:79], s80 offen
    buffer_load_dwordx4 v[44:47], v76, s[76:79], s80 offen
    buffer_load_dwordx4 v[44:47], v77, s[76:79], s80 offen
    buffer_load_dwordx4 v[44:47], v78, s[76:79], s80 offen
    buffer_load_dwordx4 v[44:47], v79, s[76:79], s80 offen
    buffer_load_dwordx4 v[44:47], v80, s[76:79], s80 offen
    buffer_load_dwordx4 v[44:47], v81, s[76:79], s80 offen
    s_add_u32 s80, s80, 81920
    s_waitcnt lgkmcnt(0)
    v_add_u32 v82, 40960, v82
    v_add_u32 v83, 40960, v83
    v_add_u32 v84, 40960, v84
    v_add_u32 v90, 40960, v90
    v_add_u32 v91, 40960, v91
    s_waitcnt vmcnt(40)
    s_barrier
    ds_read_b64_tr_b16 a[64:65], v82 offset:0
    ds_read_b64_tr_b16 a[66:67], v82 offset:1024
    ds_read_b64_tr_b16 a[68:69], v82 offset:8192
    ds_read_b64_tr_b16 a[70:71], v82 offset:9216
    ds_read_b64_tr_b16 a[144:145], v83 offset:0
    ds_read_b64_tr_b16 a[146:147], v83 offset:1024
    ds_read_b64_tr_b16 a[148:149], v83 offset:8192
    ds_read_b64_tr_b16 a[150:151], v83 offset:9216
    ds_read_b64_tr_b16 v[160:161], v90 offset:0
    ds_read_b64_tr_b16 v[162:163], v90 offset:1024
    ds_read_b64_tr_b16 v[164:165], v90 offset:8192
    ds_read_b64_tr_b16 v[166:167], v90 offset:9216
    ds_read_b64_tr_b16 v[240:241], v91 offset:0
    ds_read_b64_tr_b16 v[242:243], v91 offset:1024
    ds_read_b64_tr_b16 v[244:245], v91 offset:8192
    ds_read_b64_tr_b16 v[246:247], v91 offset:9216
    ds_read_b64_tr_b16 a[224:225], v84 offset:0
    ds_read_b64_tr_b16 a[226:227], v84 offset:512
    ds_read_b64_tr_b16 a[228:229], v84 offset:4096
    ds_read_b64_tr_b16 a[230:231], v84 offset:4608
    s_waitcnt lgkmcnt(0)
    v_add_u32 v82, 4294844416, v82
    v_add_u32 v83, 4294844416, v83
    v_add_u32 v84, 4294844416, v84
    v_add_u32 v90, 4294844416, v90
    v_add_u32 v91, 4294844416, v91
    s_waitcnt vmcnt(30)
    s_barrier
    ds_read_b64_tr_b16 a[48:49], v82 offset:0
    ds_read_b64_tr_b16 a[50:51], v82 offset:1024
    ds_read_b64_tr_b16 a[52:53], v82 offset:8192
    ds_read_b64_tr_b16 a[54:55], v82 offset:9216
    ds_read_b64_tr_b16 a[128:129], v83 offset:0
    ds_read_b64_tr_b16 a[130:131], v83 offset:1024
    ds_read_b64_tr_b16 a[132:133], v83 offset:8192
    ds_read_b64_tr_b16 a[134:135], v83 offset:9216
    ds_read_b64_tr_b16 v[144:145], v90 offset:0
    ds_read_b64_tr_b16 v[146:147], v90 offset:1024
    ds_read_b64_tr_b16 v[148:149], v90 offset:8192
    ds_read_b64_tr_b16 v[150:151], v90 offset:9216
    ds_read_b64_tr_b16 v[224:225], v91 offset:0
    ds_read_b64_tr_b16 v[226:227], v91 offset:1024
    ds_read_b64_tr_b16 v[228:229], v91 offset:8192
    ds_read_b64_tr_b16 v[230:231], v91 offset:9216
    ds_read_b64_tr_b16 a[208:209], v84 offset:0
    ds_read_b64_tr_b16 a[210:211], v84 offset:512
    ds_read_b64_tr_b16 a[212:213], v84 offset:4096
    ds_read_b64_tr_b16 a[214:215], v84 offset:4608
    s_waitcnt lgkmcnt(0)
    v_add_u32 v82, 40960, v82
    v_add_u32 v83, 40960, v83
    v_add_u32 v84, 40960, v84
    v_add_u32 v90, 40960, v90
    v_add_u32 v91, 40960, v91
    s_waitcnt vmcnt(20)
    s_barrier
    ds_read_b64_tr_b16 a[56:57], v82 offset:0
    ds_read_b64_tr_b16 a[58:59], v82 offset:1024
    ds_read_b64_tr_b16 a[60:61], v82 offset:8192
    ds_read_b64_tr_b16 a[62:63], v82 offset:9216
    ds_read_b64_tr_b16 a[136:137], v83 offset:0
    ds_read_b64_tr_b16 a[138:139], v83 offset:1024
    ds_read_b64_tr_b16 a[140:141], v83 offset:8192
    ds_read_b64_tr_b16 a[142:143], v83 offset:9216
    ds_read_b64_tr_b16 v[152:153], v90 offset:0
    ds_read_b64_tr_b16 v[154:155], v90 offset:1024
    ds_read_b64_tr_b16 v[156:157], v90 offset:8192
    ds_read_b64_tr_b16 v[158:159], v90 offset:9216
    ds_read_b64_tr_b16 v[232:233], v91 offset:0
    ds_read_b64_tr_b16 v[234:235], v91 offset:1024
    ds_read_b64_tr_b16 v[236:237], v91 offset:8192
    ds_read_b64_tr_b16 v[238:239], v91 offset:9216
    ds_read_b64_tr_b16 a[216:217], v84 offset:0
    ds_read_b64_tr_b16 a[218:219], v84 offset:512
    ds_read_b64_tr_b16 a[220:221], v84 offset:4096
    ds_read_b64_tr_b16 a[222:223], v84 offset:4608
    s_waitcnt lgkmcnt(0)
    v_add_u32 v82, 40960, v82
    v_add_u32 v83, 40960, v83
    v_add_u32 v84, 40960, v84
    v_add_u32 v90, 40960, v90
    v_add_u32 v91, 40960, v91
QL_41_2:
    s_barrier
    s_load_dwordx2 s[12:13], s[0:1], 40
    s_waitcnt lgkmcnt(0)
    s_mov_b32 s14, 5242880
    s_mov_b32 s15, 0x20000
    s_mul_i32 s46, s7, 163840
    s_mul_i32 s47, s3, 640
    s_add_u32 s46, s46, s47
    s_mul_i32 s48, s4, 10240
    s_add_u32 m0, s48, 81920
    s_add_u32 s47, s46, 0
    buffer_load_dwordx4 v72, s[12:15], s47 offen lds
    s_add_u32 m0, s48, 82944
    s_add_u32 s47, s46, 0
    buffer_load_dwordx4 v73, s[12:15], s47 offen lds
    s_add_u32 m0, s48, 83968
    s_add_u32 s47, s46, 0
    buffer_load_dwordx4 v74, s[12:15], s47 offen lds
    s_add_u32 m0, s48, 84992
    s_add_u32 s47, s46, 0
    buffer_load_dwordx4 v75, s[12:15], s47 offen lds
    s_add_u32 m0, s48, 86016
    s_add_u32 s47, s46, 0
    buffer_load_dwordx4 v76, s[12:15], s47 offen lds
    s_add_u32 m0, s48, 87040
    s_add_u32 s47, s46, 0
    buffer_load_dwordx4 v77, s[12:15], s47 offen lds
    s_add_u32 m0, s48, 88064
    s_add_u32 s47, s46, 0
    buffer_load_dwordx4 v78, s[12:15], s47 offen lds
    s_add_u32 m0, s48, 89088
    s_add_u32 s47, s46, 0
    buffer_load_dwordx4 v79, s[12:15], s47 offen lds
    s_add_u32 m0, s48, 90112
    s_add_u32 s47, s46, 0
    buffer_load_dwordx4 v80, s[12:15], s47 offen lds
    s_add_u32 m0, s48, 91136
    s_add_u32 s47, s46, 0
    buffer_load_dwordx4 v81, s[12:15], s47 offen lds
    s_add_u32 m0, s48, 122880
    s_add_u32 s47, s46, 81920
    buffer_load_dwordx4 v72, s[12:15], s47 offen lds
    s_add_u32 m0, s48, 123904
    s_add_u32 s47, s46, 81920
    buffer_load_dwordx4 v73, s[12:15], s47 offen lds
    s_add_u32 m0, s48, 124928
    s_add_u32 s47, s46, 81920
    buffer_load_dwordx4 v74, s[12:15], s47 offen lds
    s_add_u32 m0, s48, 125952
    s_add_u32 s47, s46, 81920
    buffer_load_dwordx4 v75, s[12:15], s47 offen lds
    s_add_u32 m0, s48, 126976
    s_add_u32 s47, s46, 81920
    buffer_load_dwordx4 v76, s[12:15], s47 offen lds
    s_add_u32 m0, s48, 128000
    s_add_u32 s47, s46, 81920
    buffer_load_dwordx4 v77, s[12:15], s47 offen lds
    s_add_u32 m0, s48, 129024
    s_add_u32 s47, s46, 81920
    buffer_load_dwordx4 v78, s[12:15], s47 offen lds
    s_add_u32 m0, s48, 130048
    s_add_u32 s47, s46, 81920
    buffer_load_dwordx4 v79, s[12:15], s47 offen lds
    s_add_u32 m0, s48, 131072
    s_add_u32 s47, s46, 81920
    buffer_load_dwordx4 v80, s[12:15], s47 offen lds
    s_add_u32 m0, s48, 132096
    s_add_u32 s47, s46, 81920
    buffer_load_dwordx4 v81, s[12:15], s47 offen lds
    s_waitcnt vmcnt(10)
    s_barrier
    ds_read_b64_tr_b16 v[44:45], v85 offset:0
    ds_read_b64_tr_b16 v[46:47], v85 offset:2560
    ds_read_b64_tr_b16 v[48:49], v85 offset:20480
    ds_read_b64_tr_b16 v[50:51], v85 offset:23040
    s_waitcnt lgkmcnt(0)
    ds_write_b128 v18, v[44:47] offset:0
    ds_write_b128 v18, v[48:51] offset:1024
    ds_read_b64_tr_b16 v[44:45], v86 offset:0
    ds_read_b64_tr_b16 v[46:47], v86 offset:2560
    ds_read_b64_tr_b16 v[48:49], v86 offset:20480
    ds_read_b64_tr_b16 v[50:51], v86 offset:23040
    s_waitcnt lgkmcnt(0)
    ds_write_b128 v18, v[44:47] offset:4096
    ds_write_b128 v18, v[48:51] offset:5120
    ds_read_b64_tr_b16 v[44:45], v87 offset:0
    ds_read_b64_tr_b16 v[46:47], v87 offset:2560
    ds_read_b64_tr_b16 v[48:49], v87 offset:20480
    ds_read_b64_tr_b16 v[50:51], v87 offset:23040
    s_waitcnt lgkmcnt(0)
    ds_write_b128 v18, v[44:47] offset:8192
    ds_write_b128 v18, v[48:51] offset:9216
    ds_read_b64_tr_b16 v[44:45], v88 offset:0
    ds_read_b64_tr_b16 v[46:47], v88 offset:2560
    ds_read_b64_tr_b16 v[48:49], v88 offset:20480
    ds_read_b64_tr_b16 v[50:51], v88 offset:23040
    s_waitcnt lgkmcnt(0)
    ds_write_b128 v18, v[44:47] offset:12288
    ds_write_b128 v18, v[48:51] offset:13312
    ds_read_b64_tr_b16 v[44:45], v89 offset:0
    ds_read_b64_tr_b16 v[46:47], v89 offset:2560
    ds_read_b64_tr_b16 v[48:49], v89 offset:20480
    ds_read_b64_tr_b16 v[50:51], v89 offset:23040
    s_waitcnt lgkmcnt(0)
    ds_write_b128 v18, v[44:47] offset:16384
    ds_write_b128 v18, v[48:51] offset:17408
    s_waitcnt vmcnt(0)
    s_barrier
    ds_read_b64_tr_b16 v[44:45], v85 offset:40960
    ds_read_b64_tr_b16 v[46:47], v85 offset:43520
    ds_read_b64_tr_b16 v[48:49], v85 offset:61440
    ds_read_b64_tr_b16 v[50:51], v85 offset:64000
    s_waitcnt lgkmcnt(0)
    ds_write_b128 v18, v[44:47] offset:2048
    ds_write_b128 v18, v[48:51] offset:3072
    ds_read_b64_tr_b16 v[44:45], v86 offset:40960
    ds_read_b64_tr_b16 v[46:47], v86 offset:43520
    ds_read_b64_tr_b16 v[48:49], v86 offset:61440
    ds_read_b64_tr_b16 v[50:51], v86 offset:64000
    s_waitcnt lgkmcnt(0)
    ds_write_b128 v18, v[44:47] offset:6144
    ds_write_b128 v18, v[48:51] offset:7168
    ds_read_b64_tr_b16 v[44:45], v87 offset:40960
    ds_read_b64_tr_b16 v[46:47], v87 offset:43520
    ds_read_b64_tr_b16 v[48:49], v87 offset:61440
    ds_read_b64_tr_b16 v[50:51], v87 offset:64000
    s_waitcnt lgkmcnt(0)
    ds_write_b128 v18, v[44:47] offset:10240
    ds_write_b128 v18, v[48:51] offset:11264
    ds_read_b64_tr_b16 v[44:45], v88 offset:40960
    ds_read_b64_tr_b16 v[46:47], v88 offset:43520
    ds_read_b64_tr_b16 v[48:49], v88 offset:61440
    ds_read_b64_tr_b16 v[50:51], v88 offset:64000
    s_waitcnt lgkmcnt(0)
    ds_write_b128 v18, v[44:47] offset:14336
    ds_write_b128 v18, v[48:51] offset:15360
    ds_read_b64_tr_b16 v[44:45], v89 offset:40960
    ds_read_b64_tr_b16 v[46:47], v89 offset:43520
    ds_read_b64_tr_b16 v[48:49], v89 offset:61440
    ds_read_b64_tr_b16 v[50:51], v89 offset:64000
    s_waitcnt lgkmcnt(0)
    ds_write_b128 v18, v[44:47] offset:18432
    ds_write_b128 v18, v[48:51] offset:19456
    s_waitcnt lgkmcnt(0)
    s_barrier
    s_mov_b32 s56, 0xffff0000
    s_mov_b32 s57, 0xffff0000
    s_lshl_b32 s59, s3, 2
    s_add_u32 s59, s59, s4
    v_and_b32 v40, 3, v1
    v_lshlrev_b32 v41, 2, v40
    v_add_u32 v41, 64, v41
    v_mov_b32 v42, 64
    v_mov_b32 v43, 1
    v_cmp_eq_u32 vcc, 1, v40
    s_nop 1
    v_cndmask_b32 v42, v42, v43, vcc
    v_mov_b32 v43, 128
    v_cmp_eq_u32 vcc, 2, v40
    s_nop 1
    v_cndmask_b32 v42, v42, v43, vcc
    v_mov_b32 v43, 8
    v_cmp_eq_u32 vcc, 3, v40
    s_nop 1
    v_cndmask_b32 v42, v42, v43, vcc
    s_mov_b32 s31, 0
MC_sw:
    global_load_dword v44, v41, s[60:61] sc1
    s_add_u32 s31, s31, 1
    s_cmp_gt_u32 s31, 40000
    s_cbranch_scc1 MC_sw2
    s_waitcnt vmcnt(0)
    v_cmp_lt_u32 vcc, v44, v42
    s_cbranch_vccnz MC_sw
MC_sw2:
    v_readlane_b32 s44, v44, 1
    s_nop 3
    s_cmp_eq_u32 s44, 2
    s_cselect_b32 s34, 8192, 0
    s_lshl_b32 s47, s5, 19
    s_add_u32 s47, s47, s33
    s_and_b32 s48, s7, 15
    s_mul_i32 s48, s48, 320
    s_sub_u32 s49, 8192, s34
    s_add_u32 s17, s47, s48
    s_add_u32 s17, s17, s49
    s_lshl_b32 s50, s6, 14
    s_add_u32 s50, s50, s47
    s_add_u32 s19, s50, s49
    s_lshr_b32 s48, s6, 4
    s_mul_i32 s49, s48, 11264
    s_add_u32 s49, s49, s34
    s_add_u32 s21, s47, s49
    s_add_u32 s21, s21, 32768
    s_lshl_b32 s50, s5, 19
    s_xor_b32 s50, s50, 0x80000
    s_add_u32 s50, s50, s33
    s_add_u32 s90, s50, s49
    s_add_u32 s22, s21, 65536
    s_add_u32 s23, s90, 65536
    s_mov_b32 s29, 0
    s_lshr_b32 s48, s4, 1
    s_mul_i32 s49, s48, 11264
    s_add_u32 s49, s49, s34
    s_add_u32 s49, s49, s47
    s_mul_i32 s48, s4, 2560
    s_add_u32 s49, s49, s48
    v_and_b32 v40, 15, v1
    v_lshrrev_b32 v41, 5, v1
    v_lshl_add_u32 v40, v41, 4, v40
    v_lshlrev_b32 v40, 4, v40
    v_bfe_u32 v41, v1, 4, 1
    v_xor_b32 v41, 1, v41
    v_lshl_add_u32 v40, v41, 15, v40
    v_add_u32 v3, s49, v40
    s_lshl_b32 s47, s7, 11
    s_add_u32 s47, s47, s33
    s_add_u32 s24, s47, 3145728
    s_add_u32 s27, s24, 0x10000
    s_add_u32 s47, s7, 32
    s_lshl_b32 s47, s47, 13
    s_lshr_b32 s48, s4, 1
    s_lshl_b32 s48, s48, 24
    s_add_u32 s47, s47, s48
    s_and_b32 s48, s4, 1
    s_lshl_b32 s48, s48, 12
    s_add_u32 s47, s47, s48
    s_add_u32 s25, s47, 16777216
    s_lshl_b32 s47, s4, 12
    s_add_u32 s30, s47, 114688
    s_lshl_b32 s47, s4, 10
    s_add_u32 s28, s19, s47
    s_add_u32 s28, s28, 0x100000
    s_lshl_b32 s47, s4, 8
    s_add_u32 s47, s47, 1052672
    s_add_u32 s91, s19, s47
    s_lshl_b32 s59, s3, 2
    s_add_u32 s59, s59, s4
    s_mov_b32 s86, s35
    s_mov_b32 s87, s35
    s_lshl_b32 s26, s7, 11
    s_mov_b32 s16, 0
    v_and_b32 v40, 3, v1
    v_and_b32 v41, 1, v40
    v_lshlrev_b32 v41, 6, v41
    v_lshrrev_b32 v42, 1, v40
    v_mul_u32_u24 v42, 2048, v42
    v_add_u32 v41, v41, v42
    s_lshr_b32 s44, s7, 1
    s_lshl_b32 s44, s44, 2
    s_add_u32 s44, s44, 100663296
    s_mov_b32 s45, 0
CS_44_l:
    buffer_load_dword v43, v41, s[8:11], s44 offen sc1
    s_add_u32 s45, s45, 1
    s_cmp_gt_u32 s45, 200000
    s_cbranch_scc1 CS_44_e
    s_waitcnt vmcnt(0)
    v_cmp_ne_u32 vcc, 1, v43
    s_cbranch_vccz CS_44_e
    s_sleep 2
    s_branch CS_44_l
CS_44_e:
    s_sub_u32 s46, s25, 262144
    s_xor_b32 s47, s30, 16384
    s_mov_b32 m0, s47
    s_nop 0
    buffer_load_dwordx4 v19, s[8:11], s46 offen offset:0 sc1 lds
    buffer_load_dwordx4 v19, s[8:11], s46 offen offset:1024 sc1 lds
    buffer_load_dwordx4 v19, s[8:11], s46 offen offset:2048 sc1 lds
    buffer_load_dwordx4 v19, s[8:11], s46 offen offset:3072 sc1 lds
    s_cmp_ge_u32 s4, 2
    s_cbranch_scc1 MC_t0
    v_lshlrev_b32 v40, 4, v0
    v_add_u32 v40, 81920, v40
    ds_write_b128 v40, v[92:95] offset:0
    ds_write_b128 v40, v[96:99] offset:2048
    ds_write_b128 v40, v[100:103] offset:4096
    ds_write_b128 v40, v[104:107] offset:6144
    ds_write_b128 v40, v[108:111] offset:8192
MC_t0:
    s_waitcnt lgkmcnt(0)
    v_mov_b64 v[70:71], 0
    v_mov_b64 v[72:73], 0
    v_mov_b64 v[74:75], 0
    v_mov_b64 v[76:77], 0
    v_mov_b64 v[78:79], 0
    v_mov_b64 v[80:81], 0
    v_mov_b64 v[82:83], 0
    v_mov_b64 v[84:85], 0
    v_mov_b64 v[86:87], 0
    v_mov_b64 v[88:89], 0
    v_mov_b64 v[90:91], -1
    v_mov_b64 v[92:93], -1
    s_waitcnt vmcnt(0) lgkmcnt(0)
    s_barrier
.p2align 8
    s_nop 0
    s_nop 0
MC_loop:
    s_waitcnt lgkmcnt(0)
    s_barrier
    ds_read_b128 v[30:33], v4 offset:0
    ds_read_b128 v[34:37], v4 offset:1024
    ds_read_b128 v[38:41], v4 offset:2048
    ds_read_b128 v[42:45], v4 offset:3072
    ds_read_b128 v[46:49], v4 offset:4096
    ds_read_b128 v[50:53], v4 offset:5120
    ds_read_b128 v[54:57], v4 offset:6144
    ds_read_b128 v[58:61], v4 offset:7168
    ds_read_b128 v[62:65], v4 offset:8192
    ds_read_b128 v[66:69], v4 offset:9216
    s_waitcnt lgkmcnt(9)
    v_smfmac_f32_16x16x64_bf16 v[70:73], v[30:33], a[160:167], v2
    s_waitcnt lgkmcnt(8)
    v_smfmac_f32_16x16x64_bf16 v[70:73], v[34:37], a[168:175], v2
    s_waitcnt lgkmcnt(7)
    v_smfmac_f32_16x16x64_bf16 v[70:73], v[38:41], a[176:183], v2
    s_mov_b64 exec, s[42:43]
    buffer_store_dwordx2 v[90:91], v16, s[8:11], s23 offen sc1
    s_mov_b64 exec, -1
    s_waitcnt lgkmcnt(6)
    v_smfmac_f32_16x16x64_bf16 v[70:73], v[42:45], a[184:191], v2
    s_waitcnt lgkmcnt(5)
    v_smfmac_f32_16x16x64_bf16 v[70:73], v[46:49], a[192:199], v2
    s_waitcnt lgkmcnt(4)
    v_smfmac_f32_16x16x64_bf16 v[70:73], v[50:53], a[200:207], v2
    s_waitcnt lgkmcnt(3)
    v_smfmac_f32_16x16x64_bf16 v[70:73], v[54:57], a[208:215], v2
    s_waitcnt lgkmcnt(2)
    v_smfmac_f32_16x16x64_bf16 v[70:73], v[58:61], a[216:223], v2
    s_waitcnt lgkmcnt(1)
    v_smfmac_f32_16x16x64_bf16 v[70:73], v[62:65], a[224:231], v2
    s_waitcnt lgkmcnt(0)
    v_smfmac_f32_16x16x64_bf16 v[70:73], v[66:69], a[232:239], v2
    v_smfmac_f32_16x16x64_bf16 v[74:77], v[30:33], a[0:7], v2
    v_smfmac_f32_16x16x64_bf16 v[78:81], v[30:33], a[80:87], v2
    v_smfmac_f32_16x16x64_bf16 v[74:77], v[34:37], a[8:15], v2
    v_pk_add_f32 v[70:71], v[70:71], v[72:73]
    v_smfmac_f32_16x16x64_bf16 v[78:81], v[34:37], a[88:95], v2
    v_cvt_pk_bf16_f32 v108, v70, v71
    v_cvt_pk_bf16_f32 v109, v70, v71
    v_smfmac_f32_16x16x64_bf16 v[74:77], v[38:41], a[16:23], v2
    v_mfma_f32_16x16x16_bf16 v[70:73], v[108:109], v[24:25], 0
    v_smfmac_f32_16x16x64_bf16 v[78:81], v[38:41], a[96:103], v2
    v_smfmac_f32_16x16x64_bf16 v[74:77], v[42:45], a[24:31], v2
    v_cvt_pk_bf16_f32 v108, v70, v71
    v_smfmac_f32_16x16x64_bf16 v[78:81], v[42:45], a[104:111], v2
    v_cvt_pk_bf16_f32 v109, v72, v73
    s_mov_b64 exec, s[36:37]
    v_smfmac_f32_16x16x64_bf16 v[74:77], v[46:49], a[32:39], v2
    buffer_store_dwordx2 v[108:109], v11, s[8:11], s24 offen
    s_mov_b64 exec, -1
    v_smfmac_f32_16x16x64_bf16 v[78:81], v[46:49], a[112:119], v2
    v_smfmac_f32_16x16x64_bf16 v[74:77], v[50:53], a[40:47], v2
    buffer_store_dwordx4 v[90:93], v19, s[8:11], s28 offen
    v_smfmac_f32_16x16x64_bf16 v[78:81], v[50:53], a[120:127], v2
    v_smfmac_f32_16x16x64_bf16 v[74:77], v[54:57], a[48:55], v2
    s_mov_b64 exec, s[36:37]
    buffer_store_dwordx2 v[90:91], v11, s[8:11], s27 offen
    s_mov_b64 exec, -1
    v_smfmac_f32_16x16x64_bf16 v[78:81], v[54:57], a[128:135], v2
    v_smfmac_f32_16x16x64_bf16 v[74:77], v[58:61], a[56:63], v2
    s_mov_b64 exec, s[94:95]
    buffer_store_dwordx4 v[90:93], v19, s[8:11], s91 offen
    s_mov_b64 exec, -1
    v_smfmac_f32_16x16x64_bf16 v[78:81], v[58:61], a[136:143], v2
    v_smfmac_f32_16x16x64_bf16 v[74:77], v[62:65], a[64:71], v2
    s_mov_b64 exec, s[42:43]
    buffer_store_dwordx2 v[90:91], v16, s[8:11], s22 offen
    s_mov_b64 exec, -1
    v_smfmac_f32_16x16x64_bf16 v[78:81], v[62:65], a[144:151], v2
    v_smfmac_f32_16x16x64_bf16 v[74:77], v[66:69], a[72:79], v2
    v_smfmac_f32_16x16x64_bf16 v[78:81], v[66:69], a[152:159], v2
    v_smfmac_f32_16x16x64_bf16 v[82:85], v[30:33], a[240:247], v2
    v_smfmac_f32_16x16x64_bf16 v[86:89], v[30:33], v[176:183], v2
    v_smfmac_f32_16x16x64_bf16 v[82:85], v[34:37], a[248:255], v2
    v_pk_add_f32 v[74:75], v[74:75], v[76:77]
    v_pk_add_f32 v[78:79], v[78:79], v[80:81]
    v_smfmac_f32_16x16x64_bf16 v[86:89], v[34:37], v[184:191], v2
    v_cvt_pk_bf16_f32 v108, v74, v75
    v_cvt_pk_bf16_f32 v109, v78, v79
    v_smfmac_f32_16x16x64_bf16 v[82:85], v[38:41], v[112:119], v2
    ds_write_b16 v5, v108
    v_smfmac_f32_16x16x64_bf16 v[86:89], v[38:41], v[192:199], v2
    ds_write_b16_d16_hi v5, v108 offset:288
    v_smfmac_f32_16x16x64_bf16 v[82:85], v[42:45], v[120:127], v2
    ds_write_b16 v5, v109 offset:32
    v_smfmac_f32_16x16x64_bf16 v[86:89], v[42:45], v[200:207], v2
    ds_write_b16_d16_hi v5, v109 offset:320
    v_smfmac_f32_16x16x64_bf16 v[82:85], v[46:49], v[128:135], v2
    s_waitcnt lgkmcnt(0)
    s_barrier
    ds_read_b128 v[30:33], v6 offset:0
    ds_read_b128 v[34:37], v6 offset:64
    ds_read_b128 v[38:41], v6 offset:128
    ds_read_b128 v[42:45], v6 offset:192
    v_smfmac_f32_16x16x64_bf16 v[86:89], v[46:49], v[208:215], v2
    ds_read_b128 v[46:49], v7 offset:0
    v_smfmac_f32_16x16x64_bf16 v[82:85], v[50:53], v[136:143], v2
    buffer_load_dwordx4 v[90:93], v12, s[8:11], s24 offen offset:0 sc1
    v_smfmac_f32_16x16x64_bf16 v[86:89], v[50:53], v[216:223], v2
    ds_read_b128 v[50:53], v7 offset:128
    buffer_load_dwordx4 v[94:97], v12, s[8:11], s24 offen offset:1024 sc1
    v_smfmac_f32_16x16x64_bf16 v[82:85], v[54:57], v[144:151], v2
    s_mov_b32 m0, s30
    v_smfmac_f32_16x16x64_bf16 v[86:89], v[54:57], v[224:231], v2
    ds_read_b128 v[54:57], v7 offset:2048
    v_smfmac_f32_16x16x64_bf16 v[82:85], v[58:61], v[152:159], v2
    buffer_load_dwordx4 v19, s[8:11], s25 offen offset:0 sc1 lds
    v_smfmac_f32_16x16x64_bf16 v[86:89], v[58:61], v[232:239], v2
    ds_read_b128 v[58:61], v7 offset:2176
    v_smfmac_f32_16x16x64_bf16 v[82:85], v[62:65], v[160:167], v2
    v_smfmac_f32_16x16x64_bf16 v[86:89], v[62:65], v[240:247], v2
    ds_read_b128 v[62:65], v7 offset:4096
    buffer_load_dwordx4 v19, s[8:11], s25 offen offset:1024 sc1 lds
    v_smfmac_f32_16x16x64_bf16 v[82:85], v[66:69], v[168:175], v2
    v_smfmac_f32_16x16x64_bf16 v[86:89], v[66:69], v[248:255], v2
    ds_read_b128 v[66:69], v7 offset:4224
    s_waitcnt lgkmcnt(5)
    v_mfma_f32_16x16x32_bf16 v[70:73], v[46:49], v[30:33], 0
    ds_read_b128 v[46:49], v7 offset:6144
    s_waitcnt lgkmcnt(5)
    v_mfma_f32_16x16x32_bf16 v[74:77], v[50:53], v[30:33], 0
    ds_read_b128 v[50:53], v7 offset:6272
    s_waitcnt lgkmcnt(5)
    v_mfma_f32_16x16x32_bf16 v[70:73], v[54:57], v[34:37], v[70:73]
    buffer_load_dwordx4 v19, s[8:11], s25 offen offset:2048 sc1 lds
    s_waitcnt lgkmcnt(4)
    v_mfma_f32_16x16x32_bf16 v[74:77], v[58:61], v[34:37], v[74:77]
    s_waitcnt lgkmcnt(3)
    v_mfma_f32_16x16x32_bf16 v[70:73], v[62:65], v[38:41], v[70:73]
    s_waitcnt lgkmcnt(2)
    v_mfma_f32_16x16x32_bf16 v[74:77], v[66:69], v[38:41], v[74:77]
    ds_read_b128 v[54:57], v8
    ds_read_b128 v[58:61], v8 offset:256
    s_waitcnt lgkmcnt(3)
    v_mfma_f32_16x16x32_bf16 v[70:73], v[46:49], v[42:45], v[70:73]
    buffer_load_dwordx4 v19, s[8:11], s25 offen offset:3072 sc1 lds
    s_waitcnt lgkmcnt(2)
    v_mfma_f32_16x16x32_bf16 v[74:77], v[50:53], v[42:45], v[74:77]
    s_waitcnt vmcnt(4)
    s_mov_b32 s31, 0
    v_mfma_f32_16x16x32_bf16 v[78:81], v[90:93], v[30:33], 0
    v_mfma_f32_16x16x32_bf16 v[98:101], v[90:93], v[34:37], 0
    v_mfma_f32_16x16x32_bf16 v[78:81], v[94:97], v[38:41], v[78:81]
    v_mfma_f32_16x16x32_bf16 v[98:101], v[94:97], v[42:45], v[98:101]
    v_pk_add_f32 v[82:83], v[82:83], v[84:85]
    v_cvt_pk_bf16_f32 v106, v82, v83
    v_pk_add_f32 v[86:87], v[86:87], v[88:89]
    v_cvt_pk_bf16_f32 v107, v86, v87
    v_max3_f32 v108, v70, v71, v72
    v_max3_f32 v108, v108, v73, v74
    v_max3_f32 v108, v108, v75, v76
    v_mov_b32 v62, 0x3f803f80
    v_mov_b32 v63, 0x3f803f80
    v_pk_add_f32 v[78:79], v[78:79], v[100:101]
    v_cmp_u_f32 vcc, v78, v79
    v_mov_b64 v[64:65], v[62:63]
    s_cbranch_vccnz ST_45_kretry
ST_45_kok:
    v_max3_f32 v108, v108, v77, v78
    v_max_f32 v108, v108, v79
    v_mov_b32 v109, v108
    s_nop 1
    v_permlane32_swap_b32 v108, v109
    v_max_f32 v108, v108, v109
    v_mov_b32 v109, v108
    s_nop 1
    v_permlane16_swap_b32 v108, v109
    v_max_f32 v108, v108, v109
    v_mul_f32 v110, s35, v108
    v_pk_fma_f32 v[70:71], v[70:71], s[86:87], v[110:111] op_sel_hi:[1,1,0] neg_lo:[0,0,1] neg_hi:[0,0,1]
    v_pk_fma_f32 v[72:73], v[72:73], s[86:87], v[110:111] op_sel_hi:[1,1,0] neg_lo:[0,0,1] neg_hi:[0,0,1]
    v_pk_fma_f32 v[74:75], v[74:75], s[86:87], v[110:111] op_sel_hi:[1,1,0] neg_lo:[0,0,1] neg_hi:[0,0,1]
    v_pk_fma_f32 v[76:77], v[76:77], s[86:87], v[110:111] op_sel_hi:[1,1,0] neg_lo:[0,0,1] neg_hi:[0,0,1]
    v_pk_fma_f32 v[78:79], v[78:79], s[86:87], v[110:111] op_sel_hi:[1,1,0] neg_lo:[0,0,1] neg_hi:[0,0,1]
    v_exp_f32 v70, v70
    v_exp_f32 v71, v71
    v_exp_f32 v72, v72
    v_exp_f32 v73, v73
    v_exp_f32 v74, v74
    v_exp_f32 v75, v75
    v_exp_f32 v76, v76
    v_exp_f32 v77, v77
    v_exp_f32 v78, v78
    v_exp_f32 v79, v79
    v_cvt_pk_bf16_f32 v66, v70, v71
    v_cvt_pk_bf16_f32 v67, v72, v73
    v_cvt_pk_bf16_f32 v68, v74, v75
    v_cvt_pk_bf16_f32 v69, v76, v77
    v_cvt_pk_bf16_f32 v26, v78, v79
    v_cvt_pk_bf16_f32 v29, v78, v79
    s_waitcnt lgkmcnt(0)
    v_mfma_f32_16x16x32_bf16 v[30:33], v[62:65], v[66:69], 0
    s_cmp_lg_u32 s59, 3
    s_cbranch_scc1 KMS_46
    s_add_u32 s44, s26, 67108864
    buffer_store_dwordx4 v[90:93], v12, s[8:11], s44 offen offset:0 sc1
    buffer_store_dwordx4 v[94:97], v12, s[8:11], s44 offen offset:1024 sc1
KMS_46:
    s_add_u32 s44, s26, 71303168
    v_mfma_f32_16x16x32_bf16 v[46:49], v[54:57], v[66:69], 0
    ds_read_b128 v[98:101], v18 offset:0
    ds_read_b128 v[102:105], v18 offset:1024
    v_mfma_f32_16x16x32_bf16 v[50:53], v[58:61], v[66:69], 0
    ds_read_b128 v[34:37], v18 offset:4096
    ds_read_b128 v[38:41], v18 offset:5120
    buffer_store_dword v106, v17, s[8:11], s44 offen sc1
    v_mfma_f32_16x16x16_bf16 v[30:33], v[62:63], v[26:27], v[30:33]
    ds_read_b128 v[70:73], v18 offset:8192
    ds_read_b128 v[74:77], v18 offset:9216
    v_mfma_f32_16x16x16_bf16 v[46:49], v[106:107], v[26:27], v[46:49]
    ds_read_b128 v[78:81], v18 offset:12288
    ds_read_b128 v[82:85], v18 offset:13312
    v_mfma_f32_16x16x16_bf16 v[50:53], v[106:107], v[28:29], v[50:53]
    buffer_store_dword v107, v17, s[8:11], s44 offen offset:64 sc1
    v_mov_b64 v[86:87], 0
    v_mov_b64 v[88:89], 0
    v_rcp_f32 v109, v30
    s_nop 1
    v_pk_mul_f32 v[46:47], v[46:47], v[108:109] op_sel:[0,1] op_sel_hi:[1,1]
    v_pk_mul_f32 v[48:49], v[48:49], v[108:109] op_sel:[0,1] op_sel_hi:[1,1]
    v_pk_mul_f32 v[50:51], v[50:51], v[108:109] op_sel:[0,1] op_sel_hi:[1,1]
    v_pk_mul_f32 v[52:53], v[52:53], v[108:109] op_sel:[0,1] op_sel_hi:[1,1]
    v_cvt_pk_bf16_f32 v46, v46, v47
    v_cvt_pk_bf16_f32 v47, v48, v49
    v_cvt_pk_bf16_f32 v50, v50, v51
    v_cvt_pk_bf16_f32 v51, v52, v53
    ds_write_b64 v9, v[46:47]
    ds_write_b64 v9, v[50:51] offset:32
    ds_read_b128 v[54:57], v18 offset:16384
    ds_read_b128 v[58:61], v18 offset:17408
    ds_read_b128 v[90:93], v18 offset:2048
    ds_read_b128 v[94:97], v18 offset:3072
    v_mov_b64 v[42:43], 0
    v_mov_b64 v[44:45], 0
    v_mov_b64 v[30:31], 0
    v_mov_b64 v[32:33], 0
    s_waitcnt lgkmcnt(4)
    s_barrier
    ds_read_b128 v[108:111], v10
    ds_read_b128 v[62:65], v10 offset:128
    v_mov_b64 v[46:47], 0
    v_mov_b64 v[48:49], 0
    v_mov_b64 v[50:51], 0
    v_mov_b64 v[52:53], 0
    s_waitcnt lgkmcnt(1)
    v_smfmac_f32_16x16x64_bf16 v[86:89], v[108:111], v[98:105], v2
    ds_read_b128 v[98:101], v18 offset:6144
    ds_read_b128 v[102:105], v18 offset:7168
    v_smfmac_f32_16x16x64_bf16 v[42:45], v[108:111], v[34:41], v2
    ds_read_b128 v[34:37], v18 offset:10240
    ds_read_b128 v[38:41], v18 offset:11264
    v_smfmac_f32_16x16x64_bf16 v[30:33], v[108:111], v[70:77], v2
    ds_read_b128 v[70:73], v18 offset:14336
    ds_read_b128 v[74:77], v18 offset:15360
    v_smfmac_f32_16x16x64_bf16 v[46:49], v[108:111], v[78:85], v2
    ds_read_b128 v[78:81], v18 offset:18432
    ds_read_b128 v[82:85], v18 offset:19456
    v_smfmac_f32_16x16x64_bf16 v[50:53], v[108:111], v[54:61], v2
    s_waitcnt lgkmcnt(8)
    v_smfmac_f32_16x16x64_bf16 v[86:89], v[62:65], v[90:97], v2
    s_waitcnt lgkmcnt(6)
    v_smfmac_f32_16x16x64_bf16 v[42:45], v[62:65], v[98:105], v2
    s_waitcnt lgkmcnt(4)
    v_smfmac_f32_16x16x64_bf16 v[30:33], v[62:65], v[34:41], v2
    s_waitcnt lgkmcnt(2)
    v_smfmac_f32_16x16x64_bf16 v[46:49], v[62:65], v[70:77], v2
    s_waitcnt lgkmcnt(0)
    v_smfmac_f32_16x16x64_bf16 v[50:53], v[62:65], v[78:85], v2
    v_pk_add_f32 v[86:87], v[86:87], v[88:89]
    v_pk_add_f32 v[42:43], v[42:43], v[44:45]
    v_pk_add_f32 v[30:31], v[30:31], v[32:33]
    v_cvt_pk_bf16_f32 v54, v86, v87
    v_cvt_pk_bf16_f32 v55, v42, v43
    v_cvt_pk_bf16_f32 v56, v30, v31
    v_pk_add_f32 v[46:47], v[46:47], v[48:49]
    v_cvt_pk_bf16_f32 v57, v46, v47
    v_pk_add_f32 v[50:51], v[50:51], v[52:53]
    v_permlane32_swap_b32 v54, v56
    v_cvt_pk_bf16_f32 v62, v50, v51
    v_cvt_pk_bf16_f32 v64, v50, v51
    v_permlane32_swap_b32 v55, v57
    s_nop 0
    v_permlane32_swap_b32 v62, v64
    v_permlane16_swap_b32 v54, v55
    v_permlane16_swap_b32 v56, v57
    v_mov_b32 v63, v62
    buffer_store_dwordx4 v[54:57], v13, s[8:11], s17 offen
    v_mov_b32 v65, v64
    v_permlane16_swap_b32 v62, v63
    s_nop 0
    v_permlane16_swap_b32 v64, v65
    s_mov_b64 exec, s[94:95]
    buffer_store_dwordx4 v[62:65], v14, s[8:11], s17 offen
    s_mov_b64 exec, -1
    v_mov_b64 v[70:71], 0
    v_mov_b64 v[72:73], 0
    v_mov_b64 v[74:75], 0
    v_mov_b64 v[76:77], 0
    v_mov_b64 v[78:79], 0
    v_mov_b64 v[80:81], 0
    v_mov_b64 v[82:83], 0
    v_mov_b64 v[84:85], 0
    v_mov_b64 v[86:87], 0
    v_mov_b64 v[88:89], 0
    v_mov_b64 v[90:91], -1
    v_mov_b64 v[92:93], -1
    s_cmp_ge_u32 s4, 2
    s_cbranch_scc1 ST_45_srv
    v_mov_b32 v98, v3
    v_xor_b32 v7, 16384, v7
    v_xor_b32 v8, 16384, v8
    v_mov_b32_dpp v50, v20 row_ror:8 row_mask:0xf bank_mask:0xf
    v_mov_b32_dpp v51, v21 row_ror:8 row_mask:0xf bank_mask:0xf
    v_mov_b32_dpp v52, v22 row_ror:8 row_mask:0xf bank_mask:0xf
    v_mov_b32_dpp v53, v23 row_ror:8 row_mask:0xf bank_mask:0xf
    v_cndmask_b32 v50, v20, v50, s[92:93]
    v_cndmask_b32 v51, v21, v51, s[92:93]
    v_cndmask_b32 v52, v22, v52, s[92:93]
    v_cndmask_b32 v53, v23, v53, s[92:93]
    v_bfe_u32 v108, v1, 3, 1
    v_lshrrev_b32 v109, 5, v1
    v_lshl_add_u32 v108, v108, 1, v109
    v_lshlrev_b32 v108, 7, v108
    v_and_b32 v109, 7, v1
    v_lshl_add_u32 v108, v109, 4, v108
    v_bfe_u32 v109, v1, 4, 1
    v_lshl_add_u32 v108, v109, 3, v108
    s_mul_i32 s44, s4, 2560
    s_add_u32 s44, s44, 81920
    v_add_u32 v99, s44, v108
    s_sleep 5
    s_mov_b64 exec, s[40:41]
    buffer_load_dwordx4 v[30:33], v15, s[8:11], s19 offen offset:0 sc1
    buffer_load_dwordx4 v[34:37], v15, s[8:11], s19 offen offset:1280 sc1
    buffer_load_dwordx4 v[38:41], v15, s[8:11], s19 offen offset:2560 sc1
    buffer_load_dwordx4 v[42:45], v15, s[8:11], s19 offen offset:3840 sc1
    s_mov_b64 exec, -1
    s_mov_b32 s31, 0
ST_45_rsm:
    s_waitcnt vmcnt(3)
    v_mfma_f32_16x16x32_bf16 v[62:65], v[20:23], v[30:33], 0
    s_waitcnt vmcnt(2)
    v_mfma_f32_16x16x32_bf16 v[62:65], v[20:23], v[34:37], v[62:65]
    s_waitcnt vmcnt(1)
    v_mfma_f32_16x16x32_bf16 v[62:65], v[20:23], v[38:41], v[62:65]
    s_waitcnt vmcnt(0)
    v_mfma_f32_16x16x32_bf16 v[62:65], v[20:23], v[42:45], v[62:65]
    s_mov_b64 exec, s[42:43]
    s_nop 6
    v_pk_add_f32 v[108:109], v[62:63], v[64:65]
    v_cvt_pk_bf16_f32 v62, v62, v63
    v_cvt_pk_bf16_f32 v63, v64, v65
    v_cmp_u_f32 vcc, v108, v109
    s_cbranch_vccnz ST_45_rsr
ST_45_rsd:
    buffer_store_dwordx2 v[62:63], v16, s[8:11], s90 offen sc1
    buffer_store_dwordx2 v[62:63], v16, s[8:11], s21 offen
    s_mov_b64 exec, -1
    s_bitcmp1_b32 s16, 0
    s_cselect_b32 s44, -1, 1
    s_lshl_b32 s45, s44, 20
    s_add_u32 s17, s17, s45
    s_add_u32 s19, s19, s45
    s_sub_u32 s28, s28, s45
    s_sub_u32 s91, s91, s45
    s_sub_u32 s20, s22, s21
    v_add_u32 v3, s20, v3
    s_mov_b32 s21, s22
    s_mov_b32 s90, s23
    s_add_u32 s29, s29, 1
    s_cmp_eq_u32 s29, 3
    s_cselect_b32 s29, 0, s29
    s_cmp_eq_u32 s29, 2
    s_mov_b32 s20, 65536
    s_cselect_b32 s20, 4294836224, s20
    s_add_u32 s22, s21, s20
    s_add_u32 s23, s90, s20
    s_xor_b32 s30, s30, 16384
    s_lshl_b32 s45, s44, 16
    s_mov_b32 s27, s24
    s_add_u32 s24, s24, s45
    s_add_u32 s26, s26, 65536
    s_add_u32 s25, s25, 262144
    s_add_u32 s16, s16, 1
    s_barrier
    s_sleep 7
    s_branch ST_45_gat
ST_45_rsr:
    s_mov_b64 exec, s[40:41]
    v_max3_u32 v108, v30, v31, v32
    v_max3_u32 v108, v108, v33, v34
    v_max3_u32 v108, v108, v35, v36
    v_max3_u32 v108, v108, v37, v38
    v_max3_u32 v108, v108, v39, v40
    v_max3_u32 v108, v108, v41, v42
    v_max3_u32 v108, v108, v43, v44
    v_max_u32 v108, v108, v45
    v_cmp_eq_u32 vcc, -1, v108
    s_mov_b64 exec, s[42:43]
    s_cbranch_vccz ST_45_rsd
    s_add_u32 s31, s31, 1
    s_cmp_gt_u32 s31, 40000
    s_cbranch_scc1 ST_45_rsd
    s_mov_b64 exec, s[40:41]
    buffer_load_dwordx4 v[30:33], v15, s[8:11], s19 offen offset:0 sc1
    buffer_load_dwordx4 v[34:37], v15, s[8:11], s19 offen offset:1280 sc1
    buffer_load_dwordx4 v[38:41], v15, s[8:11], s19 offen offset:2560 sc1
    buffer_load_dwordx4 v[42:45], v15, s[8:11], s19 offen offset:3840 sc1
    s_mov_b64 exec, -1
    s_branch ST_45_rsm
ST_45_kretry:
    v_max3_u32 v109, v90, v91, v92
    v_max3_u32 v109, v109, v93, v94
    v_max3_u32 v109, v109, v95, v96
    v_max_u32 v109, v109, v97
    v_cmp_eq_u32 vcc, -1, v109
    s_cbranch_vccz ST_45_kok
    s_add_u32 s31, s31, 1
    s_cmp_gt_u32 s31, 40000
    s_cbranch_scc1 ST_45_kok
    buffer_load_dwordx4 v[90:93], v12, s[8:11], s24 offen offset:0 sc1
    buffer_load_dwordx4 v[94:97], v12, s[8:11], s24 offen offset:1024 sc1
    s_waitcnt vmcnt(0)
    v_mfma_f32_16x16x32_bf16 v[78:81], v[90:93], v[30:33], 0
    v_mfma_f32_16x16x32_bf16 v[98:101], v[90:93], v[34:37], 0
    v_mfma_f32_16x16x32_bf16 v[78:81], v[94:97], v[38:41], v[78:81]
    v_mfma_f32_16x16x32_bf16 v[98:101], v[94:97], v[42:45], v[98:101]
    s_nop 7
    v_pk_add_f32 v[78:79], v[78:79], v[100:101]
    v_cmp_u_f32 vcc, v78, v79
    s_cbranch_vccnz ST_45_kretry
    s_branch ST_45_kok
ST_45_srv:
    s_add_u32 s50, s16, 2
    s_and_b32 s51, s50, 7
    s_cmp_lg_u32 s51, 0
    s_cbranch_scc1 WT_47
    s_lshr_b32 s50, s50, 3
    s_cmp_ge_u32 s50, 8
    s_cbranch_scc1 WT_47
    s_mul_i32 s44, s50, 48
    s_lshr_b32 s46, s7, 1
    s_add_u32 s44, s44, s46
    s_add_u32 s44, s44, 0
    s_lshl_b32 s44, s44, 2
    s_add_u32 s44, s44, 100663296
    v_and_b32 v110, 63, v0
    v_min_u32 v110, 0, v110
    v_lshlrev_b32 v110, 2, v110
    s_mov_b32 s45, 0
WF_48_l:
    buffer_load_dword v111, v110, s[8:11], s44 offen sc1
    s_add_u32 s45, s45, 1
    s_cmp_gt_u32 s45, 200000
    s_cbranch_scc1 WF_48_e
    s_waitcnt vmcnt(0)
    v_cmp_ne_u32 vcc, 1, v111
    s_cbranch_vccz WF_48_e
    s_sleep 2
    s_branch WF_48_l
WF_48_e:
    s_cmp_lg_u32 s50, 0
    s_cbranch_scc1 H2_49
    s_lshr_b32 s46, s7, 1
    s_add_u32 s44, s46, 0
    s_lshl_b32 s44, s44, 2
    s_add_u32 s44, s44, 100665344
    v_and_b32 v110, 63, v0
    v_min_u32 v110, 0, v110
    v_lshlrev_b32 v110, 2, v110
    s_mov_b32 s45, 0
WF_50_l:
    buffer_load_dword v111, v110, s[8:11], s44 offen sc1
    s_add_u32 s45, s45, 1
    s_cmp_gt_u32 s45, 200000
    s_cbranch_scc1 WF_50_e
    s_waitcnt vmcnt(0)
    v_cmp_ne_u32 vcc, 1, v111
    s_cbranch_vccz WF_50_e
    s_sleep 2
    s_branch WF_50_l
WF_50_e:
H2_49:
    s_mul_i32 s44, s50, 48
    s_lshr_b32 s46, s7, 1
    s_add_u32 s44, s44, s46
    s_add_u32 s44, s44, 16
    s_lshl_b32 s44, s44, 2
    s_add_u32 s44, s44, 100663296
    v_and_b32 v110, 63, v0
    v_min_u32 v110, 0, v110
    v_lshlrev_b32 v110, 2, v110
    s_mov_b32 s45, 0
WF_51_l:
    buffer_load_dword v111, v110, s[8:11], s44 offen sc1
    s_add_u32 s45, s45, 1
    s_cmp_gt_u32 s45, 200000
    s_cbranch_scc1 WF_51_e
    s_waitcnt vmcnt(0)
    v_cmp_ne_u32 vcc, 1, v111
    s_cbranch_vccz WF_51_e
    s_sleep 2
    s_branch WF_51_l
WF_51_e:
    s_cmp_lg_u32 s50, 0
    s_cbranch_scc1 H2_52
    s_lshr_b32 s46, s7, 1
    s_add_u32 s44, s46, 16
    s_lshl_b32 s44, s44, 2
    s_add_u32 s44, s44, 100665344
    v_and_b32 v110, 63, v0
    v_min_u32 v110, 0, v110
    v_lshlrev_b32 v110, 2, v110
    s_mov_b32 s45, 0
WF_53_l:
    buffer_load_dword v111, v110, s[8:11], s44 offen sc1
    s_add_u32 s45, s45, 1
    s_cmp_gt_u32 s45, 200000
    s_cbranch_scc1 WF_53_e
    s_waitcnt vmcnt(0)
    v_cmp_ne_u32 vcc, 1, v111
    s_cbranch_vccz WF_53_e
    s_sleep 2
    s_branch WF_53_l
WF_53_e:
H2_52:
WT_47:
    v_mov_b32 v98, v3
    v_xor_b32 v7, 16384, v7
    v_xor_b32 v8, 16384, v8
    v_mov_b32_dpp v50, v20 row_ror:8 row_mask:0xf bank_mask:0xf
    v_mov_b32_dpp v51, v21 row_ror:8 row_mask:0xf bank_mask:0xf
    v_mov_b32_dpp v52, v22 row_ror:8 row_mask:0xf bank_mask:0xf
    v_mov_b32_dpp v53, v23 row_ror:8 row_mask:0xf bank_mask:0xf
    v_cndmask_b32 v50, v20, v50, s[92:93]
    v_cndmask_b32 v51, v21, v51, s[92:93]
    v_cndmask_b32 v52, v22, v52, s[92:93]
    v_cndmask_b32 v53, v23, v53, s[92:93]
    v_bfe_u32 v108, v1, 3, 1
    v_lshrrev_b32 v109, 5, v1
    v_lshl_add_u32 v108, v108, 1, v109
    v_lshlrev_b32 v108, 7, v108
    v_and_b32 v109, 7, v1
    v_lshl_add_u32 v108, v109, 4, v108
    v_bfe_u32 v109, v1, 4, 1
    v_lshl_add_u32 v108, v109, 3, v108
    s_mul_i32 s44, s4, 2560
    s_add_u32 s44, s44, 81920
    v_add_u32 v99, s44, v108
    s_bitcmp1_b32 s16, 0
    s_cselect_b32 s44, -1, 1
    s_lshl_b32 s45, s44, 20
    s_add_u32 s17, s17, s45
    s_add_u32 s19, s19, s45
    s_sub_u32 s28, s28, s45
    s_sub_u32 s91, s91, s45
    s_sub_u32 s20, s22, s21
    v_add_u32 v3, s20, v3
    s_mov_b32 s21, s22
    s_mov_b32 s90, s23
    s_add_u32 s29, s29, 1
    s_cmp_eq_u32 s29, 3
    s_cselect_b32 s29, 0, s29
    s_cmp_eq_u32 s29, 2
    s_mov_b32 s20, 65536
    s_cselect_b32 s20, 4294836224, s20
    s_add_u32 s22, s21, s20
    s_add_u32 s23, s90, s20
    s_xor_b32 s30, s30, 16384
    s_lshl_b32 s45, s44, 16
    s_mov_b32 s27, s24
    s_add_u32 s24, s24, s45
    s_add_u32 s26, s26, 65536
    s_add_u32 s25, s25, 262144
    s_add_u32 s16, s16, 1
    s_barrier
    s_sleep 7
ST_45_gat:
    s_mov_b32 s31, 0
ST_45_agp:
    buffer_load_dwordx4 v[30:33], v98, s[8:11], 0 offen offset:0 sc1
    buffer_load_dwordx4 v[34:37], v98, s[8:11], 0 offen offset:512 sc1
    buffer_load_dwordx4 v[38:41], v98, s[8:11], 0 offen offset:1024 sc1
    buffer_load_dwordx4 v[42:45], v98, s[8:11], 0 offen offset:1536 sc1
    buffer_load_dwordx4 v[46:49], v98, s[8:11], 0 offen offset:2048 sc1
    s_waitcnt vmcnt(4)
    v_mfma_f32_16x16x32_bf16 v[54:57], v[30:33], v[50:53], 0
    s_waitcnt vmcnt(3)
    v_mfma_f32_16x16x32_bf16 v[58:61], v[34:37], v[50:53], 0
    s_waitcnt vmcnt(2)
    v_mfma_f32_16x16x32_bf16 v[62:65], v[38:41], v[50:53], 0
    s_waitcnt vmcnt(1)
    v_mfma_f32_16x16x32_bf16 v[66:69], v[42:45], v[50:53], 0
    s_waitcnt vmcnt(0)
    v_mfma_f32_16x16x32_bf16 v[94:97], v[46:49], v[50:53], 0
    s_nop 2
    v_pk_add_f32 v[110:111], v[54:55], v[56:57]
    v_pk_add_f32 v[110:111], v[110:111], v[58:59]
    v_pk_add_f32 v[110:111], v[110:111], v[60:61]
    v_pk_add_f32 v[110:111], v[110:111], v[62:63]
    v_pk_add_f32 v[110:111], v[110:111], v[64:65]
    v_pk_add_f32 v[110:111], v[110:111], v[66:67]
    v_pk_add_f32 v[110:111], v[110:111], v[68:69]
    s_nop 0
    v_pk_add_f32 v[110:111], v[110:111], v[94:95]
    v_pk_add_f32 v[110:111], v[110:111], v[96:97]
    v_cvt_pk_bf16_f32 v54, v54, v55
    v_cvt_pk_bf16_f32 v55, v56, v57
    v_cmp_u_f32 vcc, v110, v111
    v_cvt_pk_bf16_f32 v58, v58, v59
    v_cvt_pk_bf16_f32 v59, v60, v61
    v_cvt_pk_bf16_f32 v62, v62, v63
    v_cvt_pk_bf16_f32 v63, v64, v65
    v_cvt_pk_bf16_f32 v66, v66, v67
    v_cvt_pk_bf16_f32 v67, v68, v69
    v_cvt_pk_bf16_f32 v94, v94, v95
    v_cvt_pk_bf16_f32 v95, v96, v97
    s_cbranch_vccnz ST_45_agr
ST_45_agd:
    ds_write_b64 v99, v[54:55] offset:0
    ds_write_b64 v99, v[58:59] offset:512
    ds_write_b64 v99, v[62:63] offset:1024
    ds_write_b64 v99, v[66:67] offset:1536
    ds_write_b64 v99, v[94:95] offset:2048
    s_cmp_lt_u32 s16, 63
    s_cbranch_scc1 MC_loop
    s_branch ST_45_end
ST_45_agr:
    v_max3_u32 v108, v30, v31, v32
    v_max3_u32 v108, v108, v33, v34
    v_max3_u32 v108, v108, v35, v36
    v_max3_u32 v108, v108, v37, v38
    v_max3_u32 v108, v108, v39, v40
    v_max3_u32 v108, v108, v41, v42
    v_max3_u32 v108, v108, v43, v44
    v_max3_u32 v108, v108, v45, v46
    v_max3_u32 v108, v108, v47, v48
    v_max_u32 v108, v108, v49
    v_cmp_eq_u32 vcc, -1, v108
    s_cbranch_vccz ST_45_agd
    s_add_u32 s31, s31, 1
    s_cmp_gt_u32 s31, 40000
    s_cbranch_scc1 ST_45_agd
    s_branch ST_45_agp
ST_45_end:
    s_waitcnt lgkmcnt(0)
    s_barrier
    ds_read_b128 v[30:33], v4 offset:0
    ds_read_b128 v[34:37], v4 offset:1024
    ds_read_b128 v[38:41], v4 offset:2048
    ds_read_b128 v[42:45], v4 offset:3072
    ds_read_b128 v[46:49], v4 offset:4096
    ds_read_b128 v[50:53], v4 offset:5120
    ds_read_b128 v[54:57], v4 offset:6144
    ds_read_b128 v[58:61], v4 offset:7168
    ds_read_b128 v[62:65], v4 offset:8192
    ds_read_b128 v[66:69], v4 offset:9216
    s_waitcnt lgkmcnt(9)
    v_smfmac_f32_16x16x64_bf16 v[70:73], v[30:33], a[160:167], v2
    s_waitcnt lgkmcnt(8)
    v_smfmac_f32_16x16x64_bf16 v[70:73], v[34:37], a[168:175], v2
    s_waitcnt lgkmcnt(7)
    v_smfmac_f32_16x16x64_bf16 v[70:73], v[38:41], a[176:183], v2
    s_waitcnt lgkmcnt(6)
    v_smfmac_f32_16x16x64_bf16 v[70:73], v[42:45], a[184:191], v2
    s_waitcnt lgkmcnt(5)
    v_smfmac_f32_16x16x64_bf16 v[70:73], v[46:49], a[192:199], v2
    s_waitcnt lgkmcnt(4)
    v_smfmac_f32_16x16x64_bf16 v[70:73], v[50:53], a[200:207], v2
    s_waitcnt lgkmcnt(3)
    v_smfmac_f32_16x16x64_bf16 v[70:73], v[54:57], a[208:215], v2
    s_waitcnt lgkmcnt(2)
    v_smfmac_f32_16x16x64_bf16 v[70:73], v[58:61], a[216:223], v2
    s_waitcnt lgkmcnt(1)
    v_smfmac_f32_16x16x64_bf16 v[70:73], v[62:65], a[224:231], v2
    s_waitcnt lgkmcnt(0)
    v_smfmac_f32_16x16x64_bf16 v[70:73], v[66:69], a[232:239], v2
    s_add_u32 s46, s26, 67108864
    v_smfmac_f32_16x16x64_bf16 v[82:85], v[30:33], a[240:247], v2
    v_smfmac_f32_16x16x64_bf16 v[86:89], v[30:33], v[176:183], v2
    v_smfmac_f32_16x16x64_bf16 v[82:85], v[34:37], a[248:255], v2
    v_pk_add_f32 v[70:71], v[70:71], v[72:73]
    v_smfmac_f32_16x16x64_bf16 v[86:89], v[34:37], v[184:191], v2
    v_cvt_pk_bf16_f32 v108, v70, v71
    v_cvt_pk_bf16_f32 v109, v70, v71
    v_smfmac_f32_16x16x64_bf16 v[82:85], v[38:41], v[112:119], v2
    v_mfma_f32_16x16x16_bf16 v[70:73], v[108:109], v[24:25], 0
    v_smfmac_f32_16x16x64_bf16 v[86:89], v[38:41], v[192:199], v2
    v_smfmac_f32_16x16x64_bf16 v[82:85], v[42:45], v[120:127], v2
    v_cvt_pk_bf16_f32 v108, v70, v71
    v_smfmac_f32_16x16x64_bf16 v[86:89], v[42:45], v[200:207], v2
    v_cvt_pk_bf16_f32 v109, v72, v73
    s_mov_b64 exec, s[36:37]
    v_smfmac_f32_16x16x64_bf16 v[82:85], v[46:49], v[128:135], v2
    buffer_store_dwordx2 v[108:109], v11, s[8:11], s46 offen sc1
    s_mov_b64 exec, -1
    v_smfmac_f32_16x16x64_bf16 v[86:89], v[46:49], v[208:215], v2
    v_smfmac_f32_16x16x64_bf16 v[82:85], v[50:53], v[136:143], v2
    v_smfmac_f32_16x16x64_bf16 v[86:89], v[50:53], v[216:223], v2
    v_smfmac_f32_16x16x64_bf16 v[82:85], v[54:57], v[144:151], v2
    v_smfmac_f32_16x16x64_bf16 v[86:89], v[54:57], v[224:231], v2
    v_smfmac_f32_16x16x64_bf16 v[82:85], v[58:61], v[152:159], v2
    v_smfmac_f32_16x16x64_bf16 v[86:89], v[58:61], v[232:239], v2
    v_smfmac_f32_16x16x64_bf16 v[82:85], v[62:65], v[160:167], v2
    v_smfmac_f32_16x16x64_bf16 v[86:89], v[62:65], v[240:247], v2
    v_smfmac_f32_16x16x64_bf16 v[82:85], v[66:69], v[168:175], v2
    v_smfmac_f32_16x16x64_bf16 v[86:89], v[66:69], v[248:255], v2
    s_nop 7
    v_pk_add_f32 v[82:83], v[82:83], v[84:85]
    v_cvt_pk_bf16_f32 v106, v82, v83
    v_pk_add_f32 v[86:87], v[86:87], v[88:89]
    v_cvt_pk_bf16_f32 v107, v86, v87
    s_add_u32 s44, s26, 71303168
    buffer_store_dword v106, v17, s[8:11], s44 offen sc1
    buffer_store_dword v107, v17, s[8:11], s44 offen offset:64 sc1
ST_54_end:
    s_waitcnt vmcnt(0)
M_end:
    s_endpgm
M_codeend:
.section .rodata,"a"
.p2align 6
.amdhsa_kernel concat_heads__memory_aug_recurrent_mem_tr__mha_block__prompt_kernel
  .amdhsa_next_free_vgpr 512
  .amdhsa_next_free_sgpr 102
  .amdhsa_accum_offset 256
  .amdhsa_group_segment_fixed_size 0
  .amdhsa_kernarg_size 104
  .amdhsa_user_sgpr_count 2
  .amdhsa_user_sgpr_kernarg_segment_ptr 1
  .amdhsa_system_sgpr_workgroup_id_x 1
.end_amdhsa_kernel
```
